```python
import torch

def _softmax(x, axis=-1):
    return torch.softmax(x, dim=axis)
def _gelu(x):
    return torch.nn.functional.gelu(x, approximate="tanh")
def _silu(x):
    return torch.nn.functional.silu(x)
def _sigmoid(x):
    return torch.sigmoid(x)
def _layernorm(x, axis=-1, eps=1e-5):
    m = x.mean(dim=axis, keepdim=True)
    v = x.var(dim=axis, keepdim=True, unbiased=False)
    return (x - m) / torch.sqrt(v + eps)
def _scatter_add(tgt, idx, src, axis=0):
    return tgt.clone().index_add_(axis, idx, src)
def _segment_sum(src, seg, n):
    out = torch.zeros((n,) + src.shape[1:], dtype=src.dtype)
    return out.index_add_(0, seg, src)
def _pad(x, pw):
    flat = tuple(v for pair in reversed(pw) for v in pair)
    return torch.nn.functional.pad(x, flat)

kernel_name = 'interleave_layers__ssm_conv_h3__glu_gated_bilinear__prompt'

def setup_inputs():

    _w = (lambda a: (lambda t: t.to(torch.bfloat16) if t.is_floating_point() else t)(torch.as_tensor(a)))
    def _A_setup():
        B, S, D = 1, 2048, 640
        ks = 4
        return {
            "q": _w((lambda *s: torch.randn(*s, dtype=torch.bfloat16) * 0.05)(B, S, D)),
            "k": _w((lambda *s: torch.randn(*s, dtype=torch.bfloat16) * 0.2)(B, S, D)),
            "v": _w((lambda *s: torch.randn(*s, dtype=torch.bfloat16) * 0.2)(B, S, D)),
            "shift_k": _w((lambda *s: torch.randn(*s, dtype=torch.bfloat16) * 0.2)(D, ks) * 0.5),
            "ssm_k": _w((lambda *s: torch.randn(*s, dtype=torch.bfloat16) * 0.8)(D, S) * (1.0 / S ** 0.5)),
            "ssm_D": _w((lambda *s: torch.randn(*s, dtype=torch.bfloat16) * 0.2)(D)),
        }
    _A_in = _A_setup()

    def _B_setup():
        B, S, D, F = 1, 2048, 640, 1728
        return {
            "x": _w((lambda *s: torch.randn(*s, dtype=torch.bfloat16) * 0.05)(B, S, D)),
            "w_gate": _w((lambda *s: torch.randn(*s, dtype=torch.bfloat16) * 0.4)(D, F) * (D ** -0.5)),
            "w_up": _w((lambda *s: torch.randn(*s, dtype=torch.bfloat16) * 0.4)(D, F) * (D ** -0.5)),
            "w_down": _w((lambda *s: torch.randn(*s, dtype=torch.bfloat16) * 0.4)(F, D) * (F ** -0.5)),
        }
    _B_in = _B_setup()

    return {
        "A_q": _A_in["q"],
        "A_k": _A_in["k"],
        "A_v": _A_in["v"],
        "A_shift_k": _A_in["shift_k"],
        "A_ssm_k": _A_in["ssm_k"],
        "A_ssm_D": _A_in["ssm_D"],
        "B_x": _B_in["x"],
        "B_w_gate": _B_in["w_gate"],
        "B_w_up": _B_in["w_up"],
        "B_w_down": _B_in["w_down"],
    }

def reference(A_q, A_k, A_v, A_shift_k, A_ssm_k, A_ssm_D, B_x, B_w_gate, B_w_up, B_w_down):
    def _A_ref(q, k, v, shift_k, ssm_k, ssm_D):
        B, S, D = q.shape
        ks = shift_k.shape[-1]
        k_pad = _pad(k, ((0, 0), (ks - 1, 0), (0, 0)))
        k_shift = torch.zeros_like(k)
        for t in range(ks):
            k_shift = k_shift + k_pad[:, t:t + S, :] * shift_k[:, ks - 1 - t][None, None, :]
        kv = k_shift * v
        L = 2 * S
        kv_pad = _pad(kv, ((0, 0), (0, S), (0, 0)))
        kf_pad = _pad(ssm_k, ((0, 0), (0, S)))
        kv_f = (lambda x, axes=(-2,-1): torch.fft.rfft2(x.float(), dim=axes))(kv_pad[:, None, :, :], axes=(1, 2))
        kf_f = (lambda x, axes=(-2,-1): torch.fft.rfft2(x.float(), dim=axes))(kf_pad[:, None, :], axes=(1, 2))
        kf_f = (lambda x, *d: x.permute(*d))(kf_f, 1, 2, 0)
        y_f = kv_f * kf_f[None, :, :, :]
        y = (lambda x, s, axes=(-2,-1): torch.fft.irfft2(x, s=s, dim=axes).to(torch.bfloat16))(y_f, (1, L), axes=(1, 2))[:, 0, :S, :]
        y = y + kv * ssm_D[None, None, :]
        return q * y

    def _B_ref(x, w_gate, w_up, w_down):
        g = torch.einsum("bsd,df->bsf", x, w_gate)
        u = torch.einsum("bsd,df->bsf", x, w_up)
        h = g * u
        return torch.einsum("bsf,fd->bsd", h, w_down)

    x = A_q
    x = x + _A_ref(_layernorm(x, axis=-1), A_k, A_v, A_shift_k, A_ssm_k, A_ssm_D)
    x = x + _B_ref(_layernorm(x, axis=-1), B_w_gate, B_w_up, B_w_down)
    x = x + _A_ref(_layernorm(x, axis=-1), A_k, A_v, A_shift_k, A_ssm_k, A_ssm_D)
    x = x + _B_ref(_layernorm(x, axis=-1), B_w_gate, B_w_up, B_w_down)
    return x
```

```asm
; @launch grid=(256,1,1) block=(256,1,1) lds=163840
.amdgcn_target "amdgcn-amd-amdhsa--gfx950"
.text
.globl interleave_layers__ssm_conv_h3__glu_gated_bilinear__prompt_kernel
.p2align 8
.type interleave_layers__ssm_conv_h3__glu_gated_bilinear__prompt_kernel,@function
interleave_layers__ssm_conv_h3__glu_gated_bilinear__prompt_kernel:
    s_cmp_ge_u32 s2, 256
    s_cbranch_scc1 L_end_1
    s_load_dwordx16 s[64:79], s[0:1], 0
    s_load_dwordx8 s[80:87], s[0:1], 64
    s_load_dwordx2 s[4:5], s[0:1], 96
    v_lshrrev_b32 v1, 6, v0
    v_and_b32 v0, 63, v0
    v_readfirstlane_b32 s3, v1
    s_and_b32 s45, s2, 7
    s_lshr_b32 s47, s2, 3
    s_lshr_b32 s28, s3, 1
    s_and_b32 s29, s3, 1
    s_cmp_ge_u32 s47, 20
    s_cbranch_scc1 L_help_2
    s_mul_i32 s31, s45, 20
    s_add_u32 s31, s31, s47
    s_and_b32 s33, s31, 15
    s_lshl_b32 s33, s33, 7
    s_lshl_b32 s92, s3, 5
    s_add_u32 s33, s33, s92
    s_lshr_b32 s92, s31, 4
    s_lshl_b32 s92, s92, 6
    v_lshrrev_b32 v26, 4, v0
    v_lshlrev_b32 v26, 3, v26
    v_add_u32 v26, s33, v26
    v_and_b32 v27, 15, v0
    v_lshlrev_b32 v27, 2, v27
    v_add_u32 v27, s92, v27
    v_mul_u32_u24 v28, 1280, v26
    v_lshl_add_u32 v28, v27, 1, v28
    v_subrev_u32 v29, 3840, v28
    v_lshlrev_b32 v30, 3, v27
    s_movk_i32 s93, 5120
    s_waitcnt lgkmcnt(0)
    s_mov_b32 s12, s4
    s_mov_b32 s13, s5
    s_mov_b32 s14, 0x25d0000
    s_mov_b32 s15, 0x20000
    s_mov_b32 s88, s66
    s_mov_b32 s89, s67
    s_mov_b32 s90, 0x280000
    s_mov_b32 s91, 0x20000
    s_mov_b32 s8, s68
    s_mov_b32 s9, s69
    s_mov_b32 s10, 0x280000
    s_mov_b32 s11, 0x20000
    buffer_load_dwordx2 v[160:161], v29, s[88:91], 0 offen offset:0 nt
    buffer_load_dwordx2 v[162:163], v29, s[88:91], 0 offen offset:1280 nt
    buffer_load_dwordx2 v[164:165], v29, s[88:91], 0 offen offset:2560 nt
    buffer_load_dwordx2 v[166:167], v28, s[88:91], 0 offen offset:0 nt
    buffer_load_dwordx2 v[168:169], v28, s[88:91], 0 offen offset:1280 nt
    buffer_load_dwordx2 v[170:171], v28, s[88:91], 0 offen offset:2560 nt
    buffer_load_dwordx2 v[172:173], v28, s[88:91], 0 offen offset:3840 nt
    buffer_load_dwordx2 v[174:175], v28, s[88:91], s93 offen offset:0 nt
    buffer_load_dwordx2 v[176:177], v28, s[88:91], s93 offen offset:1280 nt
    buffer_load_dwordx2 v[178:179], v28, s[88:91], s93 offen offset:2560 nt
    buffer_load_dwordx2 v[180:181], v28, s[88:91], s93 offen offset:3840 nt
    s_mov_b32 s88, s70
    s_mov_b32 s89, s71
    s_mov_b32 s90, 0x1400
    s_mov_b32 s91, 0x20000
    buffer_load_dwordx4 v[200:203], v30, s[88:91], 0 offen nt
    buffer_load_dwordx4 v[204:207], v30, s[88:91], 0 offen offset:16 nt
    buffer_load_dwordx2 v[184:185], v28, s[8:11], 0 offen offset:0 nt
    buffer_load_dwordx2 v[186:187], v28, s[8:11], 0 offen offset:1280 nt
    buffer_load_dwordx2 v[188:189], v28, s[8:11], 0 offen offset:2560 nt
    buffer_load_dwordx2 v[190:191], v28, s[8:11], 0 offen offset:3840 nt
    buffer_load_dwordx2 v[192:193], v28, s[8:11], s93 offen offset:0 nt
    buffer_load_dwordx2 v[194:195], v28, s[8:11], s93 offen offset:1280 nt
    buffer_load_dwordx2 v[196:197], v28, s[8:11], s93 offen offset:2560 nt
    buffer_load_dwordx2 v[198:199], v28, s[8:11], s93 offen offset:3840 nt
    s_lshl_b32 s33, s31, 2
    s_add_u32 s33, s33, s3
    s_mul_i32 s92, s3, 37888
    s_mov_b32 s88, s72
    s_mov_b32 s89, s73
    s_mov_b32 s90, 0x280000
    s_mov_b32 s91, 0x20000
    s_mov_b32 s8, s74
    s_mov_b32 s9, s75
    s_mov_b32 s10, 0x500
    s_mov_b32 s11, 0x20000
    s_lshl_b32 s93, s33, 12
    s_lshl_b32 s94, s33, 1
    v_lshlrev_b32 v2, 4, v0
    v_mov_b32 v20, 0
    buffer_load_ushort v52, v20, s[8:11], s94 offen nt
    s_mov_b32 s55, 0x17c3000
    buffer_load_dword v19, v20, s[12:15], s55 offen sc1
    buffer_load_dwordx4 v[60:63], v2, s[88:91], s93 offen offset:0 nt
    buffer_load_dwordx4 v[68:71], v2, s[88:91], s93 offen offset:1024 nt
    buffer_load_dwordx4 v[76:79], v2, s[88:91], s93 offen offset:2048 nt
    buffer_load_dwordx4 v[84:87], v2, s[88:91], s93 offen offset:3072 nt
    v_lshlrev_b32 v31, 12, v27
    v_add_u32 v31, 4080, v31
    v_lshlrev_b32 v30, 1, v26
    v_sub_u32 v53, v31, v30
    s_mov_b32 s16, s64
    s_mov_b32 s17, s65
    s_mov_b32 s18, 0x280000
    s_mov_b32 s19, 0x20000
    s_mov_b32 s20, s84
    s_mov_b32 s21, s85
    s_mov_b32 s22, 0x280000
    s_mov_b32 s23, 0x20000
    s_mov_b32 s24, s45
    s_mov_b32 s58, s47
    s_and_b32 s26, s58, 7
    s_lshr_b32 s27, s58, 3
    s_xor_b32 s39, s29, s58
    s_and_b32 s39, s39, 1
    s_lshr_b32 s59, s45, 2
    s_lshl_b32 s59, s59, 2
    s_lshr_b32 s51, s47, 3
    s_add_u32 s59, s59, s51
    s_and_b32 s25, s45, 3
    s_lshl_b32 s25, s25, 3
    s_and_b32 s51, s47, 7
    s_add_u32 s25, s25, s51
    s_lshl_b32 s51, s59, 2
    s_add_u32 s52, s51, s3
    s_lshl_b32 s51, s24, 2
    s_add_u32 s53, s51, s27
    s_mul_i32 s30, s52, 40960
    s_mul_i32 s32, s53, 114688
    s_mul_i32 s51, s3, 28672
    s_add_u32 s32, s32, s51
    s_mul_i32 s34, s52, 114688
    s_mul_i32 s36, s53, 40960
    s_lshl_b32 s51, s39, 10
    s_add_u32 s36, s36, s51
    s_lshl_b32 s38, s53, 1
    s_add_u32 s38, s38, s39
    s_lshl_b32 s48, s38, 13
    s_lshl_b32 s51, s26, 1
    s_add_u32 s51, s51, s28
    s_lshl_b32 s51, s51, 9
    s_add_u32 s49, s48, s51
    s_mul_i32 s38, s38, 20480
    s_mov_b32 s35, s38
    s_mul_i32 s51, s26, 160
    s_add_u32 s38, s38, s51
    s_lshl_b32 s40, s52, 12
    s_lshl_b32 s42, s53, 12
    s_lshl_b32 s51, s26, 7
    s_add_u32 s42, s42, s51
    s_lshl_b32 s44, s53, 12
    s_lshl_b32 s51, s3, 10
    s_add_u32 s44, s44, s51
    s_lshl_b32 s46, s52, 12
    s_lshl_b32 s51, s25, 7
    s_add_u32 s46, s46, s51
    s_mov_b32 s50, 100000
    s_cmp_eq_u32 s28, 0
    s_cselect_b32 s56, -1, 0
    s_cselect_b32 s57, 0, -1
    v_lshlrev_b32 v2, 4, v0
    s_lshl_b32 s51, s39, 10
    v_add_u32 v5, s51, v2
    v_xor_b32 v6, 1024, v5
    v_lshrrev_b32 v21, 4, v0
    v_and_b32 v22, 15, v0
    v_lshlrev_b32 v23, 4, v22
    s_mul_i32 s51, s25, 7
    v_add_u32 v25, s51, v21
    v_lshrrev_b32 v24, 2, v25
    v_lshl_add_u32 v7, v24, 11, v23
    v_and_b32 v24, 3, v25
    v_lshl_add_u32 v7, v24, 8, v7
    s_mul_i32 s51, s26, 10
    s_lshl_b32 s54, s28, 2
    s_add_u32 s54, s54, s51
    v_add_u32 v25, s54, v21
    v_lshrrev_b32 v24, 2, v25
    v_lshl_add_u32 v8, v24, 11, v23
    v_and_b32 v24, 3, v25
    v_lshl_add_u32 v8, v24, 8, v8
    s_add_u32 s51, s51, 8
    v_lshrrev_b32 v25, 1, v21
    v_add_u32 v25, s51, v25
    v_lshrrev_b32 v24, 2, v25
    v_lshl_add_u32 v9, v24, 11, v23
    v_and_b32 v24, 3, v25
    v_lshl_add_u32 v9, v24, 8, v9
    v_and_b32 v24, 1, v21
    v_lshl_add_u32 v9, v24, 3, v9
    v_mul_u32_u24 v24, 1280, v22
    v_lshl_add_u32 v10, v21, 4, v24
    s_lshl_b32 s51, s28, 6
    v_add_u32 v10, s51, v10
    v_lshl_add_u32 v11, v21, 3, v24
    v_add_u32 v11, 128, v11
    v_and_b32 v12, 31, v0
    v_lshlrev_b32 v12, 7, v12
    v_and_b32 v13, 7, v0
    v_lshlrev_b32 v13, 7, v13
    v_lshlrev_b32 v14, 5, v22
    v_lshl_add_u32 v14, v21, 3, v14
    s_xor_b32 s51, s3, 0
    s_mul_i32 s51, s51, 5120
    s_add_u32 s51, s51, 143360
    v_add_u32 v15, s51, v2
    s_xor_b32 s51, s3, 1
    s_mul_i32 s51, s51, 5120
    s_add_u32 s51, s51, 143360
    v_add_u32 v16, s51, v2
    s_xor_b32 s51, s3, 2
    s_mul_i32 s51, s51, 5120
    s_add_u32 s51, s51, 143360
    v_add_u32 v17, s51, v2
    s_xor_b32 s51, s3, 3
    s_mul_i32 s51, s51, 5120
    s_add_u32 s51, s51, 143360
    v_add_u32 v1, s51, v2
    v_mov_b32 v20, 0
    v_and_b32 v24, 3, v0
    v_lshrrev_b32 v25, 2, v0
    v_mul_u32_u24 v252, 1280, v24
    v_lshl_add_u32 v252, v25, 4, v252
    s_lshl_b32 s62, s24, 7
    s_lshl_b32 s54, s29, 10
    s_add_u32 s62, s62, s54
    s_lshl_b32 s54, s58, 2
    s_add_u32 s62, s62, s54
    s_mul_i32 s62, s62, 1280
    s_mul_i32 s60, s26, 56
    s_mul_i32 s54, s3, 14
    s_add_u32 s60, s60, s54
    s_mul_i32 s60, s60, 5120
    s_add_u32 s60, s60, 0x1360000
    s_lshl_b32 s37, s26, 7
    s_add_u32 s37, s37, 0x17b8000
    s_waitcnt vmcnt(26)
    v_lshlrev_b32 v208, 16, v160
    v_and_b32 v209, 0xffff0000, v160
    v_lshlrev_b32 v210, 16, v161
    v_and_b32 v211, 0xffff0000, v161
    s_waitcnt vmcnt(25)
    v_lshlrev_b32 v212, 16, v162
    v_and_b32 v213, 0xffff0000, v162
    v_lshlrev_b32 v214, 16, v163
    v_and_b32 v215, 0xffff0000, v163
    s_waitcnt vmcnt(24)
    v_lshlrev_b32 v216, 16, v164
    v_and_b32 v217, 0xffff0000, v164
    v_lshlrev_b32 v218, 16, v165
    v_and_b32 v219, 0xffff0000, v165
    s_waitcnt vmcnt(23)
    v_lshlrev_b32 v220, 16, v166
    v_and_b32 v221, 0xffff0000, v166
    v_lshlrev_b32 v222, 16, v167
    v_and_b32 v223, 0xffff0000, v167
    s_waitcnt vmcnt(22)
    v_lshlrev_b32 v224, 16, v168
    v_and_b32 v225, 0xffff0000, v168
    v_lshlrev_b32 v226, 16, v169
    v_and_b32 v227, 0xffff0000, v169
    s_waitcnt vmcnt(21)
    v_lshlrev_b32 v228, 16, v170
    v_and_b32 v229, 0xffff0000, v170
    v_lshlrev_b32 v230, 16, v171
    v_and_b32 v231, 0xffff0000, v171
    s_waitcnt vmcnt(20)
    v_lshlrev_b32 v232, 16, v172
    v_and_b32 v233, 0xffff0000, v172
    v_lshlrev_b32 v234, 16, v173
    v_and_b32 v235, 0xffff0000, v173
    s_waitcnt vmcnt(19)
    v_lshlrev_b32 v236, 16, v174
    v_and_b32 v237, 0xffff0000, v174
    v_lshlrev_b32 v238, 16, v175
    v_and_b32 v239, 0xffff0000, v175
    s_waitcnt vmcnt(18)
    v_lshlrev_b32 v240, 16, v176
    v_and_b32 v241, 0xffff0000, v176
    v_lshlrev_b32 v242, 16, v177
    v_and_b32 v243, 0xffff0000, v177
    s_waitcnt vmcnt(17)
    v_lshlrev_b32 v244, 16, v178
    v_and_b32 v245, 0xffff0000, v178
    v_lshlrev_b32 v246, 16, v179
    v_and_b32 v247, 0xffff0000, v179
    s_waitcnt vmcnt(16)
    v_lshlrev_b32 v248, 16, v180
    v_and_b32 v249, 0xffff0000, v180
    v_lshlrev_b32 v250, 16, v181
    v_and_b32 v251, 0xffff0000, v181
    s_waitcnt vmcnt(14)
    v_lshlrev_b32 v88, 16, v200
    v_and_b32 v92, 0xffff0000, v200
    v_lshlrev_b32 v96, 16, v201
    v_and_b32 v100, 0xffff0000, v201
    v_lshlrev_b32 v89, 16, v202
    v_and_b32 v93, 0xffff0000, v202
    v_lshlrev_b32 v97, 16, v203
    v_and_b32 v101, 0xffff0000, v203
    v_lshlrev_b32 v90, 16, v204
    v_and_b32 v94, 0xffff0000, v204
    v_lshlrev_b32 v98, 16, v205
    v_and_b32 v102, 0xffff0000, v205
    v_lshlrev_b32 v91, 16, v206
    v_and_b32 v95, 0xffff0000, v206
    v_lshlrev_b32 v99, 16, v207
    v_and_b32 v103, 0xffff0000, v207
    v_pk_mul_f32 v[128:129], v[208:209], v[100:101]
    v_pk_mul_f32 v[130:131], v[210:211], v[102:103]
    v_pk_fma_f32 v[128:129], v[212:213], v[96:97], v[128:129]
    v_pk_fma_f32 v[130:131], v[214:215], v[98:99], v[130:131]
    v_pk_fma_f32 v[128:129], v[216:217], v[92:93], v[128:129]
    v_pk_fma_f32 v[130:131], v[218:219], v[94:95], v[130:131]
    v_pk_fma_f32 v[128:129], v[220:221], v[88:89], v[128:129]
    v_pk_fma_f32 v[130:131], v[222:223], v[90:91], v[130:131]
    v_pk_mul_f32 v[132:133], v[212:213], v[100:101]
    v_pk_mul_f32 v[134:135], v[214:215], v[102:103]
    v_pk_fma_f32 v[132:133], v[216:217], v[96:97], v[132:133]
    v_pk_fma_f32 v[134:135], v[218:219], v[98:99], v[134:135]
    v_pk_fma_f32 v[132:133], v[220:221], v[92:93], v[132:133]
    v_pk_fma_f32 v[134:135], v[222:223], v[94:95], v[134:135]
    v_pk_fma_f32 v[132:133], v[224:225], v[88:89], v[132:133]
    v_pk_fma_f32 v[134:135], v[226:227], v[90:91], v[134:135]
    v_pk_mul_f32 v[136:137], v[216:217], v[100:101]
    v_pk_mul_f32 v[138:139], v[218:219], v[102:103]
    v_pk_fma_f32 v[136:137], v[220:221], v[96:97], v[136:137]
    v_pk_fma_f32 v[138:139], v[222:223], v[98:99], v[138:139]
    v_pk_fma_f32 v[136:137], v[224:225], v[92:93], v[136:137]
    v_pk_fma_f32 v[138:139], v[226:227], v[94:95], v[138:139]
    v_pk_fma_f32 v[136:137], v[228:229], v[88:89], v[136:137]
    v_pk_fma_f32 v[138:139], v[230:231], v[90:91], v[138:139]
    v_pk_mul_f32 v[140:141], v[220:221], v[100:101]
    v_pk_mul_f32 v[142:143], v[222:223], v[102:103]
    v_pk_fma_f32 v[140:141], v[224:225], v[96:97], v[140:141]
    v_pk_fma_f32 v[142:143], v[226:227], v[98:99], v[142:143]
    v_pk_fma_f32 v[140:141], v[228:229], v[92:93], v[140:141]
    v_pk_fma_f32 v[142:143], v[230:231], v[94:95], v[142:143]
    v_pk_fma_f32 v[140:141], v[232:233], v[88:89], v[140:141]
    v_pk_fma_f32 v[142:143], v[234:235], v[90:91], v[142:143]
    v_pk_mul_f32 v[144:145], v[224:225], v[100:101]
    v_pk_mul_f32 v[146:147], v[226:227], v[102:103]
    v_pk_fma_f32 v[144:145], v[228:229], v[96:97], v[144:145]
    v_pk_fma_f32 v[146:147], v[230:231], v[98:99], v[146:147]
    v_pk_fma_f32 v[144:145], v[232:233], v[92:93], v[144:145]
    v_pk_fma_f32 v[146:147], v[234:235], v[94:95], v[146:147]
    v_pk_fma_f32 v[144:145], v[236:237], v[88:89], v[144:145]
    v_pk_fma_f32 v[146:147], v[238:239], v[90:91], v[146:147]
    v_pk_mul_f32 v[148:149], v[228:229], v[100:101]
    v_pk_mul_f32 v[150:151], v[230:231], v[102:103]
    v_pk_fma_f32 v[148:149], v[232:233], v[96:97], v[148:149]
    v_pk_fma_f32 v[150:151], v[234:235], v[98:99], v[150:151]
    v_pk_fma_f32 v[148:149], v[236:237], v[92:93], v[148:149]
    v_pk_fma_f32 v[150:151], v[238:239], v[94:95], v[150:151]
    v_pk_fma_f32 v[148:149], v[240:241], v[88:89], v[148:149]
    v_pk_fma_f32 v[150:151], v[242:243], v[90:91], v[150:151]
    v_pk_mul_f32 v[152:153], v[232:233], v[100:101]
    v_pk_mul_f32 v[154:155], v[234:235], v[102:103]
    v_pk_fma_f32 v[152:153], v[236:237], v[96:97], v[152:153]
    v_pk_fma_f32 v[154:155], v[238:239], v[98:99], v[154:155]
    v_pk_fma_f32 v[152:153], v[240:241], v[92:93], v[152:153]
    v_pk_fma_f32 v[154:155], v[242:243], v[94:95], v[154:155]
    v_pk_fma_f32 v[152:153], v[244:245], v[88:89], v[152:153]
    v_pk_fma_f32 v[154:155], v[246:247], v[90:91], v[154:155]
    v_pk_mul_f32 v[156:157], v[236:237], v[100:101]
    v_pk_mul_f32 v[158:159], v[238:239], v[102:103]
    v_pk_fma_f32 v[156:157], v[240:241], v[96:97], v[156:157]
    v_pk_fma_f32 v[158:159], v[242:243], v[98:99], v[158:159]
    v_pk_fma_f32 v[156:157], v[244:245], v[92:93], v[156:157]
    v_pk_fma_f32 v[158:159], v[246:247], v[94:95], v[158:159]
    v_pk_fma_f32 v[156:157], v[248:249], v[88:89], v[156:157]
    v_pk_fma_f32 v[158:159], v[250:251], v[90:91], v[158:159]
    s_waitcnt vmcnt(13)
    v_lshlrev_b32 v88, 16, v184
    v_and_b32 v89, 0xffff0000, v184
    v_lshlrev_b32 v90, 16, v185
    v_and_b32 v91, 0xffff0000, v185
    v_pk_mul_f32 v[128:129], v[128:129], v[88:89]
    v_pk_mul_f32 v[130:131], v[130:131], v[90:91]
    s_waitcnt vmcnt(12)
    v_lshlrev_b32 v104, 16, v186
    v_and_b32 v105, 0xffff0000, v186
    v_lshlrev_b32 v106, 16, v187
    v_and_b32 v107, 0xffff0000, v187
    v_pk_mul_f32 v[132:133], v[132:133], v[104:105]
    v_pk_mul_f32 v[134:135], v[134:135], v[106:107]
    s_waitcnt vmcnt(11)
    v_lshlrev_b32 v88, 16, v188
    v_and_b32 v89, 0xffff0000, v188
    v_lshlrev_b32 v90, 16, v189
    v_and_b32 v91, 0xffff0000, v189
    v_pk_mul_f32 v[136:137], v[136:137], v[88:89]
    v_pk_mul_f32 v[138:139], v[138:139], v[90:91]
    s_waitcnt vmcnt(10)
    v_lshlrev_b32 v104, 16, v190
    v_and_b32 v105, 0xffff0000, v190
    v_lshlrev_b32 v106, 16, v191
    v_and_b32 v107, 0xffff0000, v191
    v_pk_mul_f32 v[140:141], v[140:141], v[104:105]
    v_pk_mul_f32 v[142:143], v[142:143], v[106:107]
    s_waitcnt vmcnt(9)
    v_lshlrev_b32 v88, 16, v192
    v_and_b32 v89, 0xffff0000, v192
    v_lshlrev_b32 v90, 16, v193
    v_and_b32 v91, 0xffff0000, v193
    v_pk_mul_f32 v[144:145], v[144:145], v[88:89]
    v_pk_mul_f32 v[146:147], v[146:147], v[90:91]
    s_waitcnt vmcnt(8)
    v_lshlrev_b32 v104, 16, v194
    v_and_b32 v105, 0xffff0000, v194
    v_lshlrev_b32 v106, 16, v195
    v_and_b32 v107, 0xffff0000, v195
    v_pk_mul_f32 v[148:149], v[148:149], v[104:105]
    v_pk_mul_f32 v[150:151], v[150:151], v[106:107]
    s_waitcnt vmcnt(7)
    v_lshlrev_b32 v88, 16, v196
    v_and_b32 v89, 0xffff0000, v196
    v_lshlrev_b32 v90, 16, v197
    v_and_b32 v91, 0xffff0000, v197
    v_pk_mul_f32 v[152:153], v[152:153], v[88:89]
    v_pk_mul_f32 v[154:155], v[154:155], v[90:91]
    s_waitcnt vmcnt(6)
    v_lshlrev_b32 v104, 16, v198
    v_and_b32 v105, 0xffff0000, v198
    v_lshlrev_b32 v106, 16, v199
    v_and_b32 v107, 0xffff0000, v199
    v_pk_mul_f32 v[156:157], v[156:157], v[104:105]
    v_pk_mul_f32 v[158:159], v[158:159], v[106:107]
    v_cvt_pk_bf16_f32 v160, v156, v152
    v_cvt_pk_bf16_f32 v161, v148, v144
    v_cvt_pk_bf16_f32 v162, v140, v136
    v_cvt_pk_bf16_f32 v163, v132, v128
    s_mov_b32 s94, 0x0
    buffer_store_dwordx4 v[160:163], v53, s[12:15], s94 offen sc1
    v_cvt_pk_bf16_f32 v164, v157, v153
    v_cvt_pk_bf16_f32 v165, v149, v145
    v_cvt_pk_bf16_f32 v166, v141, v137
    v_cvt_pk_bf16_f32 v167, v133, v129
    s_mov_b32 s94, 0x1000
    buffer_store_dwordx4 v[164:167], v53, s[12:15], s94 offen sc1
    v_cvt_pk_bf16_f32 v168, v158, v154
    v_cvt_pk_bf16_f32 v169, v150, v146
    v_cvt_pk_bf16_f32 v170, v142, v138
    v_cvt_pk_bf16_f32 v171, v134, v130
    s_mov_b32 s94, 0x2000
    buffer_store_dwordx4 v[168:171], v53, s[12:15], s94 offen sc1
    v_cvt_pk_bf16_f32 v172, v159, v155
    v_cvt_pk_bf16_f32 v173, v151, v147
    v_cvt_pk_bf16_f32 v174, v143, v139
    v_cvt_pk_bf16_f32 v175, v135, v131
    s_mov_b32 s94, 0x3000
    buffer_store_dwordx4 v[172:175], v53, s[12:15], s94 offen sc1
    v_mov_b32 v232, 0
    v_mov_b32 v56, 0
    v_mov_b32 v233, 0
    v_mov_b32 v57, 0
    v_mov_b32 v234, 0
    v_mov_b32 v58, 0
    v_mov_b32 v235, 0
    v_mov_b32 v59, 0
    v_add_u32 v238, s92, v2
    v_and_b32 v24, 31, v0
    v_min_u32 v24, 29, v24
    v_lshlrev_b32 v24, 4, v24
    v_add_u32 v24, 37376, v24
    v_and_b32 v25, 7, v0
    v_mul_u32_u24 v25, 4160, v25
    v_cmp_gt_u32 vcc, 32, v0
    v_bfe_u32 v26, v0, 3, 1
    v_add_u32 v26, v26, v21
    v_cndmask_b32 v24, v25, v24, vcc
    v_add_u32 v24, s92, v24
    ds_write_b128 v24, v[232:235]
    v_lshlrev_b32 v26, 4, v26
    v_add3_u32 v236, v25, v26, s92
    v_lshlrev_b32 v24, 5, v22
    v_sub_u32 v25, 33760, v24
    v_lshl_add_u32 v25, v21, 4, v25
    v_add_u32 v237, s92, v25
    v_lshl_add_u32 v24, v21, 3, v24
    s_mul_i32 s94, s3, 2080
    s_add_u32 s94, s94, 151552
    v_add_u32 v239, s94, v24
    v_bfe_u32 v24, v0, 2, 2
    v_mul_u32_u24 v24, 2080, v24
    v_lshl_add_u32 v24, v21, 5, v24
    v_and_b32 v25, 3, v0
    v_lshl_add_u32 v24, v25, 3, v24
    s_lshl_b32 s94, s3, 9
    s_add_u32 s94, s94, 151552
    v_add_u32 v240, s94, v24
    v_mul_u32_u24 v25, 20480, v21
    v_lshl_add_u32 v241, v22, 3, v25
    s_mul_i32 s95, s3, 327680
    s_lshl_b32 s94, s31, 7
    s_add_u32 s95, s95, s94
    s_add_u32 s95, s95, 0x500000
    s_lshl_b32 s63, s31, 7
    s_add_u32 s63, s63, 0x17be000
    s_waitcnt vmcnt(4)
    v_add_u32 v19, 1, v19
    ds_write_b128 v238, v[60:63] offset:29136
    v_mov_b32_dpp v56, v60 wave_shr:1 row_mask:0xf bank_mask:0xf
    v_mov_b32_dpp v57, v61 wave_shr:1 row_mask:0xf bank_mask:0xf
    v_mov_b32_dpp v58, v62 wave_shr:1 row_mask:0xf bank_mask:0xf
    v_mov_b32_dpp v59, v63 wave_shr:1 row_mask:0xf bank_mask:0xf
    v_mov_b32_dpp v64, v60 wave_ror:1 row_mask:0xf bank_mask:0xf
    v_mov_b32_dpp v65, v61 wave_ror:1 row_mask:0xf bank_mask:0xf
    v_mov_b32_dpp v66, v62 wave_ror:1 row_mask:0xf bank_mask:0xf
    v_mov_b32_dpp v67, v63 wave_ror:1 row_mask:0xf bank_mask:0xf
    ds_write_b128 v238, v[58:61] offset:12496
    v_mov_b32 v96, v57
    v_mov_b32 v97, v58
    v_mov_b32 v98, v59
    v_mov_b32 v99, v60
    v_mov_b32 v100, v61
    v_mov_b32 v101, v62
    ds_write_b128 v238, v[96:99] offset:4176
    ds_write_b128 v238, v[98:101] offset:20816
    v_alignbit_b32 v102, v57, v56, 16
    v_alignbit_b32 v103, v58, v57, 16
    v_alignbit_b32 v104, v59, v58, 16
    v_alignbit_b32 v105, v60, v59, 16
    v_alignbit_b32 v106, v61, v60, 16
    v_alignbit_b32 v107, v62, v61, 16
    ds_write_b128 v238, v[102:105] offset:16
    ds_write_b128 v238, v[104:107] offset:16656
    v_alignbit_b32 v108, v58, v57, 16
    v_alignbit_b32 v109, v59, v58, 16
    v_alignbit_b32 v110, v60, v59, 16
    v_alignbit_b32 v111, v61, v60, 16
    v_alignbit_b32 v112, v62, v61, 16
    v_alignbit_b32 v113, v63, v62, 16
    ds_write_b128 v238, v[108:111] offset:8336
    ds_write_b128 v238, v[110:113] offset:24976
    s_waitcnt lgkmcnt(6)
    ds_write_b128 v238, v[68:71] offset:30160
    v_mov_b32_dpp v64, v68 wave_shr:1 row_mask:0xf bank_mask:0xf
    v_mov_b32_dpp v65, v69 wave_shr:1 row_mask:0xf bank_mask:0xf
    v_mov_b32_dpp v66, v70 wave_shr:1 row_mask:0xf bank_mask:0xf
    v_mov_b32_dpp v67, v71 wave_shr:1 row_mask:0xf bank_mask:0xf
    v_mov_b32_dpp v72, v68 wave_ror:1 row_mask:0xf bank_mask:0xf
    v_mov_b32_dpp v73, v69 wave_ror:1 row_mask:0xf bank_mask:0xf
    v_mov_b32_dpp v74, v70 wave_ror:1 row_mask:0xf bank_mask:0xf
    v_mov_b32_dpp v75, v71 wave_ror:1 row_mask:0xf bank_mask:0xf
    ds_write_b128 v238, v[66:69] offset:13520
    v_mov_b32 v116, v65
    v_mov_b32 v117, v66
    v_mov_b32 v118, v67
    v_mov_b32 v119, v68
    v_mov_b32 v120, v69
    v_mov_b32 v121, v70
    ds_write_b128 v238, v[116:119] offset:5200
    ds_write_b128 v238, v[118:121] offset:21840
    v_alignbit_b32 v122, v65, v64, 16
    v_alignbit_b32 v123, v66, v65, 16
    v_alignbit_b32 v124, v67, v66, 16
    v_alignbit_b32 v125, v68, v67, 16
    v_alignbit_b32 v126, v69, v68, 16
    v_alignbit_b32 v127, v70, v69, 16
    ds_write_b128 v238, v[122:125] offset:1040
    ds_write_b128 v238, v[124:127] offset:17680
    v_alignbit_b32 v128, v66, v65, 16
    v_alignbit_b32 v129, v67, v66, 16
    v_alignbit_b32 v130, v68, v67, 16
    v_alignbit_b32 v131, v69, v68, 16
    v_alignbit_b32 v132, v70, v69, 16
    v_alignbit_b32 v133, v71, v70, 16
    ds_write_b128 v238, v[128:131] offset:9360
    ds_write_b128 v238, v[130:133] offset:26000
    s_waitcnt lgkmcnt(6)
    s_waitcnt vmcnt(0)
    s_barrier
    s_cmp_lg_u32 s3, 0
    s_cbranch_scc1 L_noflag_11
    s_mov_b64 exec, 1
    buffer_store_dword v19, v20, s[12:15], s63 offen sc1
    s_mov_b64 exec, -1
L_noflag_11:
    ds_write_b128 v238, v[76:79] offset:31184
    v_mov_b32_dpp v72, v76 wave_shr:1 row_mask:0xf bank_mask:0xf
    v_mov_b32_dpp v73, v77 wave_shr:1 row_mask:0xf bank_mask:0xf
    v_mov_b32_dpp v74, v78 wave_shr:1 row_mask:0xf bank_mask:0xf
    v_mov_b32_dpp v75, v79 wave_shr:1 row_mask:0xf bank_mask:0xf
    v_mov_b32_dpp v80, v76 wave_ror:1 row_mask:0xf bank_mask:0xf
    v_mov_b32_dpp v81, v77 wave_ror:1 row_mask:0xf bank_mask:0xf
    v_mov_b32_dpp v82, v78 wave_ror:1 row_mask:0xf bank_mask:0xf
    v_mov_b32_dpp v83, v79 wave_ror:1 row_mask:0xf bank_mask:0xf
    ds_write_b128 v238, v[74:77] offset:14544
    v_mov_b32 v96, v73
    v_mov_b32 v97, v74
    v_mov_b32 v98, v75
    v_mov_b32 v99, v76
    v_mov_b32 v100, v77
    v_mov_b32 v101, v78
    ds_write_b128 v238, v[96:99] offset:6224
    ds_write_b128 v238, v[98:101] offset:22864
    v_alignbit_b32 v102, v73, v72, 16
    v_alignbit_b32 v103, v74, v73, 16
    v_alignbit_b32 v104, v75, v74, 16
    v_alignbit_b32 v105, v76, v75, 16
    v_alignbit_b32 v106, v77, v76, 16
    v_alignbit_b32 v107, v78, v77, 16
    ds_write_b128 v238, v[102:105] offset:2064
    ds_write_b128 v238, v[104:107] offset:18704
    v_alignbit_b32 v108, v74, v73, 16
    v_alignbit_b32 v109, v75, v74, 16
    v_alignbit_b32 v110, v76, v75, 16
    v_alignbit_b32 v111, v77, v76, 16
    v_alignbit_b32 v112, v78, v77, 16
    v_alignbit_b32 v113, v79, v78, 16
    ds_write_b128 v238, v[108:111] offset:10384
    ds_write_b128 v238, v[110:113] offset:27024
    s_waitcnt lgkmcnt(6)
    s_and_b32 s94, s31, 0xf0
    s_lshl_b32 s94, s94, 7
    s_add_u32 s94, s94, 0x17be000
    v_lshlrev_b32 v24, 7, v22
    s_lshl_b32 s54, s28, 11
    v_add_u32 v244, s54, v2
    v_xor_b32 v245, 2048, v244
    v_add_u32 v246, 4096, v2
    v_lshlrev_b32 v247, 3, v13
    buffer_load_dword v18, v24, s[12:15], s94 offen sc1
    ds_write_b128 v238, v[84:87] offset:32208
    v_mov_b32_dpp v80, v84 wave_shr:1 row_mask:0xf bank_mask:0xf
    v_mov_b32_dpp v81, v85 wave_shr:1 row_mask:0xf bank_mask:0xf
    v_mov_b32_dpp v82, v86 wave_shr:1 row_mask:0xf bank_mask:0xf
    v_mov_b32_dpp v83, v87 wave_shr:1 row_mask:0xf bank_mask:0xf
    ds_write_b128 v238, v[82:85] offset:15568
    v_mov_b32 v116, v81
    v_mov_b32 v117, v82
    v_mov_b32 v118, v83
    v_mov_b32 v119, v84
    v_mov_b32 v120, v85
    v_mov_b32 v121, v86
    ds_write_b128 v238, v[116:119] offset:7248
    ds_write_b128 v238, v[118:121] offset:23888
    v_alignbit_b32 v122, v81, v80, 16
    v_alignbit_b32 v123, v82, v81, 16
    v_alignbit_b32 v124, v83, v82, 16
    v_alignbit_b32 v125, v84, v83, 16
    v_alignbit_b32 v126, v85, v84, 16
    v_alignbit_b32 v127, v86, v85, 16
    ds_write_b128 v238, v[122:125] offset:3088
    ds_write_b128 v238, v[124:127] offset:19728
    v_alignbit_b32 v128, v82, v81, 16
    v_alignbit_b32 v129, v83, v82, 16
    v_alignbit_b32 v130, v84, v83, 16
    v_alignbit_b32 v131, v85, v84, 16
    v_alignbit_b32 v132, v86, v85, 16
    v_alignbit_b32 v133, v87, v86, 16
    ds_write_b128 v238, v[128:131] offset:11408
    ds_write_b128 v238, v[130:133] offset:28048
    s_waitcnt lgkmcnt(6)
    s_mul_i32 s51, s27, 3
    s_lshr_b32 s51, s51, 2
    s_lshl_b32 s54, s51, 12
    s_add_u32 s54, s54, 0
    s_add_u32 s64, s32, s54
    s_mul_i32 s54, s51, 10240
    s_add_u32 s54, s54, 0
    s_add_u32 s71, s60, s54
    s_add_u32 s51, s51, 1
    s_cmp_eq_u32 s51, 3
    s_cselect_b32 s51, 0, s51
    s_lshl_b32 s54, s51, 12
    s_add_u32 s54, s54, 0
    s_add_u32 s65, s32, s54
    s_mul_i32 s54, s51, 10240
    s_add_u32 s54, s54, 0
    s_add_u32 s72, s60, s54
    s_add_u32 s51, s51, 1
    s_cmp_eq_u32 s51, 3
    s_cselect_b32 s51, 0, s51
    s_lshl_b32 s54, s51, 12
    s_add_u32 s54, s54, 0
    s_add_u32 s66, s32, s54
    s_mul_i32 s54, s51, 10240
    s_add_u32 s54, s54, 0
    s_add_u32 s73, s60, s54
    s_add_u32 s51, s51, 1
    s_cmp_eq_u32 s51, 3
    s_cselect_b32 s51, 0, s51
    s_mul_i32 s51, s27, 4
    s_lshr_b32 s51, s51, 2
    s_lshl_b32 s54, s51, 12
    s_add_u32 s54, s54, 12288
    s_add_u32 s67, s32, s54
    s_mul_i32 s54, s51, 10240
    s_add_u32 s54, s54, 30720
    s_add_u32 s74, s60, s54
    s_add_u32 s51, s51, 1
    s_cmp_eq_u32 s51, 4
    s_cselect_b32 s51, 0, s51
    s_lshl_b32 s54, s51, 12
    s_add_u32 s54, s54, 12288
    s_add_u32 s68, s32, s54
    s_mul_i32 s54, s51, 10240
    s_add_u32 s54, s54, 30720
    s_add_u32 s75, s60, s54
    s_add_u32 s51, s51, 1
    s_cmp_eq_u32 s51, 4
    s_cselect_b32 s51, 0, s51
    s_lshl_b32 s54, s51, 12
    s_add_u32 s54, s54, 12288
    s_add_u32 s69, s32, s54
    s_mul_i32 s54, s51, 10240
    s_add_u32 s54, s54, 30720
    s_add_u32 s76, s60, s54
    s_add_u32 s51, s51, 1
    s_cmp_eq_u32 s51, 4
    s_cselect_b32 s51, 0, s51
    s_lshl_b32 s54, s51, 12
    s_add_u32 s54, s54, 12288
    s_add_u32 s70, s32, s54
    s_mul_i32 s54, s51, 10240
    s_add_u32 s54, s54, 30720
    s_add_u32 s77, s60, s54
    s_add_u32 s51, s51, 1
    s_cmp_eq_u32 s51, 4
    s_cselect_b32 s51, 0, s51
    s_mul_i32 s51, s25, 7
    s_add_u32 s54, s51, 6
    s_lshr_b32 s51, s51, 3
    s_lshr_b32 s54, s54, 3
    s_sub_u32 s54, s54, s51
    v_and_b32 v54, 1, v0
    v_mul_u32_u24 v54, s54, v54
    v_lshlrev_b32 v54, 2, v54
    s_lshl_b32 s51, s51, 2
    s_add_u32 s51, s51, s3
    v_lshlrev_b32 v54, 7, v54
    s_lshl_b32 s43, s51, 7
    s_add_u32 s43, s43, 0x17ba000
    v_sub_u32 v25, 15, v22
    v_and_b32 v26, 1, v25
    v_lshlrev_b32 v26, 4, v26
    v_lshlrev_b32 v52, v26, v52
    v_lshrrev_b32 v25, 1, v25
    v_lshlrev_b32 v26, 2, v21
    v_sub_u32 v25, v25, v26
    v_cmp_eq_u32 vcc, 0, v25
    s_nop 1
    v_cndmask_b32 v216, 0, v52, vcc
    v_cmp_eq_u32 vcc, 1, v25
    s_nop 1
    v_cndmask_b32 v217, 0, v52, vcc
    v_cmp_eq_u32 vcc, 2, v25
    s_nop 1
    v_cndmask_b32 v218, 0, v52, vcc
    v_cmp_eq_u32 vcc, 3, v25
    s_nop 1
    v_cndmask_b32 v219, 0, v52, vcc
    s_waitcnt vmcnt(0)
L_chk_12:
    v_cmp_ne_u32 vcc, v19, v18
    s_cbranch_vccz L_ok_13
    s_cmp_eq_u32 s50, 0
    s_cbranch_scc1 L_ok_13
    s_sub_u32 s50, s50, 1
    s_sleep 1
    s_mov_b64 exec, vcc
    buffer_load_dword v18, v24, s[12:15], s94 offen sc1
    s_mov_b64 exec, -1
    s_waitcnt vmcnt(0)
    s_branch L_chk_12
L_ok_13:
    s_add_u32 m0, s92, 33280
    s_add_u32 s94, s93, 0
    buffer_load_dwordx4 v2, s[12:15], s94 offen offset:0 sc1 lds
    buffer_load_dwordx4 v2, s[12:15], s94 offen offset:1024 sc1 lds
    buffer_load_dwordx4 v2, s[12:15], s94 offen offset:2048 sc1 lds
    buffer_load_dwordx4 v2, s[12:15], s94 offen offset:3072 sc1 lds
    s_waitcnt lgkmcnt(0)
    ds_read_b128 v[56:59], v236 offset:0
    ds_read_b128 v[60:63], v236 offset:512
    ds_read_b128 v[64:67], v236 offset:1024
    ds_read_b128 v[68:71], v236 offset:1536
    ds_read_b128 v[72:75], v236 offset:64
    ds_read_b128 v[76:79], v236 offset:576
    ds_read_b128 v[80:83], v236 offset:1088
    ds_read_b128 v[84:87], v236 offset:1600
    s_waitcnt vmcnt(0)
    ds_read_b128 v[88:91], v237 offset:3584
    ds_read_b128 v[92:95], v237 offset:3072
    ds_read_b128 v[96:99], v237 offset:2560
    ds_read_b128 v[100:103], v237 offset:2048
    ds_read_b128 v[104:107], v237 offset:3648
    ds_read_b128 v[108:111], v237 offset:3136
    ds_read_b128 v[112:115], v237 offset:2624
    s_waitcnt lgkmcnt(11)
    ds_read_b128 v[116:119], v237 offset:2112
    s_waitcnt lgkmcnt(7)
    v_mfma_f32_16x16x32_bf16 v[184:187], v[216:219], v[88:91], 0
    ds_read_b128 v[152:155], v237 offset:3712
    s_waitcnt lgkmcnt(7)
    v_mfma_f32_16x16x32_bf16 v[188:191], v[216:219], v[92:95], 0
    ds_read_b128 v[120:123], v236 offset:128
    s_waitcnt lgkmcnt(7)
    v_mfma_f32_16x16x32_bf16 v[192:195], v[216:219], v[96:99], 0
    ds_read_b128 v[156:159], v237 offset:3200
    s_waitcnt lgkmcnt(7)
    v_mfma_f32_16x16x32_bf16 v[196:199], v[216:219], v[100:103], 0
    ds_read_b128 v[124:127], v236 offset:640
    v_mfma_f32_16x16x32_bf16 v[184:187], v[56:59], v[88:91], v[184:187]
    ds_read_b128 v[160:163], v237 offset:2688
    v_mfma_f32_16x16x32_bf16 v[188:191], v[56:59], v[92:95], v[188:191]
    ds_read_b128 v[128:131], v236 offset:1152
    v_mfma_f32_16x16x32_bf16 v[188:191], v[60:63], v[88:91], v[188:191]
    ds_read_b128 v[164:167], v237 offset:2176
    v_mfma_f32_16x16x32_bf16 v[192:195], v[56:59], v[96:99], v[192:195]
    ds_read_b128 v[132:135], v236 offset:1664
    v_mfma_f32_16x16x32_bf16 v[192:195], v[60:63], v[92:95], v[192:195]
    ds_read_b128 v[168:171], v237 offset:3776
    v_mfma_f32_16x16x32_bf16 v[192:195], v[64:67], v[88:91], v[192:195]
    ds_read_b128 v[136:139], v236 offset:192
    v_mfma_f32_16x16x32_bf16 v[196:199], v[56:59], v[100:103], v[196:199]
    ds_read_b128 v[172:175], v237 offset:3264
    v_mfma_f32_16x16x32_bf16 v[196:199], v[60:63], v[96:99], v[196:199]
    s_waitcnt lgkmcnt(11)
    ds_read_b128 v[140:143], v236 offset:704
    v_mfma_f32_16x16x32_bf16 v[196:199], v[64:67], v[92:95], v[196:199]
    ds_read_b128 v[176:179], v237 offset:2752
    v_mfma_f32_16x16x32_bf16 v[196:199], v[68:71], v[88:91], v[196:199]
    ds_read_b128 v[144:147], v236 offset:1216
    v_mfma_f32_16x16x32_bf16 v[184:187], v[72:75], v[104:107], v[184:187]
    ds_read_b128 v[180:183], v237 offset:2240
    v_mfma_f32_16x16x32_bf16 v[188:191], v[72:75], v[108:111], v[188:191]
    s_waitcnt lgkmcnt(11)
    ds_read_b128 v[148:151], v236 offset:1728
    v_mfma_f32_16x16x32_bf16 v[188:191], v[76:79], v[104:107], v[188:191]
    v_mfma_f32_16x16x32_bf16 v[192:195], v[72:75], v[112:115], v[192:195]
    v_mfma_f32_16x16x32_bf16 v[192:195], v[76:79], v[108:111], v[192:195]
    v_mfma_f32_16x16x32_bf16 v[192:195], v[80:83], v[104:107], v[192:195]
    v_mfma_f32_16x16x32_bf16 v[196:199], v[72:75], v[116:119], v[196:199]
    v_mfma_f32_16x16x32_bf16 v[196:199], v[76:79], v[112:115], v[196:199]
    v_mfma_f32_16x16x32_bf16 v[196:199], v[80:83], v[108:111], v[196:199]
    v_mfma_f32_16x16x32_bf16 v[196:199], v[84:87], v[104:107], v[196:199]
    v_mfma_f32_16x16x32_bf16 v[184:187], v[120:123], v[152:155], v[184:187]
    ds_read_b128 v[88:91], v237 offset:3840
    v_mfma_f32_16x16x32_bf16 v[188:191], v[120:123], v[156:159], v[188:191]
    ds_read_b128 v[56:59], v236 offset:256
    v_mfma_f32_16x16x32_bf16 v[188:191], v[124:127], v[152:155], v[188:191]
    ds_read_b128 v[92:95], v237 offset:3328
    s_waitcnt lgkmcnt(14)
    v_mfma_f32_16x16x32_bf16 v[192:195], v[120:123], v[160:163], v[192:195]
    ds_read_b128 v[60:63], v236 offset:768
    v_mfma_f32_16x16x32_bf16 v[192:195], v[124:127], v[156:159], v[192:195]
    s_waitcnt lgkmcnt(11)
    ds_read_b128 v[96:99], v237 offset:2816
    v_mfma_f32_16x16x32_bf16 v[192:195], v[128:131], v[152:155], v[192:195]
    ds_read_b128 v[64:67], v236 offset:1280
    v_mfma_f32_16x16x32_bf16 v[196:199], v[120:123], v[164:167], v[196:199]
    ds_read_b128 v[100:103], v237 offset:2304
    v_mfma_f32_16x16x32_bf16 v[196:199], v[124:127], v[160:163], v[196:199]
    ds_read_b128 v[68:71], v236 offset:1792
    v_mfma_f32_16x16x32_bf16 v[196:199], v[128:131], v[156:159], v[196:199]
    s_waitcnt lgkmcnt(11)
    ds_read_b128 v[104:107], v237 offset:3904
    v_mfma_f32_16x16x32_bf16 v[196:199], v[132:135], v[152:155], v[196:199]
    ds_read_b128 v[72:75], v236 offset:320
    v_mfma_f32_16x16x32_bf16 v[184:187], v[136:139], v[168:171], v[184:187]
    ds_read_b128 v[108:111], v237 offset:3392
    v_mfma_f32_16x16x32_bf16 v[188:191], v[136:139], v[172:175], v[188:191]
    ds_read_b128 v[76:79], v236 offset:832
    v_mfma_f32_16x16x32_bf16 v[188:191], v[140:143], v[168:171], v[188:191]
    s_waitcnt lgkmcnt(11)
    ds_read_b128 v[112:115], v237 offset:2880
    v_mfma_f32_16x16x32_bf16 v[192:195], v[136:139], v[176:179], v[192:195]
    ds_read_b128 v[80:83], v236 offset:1344
    v_mfma_f32_16x16x32_bf16 v[192:195], v[140:143], v[172:175], v[192:195]
    ds_read_b128 v[116:119], v237 offset:2368
    v_mfma_f32_16x16x32_bf16 v[192:195], v[144:147], v[168:171], v[192:195]
    ds_read_b128 v[84:87], v236 offset:1856
    v_mfma_f32_16x16x32_bf16 v[196:199], v[136:139], v[180:183], v[196:199]
    v_mfma_f32_16x16x32_bf16 v[196:199], v[140:143], v[176:179], v[196:199]
    v_mfma_f32_16x16x32_bf16 v[196:199], v[144:147], v[172:175], v[196:199]
    v_mfma_f32_16x16x32_bf16 v[196:199], v[148:151], v[168:171], v[196:199]
    s_waitcnt lgkmcnt(14)
    v_mfma_f32_16x16x32_bf16 v[184:187], v[56:59], v[88:91], v[184:187]
    ds_read_b128 v[152:155], v237 offset:3968
    s_waitcnt lgkmcnt(14)
    v_mfma_f32_16x16x32_bf16 v[188:191], v[56:59], v[92:95], v[188:191]
    ds_read_b128 v[120:123], v236 offset:384
    s_waitcnt lgkmcnt(14)
    v_mfma_f32_16x16x32_bf16 v[188:191], v[60:63], v[88:91], v[188:191]
    ds_read_b128 v[156:159], v237 offset:3456
    s_waitcnt lgkmcnt(14)
    v_mfma_f32_16x16x32_bf16 v[192:195], v[56:59], v[96:99], v[192:195]
    ds_read_b128 v[124:127], v236 offset:896
    v_mfma_f32_16x16x32_bf16 v[192:195], v[60:63], v[92:95], v[192:195]
    s_waitcnt lgkmcnt(11)
    ds_read_b128 v[160:163], v237 offset:2944
    v_mfma_f32_16x16x32_bf16 v[192:195], v[64:67], v[88:91], v[192:195]
    ds_read_b128 v[128:131], v236 offset:1408
    v_mfma_f32_16x16x32_bf16 v[196:199], v[56:59], v[100:103], v[196:199]
    ds_read_b128 v[164:167], v237 offset:2432
    v_mfma_f32_16x16x32_bf16 v[196:199], v[60:63], v[96:99], v[196:199]
    ds_read_b128 v[132:135], v236 offset:1920
    v_mfma_f32_16x16x32_bf16 v[196:199], v[64:67], v[92:95], v[196:199]
    s_waitcnt lgkmcnt(11)
    ds_read_b128 v[168:171], v237 offset:4032
    v_mfma_f32_16x16x32_bf16 v[196:199], v[68:71], v[88:91], v[196:199]
    ds_read_b128 v[136:139], v236 offset:448
    v_mfma_f32_16x16x32_bf16 v[184:187], v[72:75], v[104:107], v[184:187]
    ds_read_b128 v[172:175], v237 offset:3520
    v_mfma_f32_16x16x32_bf16 v[188:191], v[72:75], v[108:111], v[188:191]
    ds_read_b128 v[140:143], v236 offset:960
    v_mfma_f32_16x16x32_bf16 v[188:191], v[76:79], v[104:107], v[188:191]
    s_waitcnt lgkmcnt(11)
    ds_read_b128 v[176:179], v237 offset:3008
    v_mfma_f32_16x16x32_bf16 v[192:195], v[72:75], v[112:115], v[192:195]
    ds_read_b128 v[144:147], v236 offset:1472
    v_mfma_f32_16x16x32_bf16 v[192:195], v[76:79], v[108:111], v[192:195]
    ds_read_b128 v[180:183], v237 offset:2496
    v_mfma_f32_16x16x32_bf16 v[192:195], v[80:83], v[104:107], v[192:195]
    ds_read_b128 v[148:151], v236 offset:1984
    v_mfma_f32_16x16x32_bf16 v[196:199], v[72:75], v[116:119], v[196:199]
    v_mfma_f32_16x16x32_bf16 v[196:199], v[76:79], v[112:115], v[196:199]
    v_mfma_f32_16x16x32_bf16 v[196:199], v[80:83], v[108:111], v[196:199]
    v_mfma_f32_16x16x32_bf16 v[196:199], v[84:87], v[104:107], v[196:199]
    s_waitcnt lgkmcnt(14)
    v_mfma_f32_16x16x32_bf16 v[184:187], v[120:123], v[152:155], v[184:187]
    ds_read_b128 v[88:91], v237 offset:3584
    s_waitcnt lgkmcnt(14)
    v_mfma_f32_16x16x32_bf16 v[188:191], v[120:123], v[156:159], v[188:191]
    ds_read_b128 v[56:59], v236 offset:0
    s_waitcnt lgkmcnt(14)
    v_mfma_f32_16x16x32_bf16 v[188:191], v[124:127], v[152:155], v[188:191]
    ds_read_b128 v[92:95], v237 offset:3072
    s_waitcnt lgkmcnt(14)
    v_mfma_f32_16x16x32_bf16 v[192:195], v[120:123], v[160:163], v[192:195]
    ds_read_b128 v[60:63], v236 offset:512
    v_mfma_f32_16x16x32_bf16 v[192:195], v[124:127], v[156:159], v[192:195]
    s_waitcnt lgkmcnt(11)
    ds_read_b128 v[96:99], v237 offset:2560
    v_mfma_f32_16x16x32_bf16 v[192:195], v[128:131], v[152:155], v[192:195]
    ds_read_b128 v[64:67], v236 offset:1024
    v_mfma_f32_16x16x32_bf16 v[196:199], v[120:123], v[164:167], v[196:199]
    ds_read_b128 v[100:103], v237 offset:2048
    v_mfma_f32_16x16x32_bf16 v[196:199], v[124:127], v[160:163], v[196:199]
    ds_read_b128 v[68:71], v236 offset:1536
    v_mfma_f32_16x16x32_bf16 v[196:199], v[128:131], v[156:159], v[196:199]
    s_waitcnt lgkmcnt(11)
    ds_read_b128 v[104:107], v237 offset:1536
    v_mfma_f32_16x16x32_bf16 v[196:199], v[132:135], v[152:155], v[196:199]
    ds_read_b128 v[72:75], v236 offset:2048
    v_mfma_f32_16x16x32_bf16 v[184:187], v[136:139], v[168:171], v[184:187]
    ds_read_b128 v[108:111], v237 offset:1024
    v_mfma_f32_16x16x32_bf16 v[188:191], v[136:139], v[172:175], v[188:191]
    ds_read_b128 v[76:79], v236 offset:2560
    v_mfma_f32_16x16x32_bf16 v[188:191], v[140:143], v[168:171], v[188:191]
    s_waitcnt lgkmcnt(11)
    ds_read_b128 v[112:115], v237 offset:512
    v_mfma_f32_16x16x32_bf16 v[192:195], v[136:139], v[176:179], v[192:195]
    ds_read_b128 v[80:83], v236 offset:3072
    v_mfma_f32_16x16x32_bf16 v[192:195], v[140:143], v[172:175], v[192:195]
    ds_read_b128 v[116:119], v237 offset:0
    v_mfma_f32_16x16x32_bf16 v[192:195], v[144:147], v[168:171], v[192:195]
    ds_read_b128 v[84:87], v236 offset:3584
    v_mfma_f32_16x16x32_bf16 v[196:199], v[136:139], v[180:183], v[196:199]
    v_mfma_f32_16x16x32_bf16 v[196:199], v[140:143], v[176:179], v[196:199]
    v_mfma_f32_16x16x32_bf16 v[196:199], v[144:147], v[172:175], v[196:199]
    v_mfma_f32_16x16x32_bf16 v[196:199], v[148:151], v[168:171], v[196:199]
    s_waitcnt lgkmcnt(7)
    v_mfma_f32_16x16x32_bf16 v[200:203], v[216:219], v[104:107], 0
    ds_read_b128 v[152:155], v237 offset:3648
    v_mfma_f32_16x16x32_bf16 v[200:203], v[56:59], v[104:107], v[200:203]
    ds_read_b128 v[120:123], v236 offset:64
    v_mfma_f32_16x16x32_bf16 v[200:203], v[60:63], v[100:103], v[200:203]
    ds_read_b128 v[156:159], v237 offset:3136
    v_mfma_f32_16x16x32_bf16 v[200:203], v[64:67], v[96:99], v[200:203]
    ds_read_b128 v[124:127], v236 offset:576
    v_mfma_f32_16x16x32_bf16 v[200:203], v[68:71], v[92:95], v[200:203]
    ds_read_b128 v[160:163], v237 offset:2624
    s_waitcnt lgkmcnt(11)
    v_mfma_f32_16x16x32_bf16 v[200:203], v[72:75], v[88:91], v[200:203]
    ds_read_b128 v[128:131], v236 offset:1088
    s_waitcnt lgkmcnt(11)
    v_mfma_f32_16x16x32_bf16 v[204:207], v[216:219], v[108:111], 0
    ds_read_b128 v[164:167], v237 offset:2112
    v_mfma_f32_16x16x32_bf16 v[204:207], v[56:59], v[108:111], v[204:207]
    ds_read_b128 v[132:135], v236 offset:1600
    v_mfma_f32_16x16x32_bf16 v[204:207], v[60:63], v[104:107], v[204:207]
    ds_read_b128 v[168:171], v237 offset:1600
    v_mfma_f32_16x16x32_bf16 v[204:207], v[64:67], v[100:103], v[204:207]
    ds_read_b128 v[136:139], v236 offset:2112
    v_mfma_f32_16x16x32_bf16 v[204:207], v[68:71], v[96:99], v[204:207]
    v_cvt_pk_bf16_f32 v184, v184, v185
    v_cvt_pk_bf16_f32 v185, v186, v187
    s_waitcnt lgkmcnt(11)
    ds_write_b64 v239, v[184:185] offset:0
    v_mfma_f32_16x16x32_bf16 v[204:207], v[72:75], v[92:95], v[204:207]
    ds_read_b128 v[172:175], v237 offset:1088
    v_mfma_f32_16x16x32_bf16 v[204:207], v[76:79], v[88:91], v[204:207]
    ds_read_b128 v[140:143], v236 offset:2624
    v_mfma_f32_16x16x32_bf16 v[208:211], v[216:219], v[112:115], 0
    ds_read_b128 v[176:179], v237 offset:576
    v_mfma_f32_16x16x32_bf16 v[208:211], v[56:59], v[112:115], v[208:211]
    v_cvt_pk_bf16_f32 v188, v188, v189
    v_cvt_pk_bf16_f32 v189, v190, v191
    s_waitcnt lgkmcnt(11)
    ds_write_b64 v239, v[188:189] offset:512
    v_mfma_f32_16x16x32_bf16 v[208:211], v[60:63], v[108:111], v[208:211]
    ds_read_b128 v[144:147], v236 offset:3136
    v_mfma_f32_16x16x32_bf16 v[208:211], v[64:67], v[104:107], v[208:211]
    ds_read_b128 v[180:183], v237 offset:64
    v_mfma_f32_16x16x32_bf16 v[208:211], v[68:71], v[100:103], v[208:211]
    ds_read_b128 v[148:151], v236 offset:3648
    v_mfma_f32_16x16x32_bf16 v[208:211], v[72:75], v[96:99], v[208:211]
    v_cvt_pk_bf16_f32 v192, v192, v193
    v_cvt_pk_bf16_f32 v193, v194, v195
    s_waitcnt lgkmcnt(11)
    ds_write_b64 v239, v[192:193] offset:1024
    v_mfma_f32_16x16x32_bf16 v[208:211], v[76:79], v[92:95], v[208:211]
    v_mfma_f32_16x16x32_bf16 v[208:211], v[80:83], v[88:91], v[208:211]
    v_mfma_f32_16x16x32_bf16 v[212:215], v[216:219], v[116:119], 0
    v_mfma_f32_16x16x32_bf16 v[212:215], v[56:59], v[116:119], v[212:215]
    v_cvt_pk_bf16_f32 v196, v196, v197
    v_cvt_pk_bf16_f32 v197, v198, v199
    ds_write_b64 v239, v[196:197] offset:1536
    v_mfma_f32_16x16x32_bf16 v[212:215], v[60:63], v[112:115], v[212:215]
    v_mfma_f32_16x16x32_bf16 v[212:215], v[64:67], v[108:111], v[212:215]
    v_mfma_f32_16x16x32_bf16 v[212:215], v[68:71], v[104:107], v[212:215]
    v_mfma_f32_16x16x32_bf16 v[212:215], v[72:75], v[100:103], v[212:215]
    v_mfma_f32_16x16x32_bf16 v[212:215], v[76:79], v[96:99], v[212:215]
    v_mfma_f32_16x16x32_bf16 v[212:215], v[80:83], v[92:95], v[212:215]
    v_mfma_f32_16x16x32_bf16 v[212:215], v[84:87], v[88:91], v[212:215]
    s_waitcnt lgkmcnt(11)
    v_mfma_f32_16x16x32_bf16 v[200:203], v[120:123], v[168:171], v[200:203]
    ds_read_b128 v[88:91], v237 offset:3712
    v_mfma_f32_16x16x32_bf16 v[200:203], v[124:127], v[164:167], v[200:203]
    ds_read_b128 v[56:59], v236 offset:128
    v_mfma_f32_16x16x32_bf16 v[200:203], v[128:131], v[160:163], v[200:203]
    ds_read_b128 v[92:95], v237 offset:3200
    v_mfma_f32_16x16x32_bf16 v[200:203], v[132:135], v[156:159], v[200:203]
    ds_read_b128 v[60:63], v236 offset:640
    s_waitcnt lgkmcnt(14)
    v_mfma_f32_16x16x32_bf16 v[200:203], v[136:139], v[152:155], v[200:203]
    ds_read_b128 v[96:99], v237 offset:2688
    s_waitcnt lgkmcnt(13)
    v_mfma_f32_16x16x32_bf16 v[204:207], v[120:123], v[172:175], v[204:207]
    ds_read_b128 v[64:67], v236 offset:1152
    v_mfma_f32_16x16x32_bf16 v[204:207], v[124:127], v[168:171], v[204:207]
    ds_read_b128 v[100:103], v237 offset:2176
    v_mfma_f32_16x16x32_bf16 v[204:207], v[128:131], v[164:167], v[204:207]
    s_waitcnt lgkmcnt(11)
    ds_read_b128 v[68:71], v236 offset:1664
    v_mfma_f32_16x16x32_bf16 v[204:207], v[132:135], v[160:163], v[204:207]
    s_waitcnt lgkmcnt(8)
    s_barrier
    v_mfma_f32_16x16x32_bf16 v[204:207], v[136:139], v[156:159], v[204:207]
    ds_read_b128 v[104:107], v237 offset:1664
    v_mfma_f32_16x16x32_bf16 v[204:207], v[140:143], v[152:155], v[204:207]
    ds_read_b128 v[72:75], v236 offset:2176
    v_mfma_f32_16x16x32_bf16 v[208:211], v[120:123], v[176:179], v[208:211]
    ds_read_b128 v[108:111], v237 offset:1152
    v_mfma_f32_16x16x32_bf16 v[208:211], v[124:127], v[172:175], v[208:211]
    ds_read_b128 v[76:79], v236 offset:2688
    v_mfma_f32_16x16x32_bf16 v[208:211], v[128:131], v[168:171], v[208:211]
    ds_read_b128 v[112:115], v237 offset:640
    v_mfma_f32_16x16x32_bf16 v[208:211], v[132:135], v[164:167], v[208:211]
    ds_read_b128 v[80:83], v236 offset:3200
    v_mfma_f32_16x16x32_bf16 v[208:211], v[136:139], v[160:163], v[208:211]
    ds_read_b128 v[116:119], v237 offset:128
    v_mfma_f32_16x16x32_bf16 v[208:211], v[140:143], v[156:159], v[208:211]
    s_waitcnt lgkmcnt(11)
    ds_read_b128 v[84:87], v236 offset:3712
    v_mfma_f32_16x16x32_bf16 v[208:211], v[144:147], v[152:155], v[208:211]
    ds_read_b64_tr_b16 v[184:185], v240 offset:0
    v_mfma_f32_16x16x32_bf16 v[212:215], v[120:123], v[180:183], v[212:215]
    ds_read_b64_tr_b16 v[186:187], v240 offset:128
    v_mfma_f32_16x16x32_bf16 v[212:215], v[124:127], v[176:179], v[212:215]
    ds_read_b64_tr_b16 v[188:189], v240 offset:256
    v_mfma_f32_16x16x32_bf16 v[212:215], v[128:131], v[172:175], v[212:215]
    s_waitcnt lgkmcnt(11)
    ds_read_b64_tr_b16 v[190:191], v240 offset:384
    v_mfma_f32_16x16x32_bf16 v[212:215], v[132:135], v[168:171], v[212:215]
    v_mfma_f32_16x16x32_bf16 v[212:215], v[136:139], v[164:167], v[212:215]
    v_mfma_f32_16x16x32_bf16 v[212:215], v[140:143], v[160:163], v[212:215]
    v_mfma_f32_16x16x32_bf16 v[212:215], v[144:147], v[156:159], v[212:215]
    v_mfma_f32_16x16x32_bf16 v[212:215], v[148:151], v[152:155], v[212:215]
    s_waitcnt lgkmcnt(11)
    v_mfma_f32_16x16x32_bf16 v[200:203], v[56:59], v[104:107], v[200:203]
    ds_read_b128 v[152:155], v237 offset:3776
    v_mfma_f32_16x16x32_bf16 v[200:203], v[60:63], v[100:103], v[200:203]
    ds_read_b128 v[120:123], v236 offset:192
    v_mfma_f32_16x16x32_bf16 v[200:203], v[64:67], v[96:99], v[200:203]
    ds_read_b128 v[156:159], v237 offset:3264
    v_mfma_f32_16x16x32_bf16 v[200:203], v[68:71], v[92:95], v[200:203]
    ds_read_b128 v[124:127], v236 offset:704
    s_waitcnt lgkmcnt(14)
    v_mfma_f32_16x16x32_bf16 v[200:203], v[72:75], v[88:91], v[200:203]
    s_waitcnt lgkmcnt(7)
    buffer_store_dwordx2 v[184:185], v241, s[12:15], s95 offen sc1
    s_add_u32 s95, s95, 81920
    v_mfma_f32_16x16x32_bf16 v[204:207], v[56:59], v[108:111], v[204:207]
    ds_read_b128 v[160:163], v237 offset:2752
    v_mfma_f32_16x16x32_bf16 v[204:207], v[60:63], v[104:107], v[204:207]
    ds_read_b128 v[128:131], v236 offset:1216
    v_mfma_f32_16x16x32_bf16 v[204:207], v[64:67], v[100:103], v[204:207]
    ds_read_b128 v[164:167], v237 offset:2240
    v_mfma_f32_16x16x32_bf16 v[204:207], v[68:71], v[96:99], v[204:207]
    ds_read_b128 v[132:135], v236 offset:1728
    v_mfma_f32_16x16x32_bf16 v[204:207], v[72:75], v[92:95], v[204:207]
    s_waitcnt lgkmcnt(10)
    buffer_store_dwordx2 v[186:187], v241, s[12:15], s95 offen sc1
    s_add_u32 s95, s95, 81920
    v_mfma_f32_16x16x32_bf16 v[204:207], v[76:79], v[88:91], v[204:207]
    ds_read_b128 v[168:171], v237 offset:1728
    v_mfma_f32_16x16x32_bf16 v[208:211], v[56:59], v[112:115], v[208:211]
    ds_read_b128 v[136:139], v236 offset:2240
    v_mfma_f32_16x16x32_bf16 v[208:211], v[60:63], v[108:111], v[208:211]
    ds_read_b128 v[172:175], v237 offset:1216
    v_mfma_f32_16x16x32_bf16 v[208:211], v[64:67], v[104:107], v[208:211]
    ds_read_b128 v[140:143], v236 offset:2752
    v_mfma_f32_16x16x32_bf16 v[208:211], v[68:71], v[100:103], v[208:211]
    s_waitcnt lgkmcnt(13)
    buffer_store_dwordx2 v[188:189], v241, s[12:15], s95 offen sc1
    s_add_u32 s95, s95, 81920
    v_mfma_f32_16x16x32_bf16 v[208:211], v[72:75], v[96:99], v[208:211]
    ds_read_b128 v[176:179], v237 offset:704
    v_mfma_f32_16x16x32_bf16 v[208:211], v[76:79], v[92:95], v[208:211]
    ds_read_b128 v[144:147], v236 offset:3264
    v_mfma_f32_16x16x32_bf16 v[208:211], v[80:83], v[88:91], v[208:211]
    s_waitcnt lgkmcnt(11)
    ds_read_b128 v[180:183], v237 offset:192
    v_mfma_f32_16x16x32_bf16 v[212:215], v[56:59], v[116:119], v[212:215]
    ds_read_b128 v[148:151], v236 offset:3776
    v_mfma_f32_16x16x32_bf16 v[212:215], v[60:63], v[112:115], v[212:215]
    buffer_store_dwordx2 v[190:191], v241, s[12:15], s95 offen sc1
    s_add_u32 s95, s95, 1064960
    v_mfma_f32_16x16x32_bf16 v[212:215], v[64:67], v[108:111], v[212:215]
    v_mfma_f32_16x16x32_bf16 v[212:215], v[68:71], v[104:107], v[212:215]
    v_mfma_f32_16x16x32_bf16 v[212:215], v[72:75], v[100:103], v[212:215]
    v_mfma_f32_16x16x32_bf16 v[212:215], v[76:79], v[96:99], v[212:215]
    v_mfma_f32_16x16x32_bf16 v[212:215], v[80:83], v[92:95], v[212:215]
    v_mfma_f32_16x16x32_bf16 v[212:215], v[84:87], v[88:91], v[212:215]
    s_waitcnt lgkmcnt(7)
    v_mfma_f32_16x16x32_bf16 v[200:203], v[120:123], v[168:171], v[200:203]
    ds_read_b128 v[88:91], v237 offset:3840
    v_mfma_f32_16x16x32_bf16 v[200:203], v[124:127], v[164:167], v[200:203]
    ds_read_b128 v[56:59], v236 offset:256
    v_mfma_f32_16x16x32_bf16 v[200:203], v[128:131], v[160:163], v[200:203]
    buffer_load_dwordx4 v[32:35], v252, s[16:19], s62 offen offset:0
    buffer_load_dwordx4 v[36:39], v252, s[16:19], s62 offen offset:256
    buffer_load_dwordx4 v[40:43], v252, s[16:19], s62 offen offset:512
    buffer_load_dwordx4 v[44:47], v252, s[16:19], s62 offen offset:768
    buffer_load_dwordx4 v[48:51], v252, s[16:19], s62 offen offset:1024
    v_mov_b32 v30, -1
    v_mov_b32 v31, -1
    s_add_u32 s55, s49, 0x1590000
    buffer_store_dwordx2 v[30:31], v14, s[12:15], s55 offen sc1
    s_add_u32 s55, s49, 0x280000
    buffer_store_dwordx2 v[30:31], v14, s[12:15], s55 offen sc1
    s_add_u32 s55, s49, 0x1610000
    buffer_store_dwordx2 v[30:31], v14, s[12:15], s55 offen sc1
    s_add_u32 s55, s49, 0x300000
    buffer_store_dwordx2 v[30:31], v14, s[12:15], s55 offen sc1
    v_mfma_f32_16x16x32_bf16 v[200:203], v[132:135], v[156:159], v[200:203]
    ds_read_b128 v[92:95], v237 offset:3328
    s_waitcnt lgkmcnt(9)
    v_mfma_f32_16x16x32_bf16 v[200:203], v[136:139], v[152:155], v[200:203]
    ds_read_b128 v[60:63], v236 offset:768
    s_waitcnt lgkmcnt(9)
    v_mfma_f32_16x16x32_bf16 v[204:207], v[120:123], v[172:175], v[204:207]
    ds_read_b128 v[96:99], v237 offset:2816
    v_mfma_f32_16x16x32_bf16 v[204:207], v[124:127], v[168:171], v[204:207]
    ds_read_b128 v[64:67], v236 offset:1280
    v_mfma_f32_16x16x32_bf16 v[204:207], v[128:131], v[164:167], v[204:207]
    ds_read_b128 v[100:103], v237 offset:2304
    v_mfma_f32_16x16x32_bf16 v[204:207], v[132:135], v[160:163], v[204:207]
    ds_read_b128 v[68:71], v236 offset:1792
    v_mfma_f32_16x16x32_bf16 v[204:207], v[136:139], v[156:159], v[204:207]
    ds_read_b128 v[104:107], v237 offset:1792
    s_waitcnt lgkmcnt(13)
    v_mfma_f32_16x16x32_bf16 v[204:207], v[140:143], v[152:155], v[204:207]
    ds_read_b128 v[72:75], v236 offset:2304
    s_waitcnt lgkmcnt(13)
    v_mfma_f32_16x16x32_bf16 v[208:211], v[120:123], v[176:179], v[208:211]
    ds_read_b128 v[108:111], v237 offset:1280
    v_mfma_f32_16x16x32_bf16 v[208:211], v[124:127], v[172:175], v[208:211]
    ds_read_b128 v[76:79], v236 offset:2816
    v_mfma_f32_16x16x32_bf16 v[208:211], v[128:131], v[168:171], v[208:211]
    s_waitcnt lgkmcnt(11)
    ds_read_b128 v[112:115], v237 offset:768
    v_mfma_f32_16x16x32_bf16 v[208:211], v[132:135], v[164:167], v[208:211]
    ds_read_b128 v[80:83], v236 offset:3328
    v_mfma_f32_16x16x32_bf16 v[208:211], v[136:139], v[160:163], v[208:211]
    ds_read_b128 v[116:119], v237 offset:256
    v_mfma_f32_16x16x32_bf16 v[208:211], v[140:143], v[156:159], v[208:211]
    ds_read_b128 v[84:87], v236 offset:3840
    v_mfma_f32_16x16x32_bf16 v[208:211], v[144:147], v[152:155], v[208:211]
    v_mfma_f32_16x16x32_bf16 v[212:215], v[120:123], v[180:183], v[212:215]
    v_mfma_f32_16x16x32_bf16 v[212:215], v[124:127], v[176:179], v[212:215]
    v_mfma_f32_16x16x32_bf16 v[212:215], v[128:131], v[172:175], v[212:215]
    s_barrier
    v_mfma_f32_16x16x32_bf16 v[212:215], v[132:135], v[168:171], v[212:215]
    v_mfma_f32_16x16x32_bf16 v[212:215], v[136:139], v[164:167], v[212:215]
    v_mfma_f32_16x16x32_bf16 v[212:215], v[140:143], v[160:163], v[212:215]
    v_mfma_f32_16x16x32_bf16 v[212:215], v[144:147], v[156:159], v[212:215]
    v_mfma_f32_16x16x32_bf16 v[212:215], v[148:151], v[152:155], v[212:215]
    s_waitcnt lgkmcnt(7)
    v_mfma_f32_16x16x32_bf16 v[200:203], v[56:59], v[104:107], v[200:203]
    ds_read_b128 v[152:155], v237 offset:3904
    v_mfma_f32_16x16x32_bf16 v[200:203], v[60:63], v[100:103], v[200:203]
    ds_read_b128 v[120:123], v236 offset:320
    v_mfma_f32_16x16x32_bf16 v[200:203], v[64:67], v[96:99], v[200:203]
    ds_read_b128 v[156:159], v237 offset:3392
    v_mfma_f32_16x16x32_bf16 v[200:203], v[68:71], v[92:95], v[200:203]
    ds_read_b128 v[124:127], v236 offset:832
    s_waitcnt lgkmcnt(10)
    v_mfma_f32_16x16x32_bf16 v[200:203], v[72:75], v[88:91], v[200:203]
    ds_read_b128 v[160:163], v237 offset:2880
    s_waitcnt lgkmcnt(10)
    v_mfma_f32_16x16x32_bf16 v[204:207], v[56:59], v[108:111], v[204:207]
    ds_read_b128 v[128:131], v236 offset:1344
    v_mfma_f32_16x16x32_bf16 v[204:207], v[60:63], v[104:107], v[204:207]
    ds_read_b128 v[164:167], v237 offset:2368
    v_mfma_f32_16x16x32_bf16 v[204:207], v[64:67], v[100:103], v[204:207]
    ds_read_b128 v[132:135], v236 offset:1856
    v_mfma_f32_16x16x32_bf16 v[204:207], v[68:71], v[96:99], v[204:207]
    ds_read_b128 v[168:171], v237 offset:1856
    v_mfma_f32_16x16x32_bf16 v[204:207], v[72:75], v[92:95], v[204:207]
    ds_read_b128 v[136:139], v236 offset:2368
    s_waitcnt lgkmcnt(14)
    v_mfma_f32_16x16x32_bf16 v[204:207], v[76:79], v[88:91], v[204:207]
    ds_read_b128 v[172:175], v237 offset:1344
    s_waitcnt lgkmcnt(14)
    v_mfma_f32_16x16x32_bf16 v[208:211], v[56:59], v[112:115], v[208:211]
    ds_read_b128 v[140:143], v236 offset:2880
    v_mfma_f32_16x16x32_bf16 v[208:211], v[60:63], v[108:111], v[208:211]
    s_waitcnt lgkmcnt(11)
    ds_read_b128 v[176:179], v237 offset:832
    v_mfma_f32_16x16x32_bf16 v[208:211], v[64:67], v[104:107], v[208:211]
    ds_read_b128 v[144:147], v236 offset:3392
    v_mfma_f32_16x16x32_bf16 v[208:211], v[68:71], v[100:103], v[208:211]
    ds_read_b128 v[180:183], v237 offset:320
    v_mfma_f32_16x16x32_bf16 v[208:211], v[72:75], v[96:99], v[208:211]
    ds_read_b128 v[148:151], v236 offset:3904
    v_mfma_f32_16x16x32_bf16 v[208:211], v[76:79], v[92:95], v[208:211]
    v_mfma_f32_16x16x32_bf16 v[208:211], v[80:83], v[88:91], v[208:211]
    v_mfma_f32_16x16x32_bf16 v[212:215], v[56:59], v[116:119], v[212:215]
    s_waitcnt vmcnt(9)
    s_mul_i32 s63, s3, 160
    s_add_u32 s63, s63, s31
    s_lshl_b32 s63, s63, 7
    s_add_u32 s63, s63, 0x1790000
    s_mov_b64 exec, 1
    buffer_store_dword v19, v20, s[12:15], s63 offen sc1
    s_mov_b64 exec, -1
    v_mfma_f32_16x16x32_bf16 v[212:215], v[60:63], v[112:115], v[212:215]
    v_mfma_f32_16x16x32_bf16 v[212:215], v[64:67], v[108:111], v[212:215]
    v_mfma_f32_16x16x32_bf16 v[212:215], v[68:71], v[104:107], v[212:215]
    v_mfma_f32_16x16x32_bf16 v[212:215], v[72:75], v[100:103], v[212:215]
    v_mfma_f32_16x16x32_bf16 v[212:215], v[76:79], v[96:99], v[212:215]
    v_mfma_f32_16x16x32_bf16 v[212:215], v[80:83], v[92:95], v[212:215]
    v_mfma_f32_16x16x32_bf16 v[212:215], v[84:87], v[88:91], v[212:215]
    s_waitcnt lgkmcnt(7)
    v_mfma_f32_16x16x32_bf16 v[200:203], v[120:123], v[168:171], v[200:203]
    ds_read_b128 v[88:91], v237 offset:3968
    v_mfma_f32_16x16x32_bf16 v[200:203], v[124:127], v[164:167], v[200:203]
    ds_read_b128 v[56:59], v236 offset:384
    v_mfma_f32_16x16x32_bf16 v[200:203], v[128:131], v[160:163], v[200:203]
    ds_read_b128 v[92:95], v237 offset:3456
    v_mfma_f32_16x16x32_bf16 v[200:203], v[132:135], v[156:159], v[200:203]
    ds_read_b128 v[60:63], v236 offset:896
    s_waitcnt lgkmcnt(10)
    v_mfma_f32_16x16x32_bf16 v[200:203], v[136:139], v[152:155], v[200:203]
    ds_read_b128 v[96:99], v237 offset:2944
    s_waitcnt lgkmcnt(10)
    v_mfma_f32_16x16x32_bf16 v[204:207], v[120:123], v[172:175], v[204:207]
    ds_read_b128 v[64:67], v236 offset:1408
    v_mfma_f32_16x16x32_bf16 v[204:207], v[124:127], v[168:171], v[204:207]
    ds_read_b128 v[100:103], v237 offset:2432
    v_mfma_f32_16x16x32_bf16 v[204:207], v[128:131], v[164:167], v[204:207]
    ds_read_b128 v[68:71], v236 offset:1920
    v_mfma_f32_16x16x32_bf16 v[204:207], v[132:135], v[160:163], v[204:207]
    ds_read_b128 v[104:107], v237 offset:1920
    v_mfma_f32_16x16x32_bf16 v[204:207], v[136:139], v[156:159], v[204:207]
    ds_read_b128 v[72:75], v236 offset:2432
    s_waitcnt lgkmcnt(14)
    v_mfma_f32_16x16x32_bf16 v[204:207], v[140:143], v[152:155], v[204:207]
    ds_read_b128 v[108:111], v237 offset:1408
    s_waitcnt lgkmcnt(14)
    v_mfma_f32_16x16x32_bf16 v[208:211], v[120:123], v[176:179], v[208:211]
    ds_read_b128 v[76:79], v236 offset:2944
    v_mfma_f32_16x16x32_bf16 v[208:211], v[124:127], v[172:175], v[208:211]
    s_waitcnt lgkmcnt(11)
    ds_read_b128 v[112:115], v237 offset:896
    v_mfma_f32_16x16x32_bf16 v[208:211], v[128:131], v[168:171], v[208:211]
    ds_read_b128 v[80:83], v236 offset:3456
    v_mfma_f32_16x16x32_bf16 v[208:211], v[132:135], v[164:167], v[208:211]
    ds_read_b128 v[116:119], v237 offset:384
    v_mfma_f32_16x16x32_bf16 v[208:211], v[136:139], v[160:163], v[208:211]
    ds_read_b128 v[84:87], v236 offset:3968
    v_mfma_f32_16x16x32_bf16 v[208:211], v[140:143], v[156:159], v[208:211]
    v_mfma_f32_16x16x32_bf16 v[208:211], v[144:147], v[152:155], v[208:211]
    v_mfma_f32_16x16x32_bf16 v[212:215], v[120:123], v[180:183], v[212:215]
    v_mfma_f32_16x16x32_bf16 v[212:215], v[124:127], v[176:179], v[212:215]
    v_mfma_f32_16x16x32_bf16 v[212:215], v[128:131], v[172:175], v[212:215]
    v_mfma_f32_16x16x32_bf16 v[212:215], v[132:135], v[168:171], v[212:215]
    v_mfma_f32_16x16x32_bf16 v[212:215], v[136:139], v[164:167], v[212:215]
    v_mfma_f32_16x16x32_bf16 v[212:215], v[140:143], v[160:163], v[212:215]
    v_mfma_f32_16x16x32_bf16 v[212:215], v[144:147], v[156:159], v[212:215]
    v_mfma_f32_16x16x32_bf16 v[212:215], v[148:151], v[152:155], v[212:215]
    s_waitcnt lgkmcnt(7)
    v_mfma_f32_16x16x32_bf16 v[200:203], v[56:59], v[104:107], v[200:203]
    ds_read_b128 v[152:155], v237 offset:4032
    v_mfma_f32_16x16x32_bf16 v[200:203], v[60:63], v[100:103], v[200:203]
    ds_read_b128 v[120:123], v236 offset:448
    v_mfma_f32_16x16x32_bf16 v[200:203], v[64:67], v[96:99], v[200:203]
    ds_read_b128 v[156:159], v237 offset:3520
    v_mfma_f32_16x16x32_bf16 v[200:203], v[68:71], v[92:95], v[200:203]
    ds_read_b128 v[124:127], v236 offset:960
    s_waitcnt lgkmcnt(10)
    v_mfma_f32_16x16x32_bf16 v[200:203], v[72:75], v[88:91], v[200:203]
    ds_read_b128 v[160:163], v237 offset:3008
    s_waitcnt lgkmcnt(10)
    v_mfma_f32_16x16x32_bf16 v[204:207], v[56:59], v[108:111], v[204:207]
    ds_read_b128 v[128:131], v236 offset:1472
    v_mfma_f32_16x16x32_bf16 v[204:207], v[60:63], v[104:107], v[204:207]
    ds_read_b128 v[164:167], v237 offset:2496
    v_mfma_f32_16x16x32_bf16 v[204:207], v[64:67], v[100:103], v[204:207]
    ds_read_b128 v[132:135], v236 offset:1984
    v_mfma_f32_16x16x32_bf16 v[204:207], v[68:71], v[96:99], v[204:207]
    ds_read_b128 v[168:171], v237 offset:1984
    v_mfma_f32_16x16x32_bf16 v[204:207], v[72:75], v[92:95], v[204:207]
    ds_read_b128 v[136:139], v236 offset:2496
    s_waitcnt lgkmcnt(14)
    v_mfma_f32_16x16x32_bf16 v[204:207], v[76:79], v[88:91], v[204:207]
    ds_read_b128 v[172:175], v237 offset:1472
    s_waitcnt lgkmcnt(14)
    v_mfma_f32_16x16x32_bf16 v[208:211], v[56:59], v[112:115], v[208:211]
    ds_read_b128 v[140:143], v236 offset:3008
    v_mfma_f32_16x16x32_bf16 v[208:211], v[60:63], v[108:111], v[208:211]
    s_waitcnt lgkmcnt(11)
    ds_read_b128 v[176:179], v237 offset:960
    v_mfma_f32_16x16x32_bf16 v[208:211], v[64:67], v[104:107], v[208:211]
    ds_read_b128 v[144:147], v236 offset:3520
    v_mfma_f32_16x16x32_bf16 v[208:211], v[68:71], v[100:103], v[208:211]
    ds_read_b128 v[180:183], v237 offset:448
    v_mfma_f32_16x16x32_bf16 v[208:211], v[72:75], v[96:99], v[208:211]
    ds_read_b128 v[148:151], v236 offset:4032
    v_mfma_f32_16x16x32_bf16 v[208:211], v[76:79], v[92:95], v[208:211]
    v_mfma_f32_16x16x32_bf16 v[208:211], v[80:83], v[88:91], v[208:211]
    v_mfma_f32_16x16x32_bf16 v[212:215], v[56:59], v[116:119], v[212:215]
    v_mfma_f32_16x16x32_bf16 v[212:215], v[60:63], v[112:115], v[212:215]
    v_mfma_f32_16x16x32_bf16 v[212:215], v[64:67], v[108:111], v[212:215]
    v_mfma_f32_16x16x32_bf16 v[212:215], v[68:71], v[104:107], v[212:215]
    v_mfma_f32_16x16x32_bf16 v[212:215], v[72:75], v[100:103], v[212:215]
    v_mfma_f32_16x16x32_bf16 v[212:215], v[76:79], v[96:99], v[212:215]
    v_mfma_f32_16x16x32_bf16 v[212:215], v[80:83], v[92:95], v[212:215]
    v_mfma_f32_16x16x32_bf16 v[212:215], v[84:87], v[88:91], v[212:215]
    s_waitcnt lgkmcnt(7)
    v_mfma_f32_16x16x32_bf16 v[200:203], v[120:123], v[168:171], v[200:203]
    buffer_load_dword v18, v54, s[12:15], s43 offen sc1
    v_mfma_f32_16x16x32_bf16 v[200:203], v[124:127], v[164:167], v[200:203]
    v_mfma_f32_16x16x32_bf16 v[200:203], v[128:131], v[160:163], v[200:203]
    v_mfma_f32_16x16x32_bf16 v[200:203], v[132:135], v[156:159], v[200:203]
    s_waitcnt lgkmcnt(6)
    v_mfma_f32_16x16x32_bf16 v[200:203], v[136:139], v[152:155], v[200:203]
    s_waitcnt lgkmcnt(5)
    v_mfma_f32_16x16x32_bf16 v[204:207], v[120:123], v[172:175], v[204:207]
    v_mfma_f32_16x16x32_bf16 v[204:207], v[124:127], v[168:171], v[204:207]
    v_mfma_f32_16x16x32_bf16 v[204:207], v[128:131], v[164:167], v[204:207]
    v_mfma_f32_16x16x32_bf16 v[204:207], v[132:135], v[160:163], v[204:207]
    v_mfma_f32_16x16x32_bf16 v[204:207], v[136:139], v[156:159], v[204:207]
    s_waitcnt lgkmcnt(4)
    v_mfma_f32_16x16x32_bf16 v[204:207], v[140:143], v[152:155], v[204:207]
    s_waitcnt lgkmcnt(3)
    v_mfma_f32_16x16x32_bf16 v[208:211], v[120:123], v[176:179], v[208:211]
    v_mfma_f32_16x16x32_bf16 v[208:211], v[124:127], v[172:175], v[208:211]
    v_mfma_f32_16x16x32_bf16 v[208:211], v[128:131], v[168:171], v[208:211]
    v_mfma_f32_16x16x32_bf16 v[208:211], v[132:135], v[164:167], v[208:211]
    v_cvt_pk_bf16_f32 v200, v200, v201
    v_cvt_pk_bf16_f32 v201, v202, v203
    ds_write_b64 v239, v[200:201] offset:0
    v_mfma_f32_16x16x32_bf16 v[208:211], v[136:139], v[160:163], v[208:211]
    v_mfma_f32_16x16x32_bf16 v[208:211], v[140:143], v[156:159], v[208:211]
    s_waitcnt lgkmcnt(3)
    v_mfma_f32_16x16x32_bf16 v[208:211], v[144:147], v[152:155], v[208:211]
    s_waitcnt lgkmcnt(2)
    v_mfma_f32_16x16x32_bf16 v[212:215], v[120:123], v[180:183], v[212:215]
    v_mfma_f32_16x16x32_bf16 v[212:215], v[124:127], v[176:179], v[212:215]
    v_mfma_f32_16x16x32_bf16 v[212:215], v[128:131], v[172:175], v[212:215]
    v_cvt_pk_bf16_f32 v204, v204, v205
    v_cvt_pk_bf16_f32 v205, v206, v207
    ds_write_b64 v239, v[204:205] offset:512
    v_mfma_f32_16x16x32_bf16 v[212:215], v[132:135], v[168:171], v[212:215]
    v_mfma_f32_16x16x32_bf16 v[212:215], v[136:139], v[164:167], v[212:215]
    v_mfma_f32_16x16x32_bf16 v[212:215], v[140:143], v[160:163], v[212:215]
    v_mfma_f32_16x16x32_bf16 v[212:215], v[144:147], v[156:159], v[212:215]
    s_waitcnt lgkmcnt(2)
    v_mfma_f32_16x16x32_bf16 v[212:215], v[148:151], v[152:155], v[212:215]
    v_cvt_pk_bf16_f32 v208, v208, v209
    v_cvt_pk_bf16_f32 v209, v210, v211
    ds_write_b64 v239, v[208:209] offset:1024
    s_nop 4
    v_cvt_pk_bf16_f32 v212, v212, v213
    v_cvt_pk_bf16_f32 v213, v214, v215
    ds_write_b64 v239, v[212:213] offset:1536
    s_waitcnt vmcnt(0) lgkmcnt(0)
    s_barrier
    ds_read_b64_tr_b16 v[184:185], v240 offset:0
    ds_read_b64_tr_b16 v[186:187], v240 offset:128
    ds_read_b64_tr_b16 v[188:189], v240 offset:256
    ds_read_b64_tr_b16 v[190:191], v240 offset:384
    s_waitcnt lgkmcnt(3)
    buffer_store_dwordx2 v[184:185], v241, s[12:15], s95 offen sc1
    s_add_u32 s95, s95, 81920
    s_waitcnt lgkmcnt(2)
    buffer_store_dwordx2 v[186:187], v241, s[12:15], s95 offen sc1
    s_add_u32 s95, s95, 81920
    s_waitcnt lgkmcnt(1)
    buffer_store_dwordx2 v[188:189], v241, s[12:15], s95 offen sc1
    s_add_u32 s95, s95, 81920
    s_waitcnt lgkmcnt(0)
    buffer_store_dwordx2 v[190:191], v241, s[12:15], s95 offen sc1
    s_add_u32 s95, s95, 81920
    s_barrier
    s_mul_i32 s63, s3, 160
    s_add_u32 s63, s63, s31
    s_lshl_b32 s63, s63, 7
    s_add_u32 s63, s63, 0x17a4000
    v_cmp_ne_u32 vcc, v19, v18
    s_cbranch_vccnz L_w1late_16
    s_mul_i32 s51, s25, 143360
    s_mul_i32 s54, s3, 35840
    s_add_u32 s52, s51, 0xf00000
    s_lshr_b32 s51, s47, 3
    s_mul_i32 s51, s51, 5
    s_lshr_b32 s51, s51, 2
    s_mul_i32 s51, s51, 7168
    s_add_u32 s51, s51, s54
    s_add_u32 s61, s54, 35840
    s_mov_b32 m0, s51
    s_add_u32 s55, s52, s51
    buffer_load_dwordx4 v2, s[12:15], s55 offen offset:0 sc1 lds
    buffer_load_dwordx4 v2, s[12:15], s55 offen offset:1024 sc1 lds
    buffer_load_dwordx4 v2, s[12:15], s55 offen offset:2048 sc1 lds
    buffer_load_dwordx4 v2, s[12:15], s55 offen offset:3072 sc1 lds
    s_add_u32 m0, s51, 4096
    s_add_u32 s55, s55, 4096
    buffer_load_dwordx4 v2, s[12:15], s55 offen offset:0 sc1 lds
    buffer_load_dwordx4 v2, s[12:15], s55 offen offset:1024 sc1 lds
    buffer_load_dwordx4 v2, s[12:15], s55 offen offset:2048 sc1 lds
    s_add_u32 s51, s51, 7168
    s_cmp_eq_u32 s51, s61
    s_cselect_b32 s51, s54, s51
    s_waitcnt vmcnt(7)
    s_mov_b64 exec, 1
    buffer_store_dword v19, v20, s[12:15], s63 offen sc1
    s_mov_b64 exec, -1
    s_mov_b32 s62, 4
L_dmaloop_18:
    s_mov_b32 m0, s51
    s_add_u32 s55, s52, s51
    buffer_load_dwordx4 v2, s[12:15], s55 offen offset:0 sc1 lds
    buffer_load_dwordx4 v2, s[12:15], s55 offen offset:1024 sc1 lds
    buffer_load_dwordx4 v2, s[12:15], s55 offen offset:2048 sc1 lds
    buffer_load_dwordx4 v2, s[12:15], s55 offen offset:3072 sc1 lds
    s_add_u32 m0, s51, 4096
    s_add_u32 s55, s55, 4096
    buffer_load_dwordx4 v2, s[12:15], s55 offen offset:0 sc1 lds
    buffer_load_dwordx4 v2, s[12:15], s55 offen offset:1024 sc1 lds
    buffer_load_dwordx4 v2, s[12:15], s55 offen offset:2048 sc1 lds
    s_add_u32 s51, s51, 7168
    s_cmp_eq_u32 s51, s61
    s_cselect_b32 s51, s54, s51
    s_waitcnt vmcnt(42)
    s_sub_u32 s62, s62, 1
    s_cmp_lg_u32 s62, 0
    s_cbranch_scc1 L_dmaloop_18
    s_branch L_join_6
L_w1late_16:
    s_waitcnt vmcnt(0)
    s_mov_b64 exec, 1
    buffer_store_dword v19, v20, s[12:15], s63 offen sc1
    s_mov_b64 exec, -1
    s_branch L_w1poll_10
L_help_2:
    s_sub_u32 s31, s47, 20
    s_lshl_b32 s31, s31, 3
    s_add_u32 s31, s31, s45
    s_waitcnt lgkmcnt(0)
    s_mov_b32 s12, s4
    s_mov_b32 s13, s5
    s_mov_b32 s14, 0x25d0000
    s_mov_b32 s15, 0x20000
    s_mov_b32 s16, s64
    s_mov_b32 s17, s65
    s_mov_b32 s18, 0x280000
    s_mov_b32 s19, 0x20000
    s_mov_b32 s20, s84
    s_mov_b32 s21, s85
    s_mov_b32 s22, 0x280000
    s_mov_b32 s23, 0x20000
    s_mov_b32 s24, s45
    s_mov_b32 s58, s47
    s_and_b32 s26, s58, 7
    s_lshr_b32 s27, s58, 3
    s_xor_b32 s39, s29, s58
    s_and_b32 s39, s39, 1
    s_lshr_b32 s59, s45, 2
    s_lshl_b32 s59, s59, 2
    s_lshr_b32 s51, s47, 3
    s_add_u32 s59, s59, s51
    s_and_b32 s25, s45, 3
    s_lshl_b32 s25, s25, 3
    s_and_b32 s51, s47, 7
    s_add_u32 s25, s25, s51
    s_lshl_b32 s51, s59, 2
    s_add_u32 s52, s51, s3
    s_lshl_b32 s51, s24, 2
    s_add_u32 s53, s51, s27
    s_mul_i32 s30, s52, 40960
    s_mul_i32 s32, s53, 114688
    s_mul_i32 s51, s3, 28672
    s_add_u32 s32, s32, s51
    s_mul_i32 s34, s52, 114688
    s_mul_i32 s36, s53, 40960
    s_lshl_b32 s51, s39, 10
    s_add_u32 s36, s36, s51
    s_lshl_b32 s38, s53, 1
    s_add_u32 s38, s38, s39
    s_lshl_b32 s48, s38, 13
    s_lshl_b32 s51, s26, 1
    s_add_u32 s51, s51, s28
    s_lshl_b32 s51, s51, 9
    s_add_u32 s49, s48, s51
    s_mul_i32 s38, s38, 20480
    s_mov_b32 s35, s38
    s_mul_i32 s51, s26, 160
    s_add_u32 s38, s38, s51
    s_lshl_b32 s40, s52, 12
    s_lshl_b32 s42, s53, 12
    s_lshl_b32 s51, s26, 7
    s_add_u32 s42, s42, s51
    s_lshl_b32 s44, s53, 12
    s_lshl_b32 s51, s3, 10
    s_add_u32 s44, s44, s51
    s_lshl_b32 s46, s52, 12
    s_lshl_b32 s51, s25, 7
    s_add_u32 s46, s46, s51
    s_mov_b32 s50, 100000
    s_cmp_eq_u32 s28, 0
    s_cselect_b32 s56, -1, 0
    s_cselect_b32 s57, 0, -1
    v_lshlrev_b32 v2, 4, v0
    s_lshl_b32 s51, s39, 10
    v_add_u32 v5, s51, v2
    v_xor_b32 v6, 1024, v5
    v_lshrrev_b32 v21, 4, v0
    v_and_b32 v22, 15, v0
    v_lshlrev_b32 v23, 4, v22
    s_mul_i32 s51, s25, 7
    v_add_u32 v25, s51, v21
    v_lshrrev_b32 v24, 2, v25
    v_lshl_add_u32 v7, v24, 11, v23
    v_and_b32 v24, 3, v25
    v_lshl_add_u32 v7, v24, 8, v7
    s_mul_i32 s51, s26, 10
    s_lshl_b32 s54, s28, 2
    s_add_u32 s54, s54, s51
    v_add_u32 v25, s54, v21
    v_lshrrev_b32 v24, 2, v25
    v_lshl_add_u32 v8, v24, 11, v23
    v_and_b32 v24, 3, v25
    v_lshl_add_u32 v8, v24, 8, v8
    s_add_u32 s51, s51, 8
    v_lshrrev_b32 v25, 1, v21
    v_add_u32 v25, s51, v25
    v_lshrrev_b32 v24, 2, v25
    v_lshl_add_u32 v9, v24, 11, v23
    v_and_b32 v24, 3, v25
    v_lshl_add_u32 v9, v24, 8, v9
    v_and_b32 v24, 1, v21
    v_lshl_add_u32 v9, v24, 3, v9
    v_mul_u32_u24 v24, 1280, v22
    v_lshl_add_u32 v10, v21, 4, v24
    s_lshl_b32 s51, s28, 6
    v_add_u32 v10, s51, v10
    v_lshl_add_u32 v11, v21, 3, v24
    v_add_u32 v11, 128, v11
    v_and_b32 v12, 31, v0
    v_lshlrev_b32 v12, 7, v12
    v_and_b32 v13, 7, v0
    v_lshlrev_b32 v13, 7, v13
    v_lshlrev_b32 v14, 5, v22
    v_lshl_add_u32 v14, v21, 3, v14
    s_xor_b32 s51, s3, 0
    s_mul_i32 s51, s51, 5120
    s_add_u32 s51, s51, 143360
    v_add_u32 v15, s51, v2
    s_xor_b32 s51, s3, 1
    s_mul_i32 s51, s51, 5120
    s_add_u32 s51, s51, 143360
    v_add_u32 v16, s51, v2
    s_xor_b32 s51, s3, 2
    s_mul_i32 s51, s51, 5120
    s_add_u32 s51, s51, 143360
    v_add_u32 v17, s51, v2
    s_xor_b32 s51, s3, 3
    s_mul_i32 s51, s51, 5120
    s_add_u32 s51, s51, 143360
    v_add_u32 v1, s51, v2
    v_mov_b32 v20, 0
    v_and_b32 v24, 3, v0
    v_lshrrev_b32 v25, 2, v0
    v_mul_u32_u24 v252, 1280, v24
    v_lshl_add_u32 v252, v25, 4, v252
    s_lshl_b32 s62, s24, 7
    s_lshl_b32 s54, s29, 10
    s_add_u32 s62, s62, s54
    s_lshl_b32 s54, s58, 2
    s_add_u32 s62, s62, s54
    s_mul_i32 s62, s62, 1280
    s_mul_i32 s60, s26, 56
    s_mul_i32 s54, s3, 14
    s_add_u32 s60, s60, s54
    s_mul_i32 s60, s60, 5120
    s_add_u32 s60, s60, 0x1360000
    s_lshl_b32 s37, s26, 7
    s_add_u32 s37, s37, 0x17b8000
    s_mov_b32 s55, 0x17c3000
    buffer_load_dword v19, v20, s[12:15], s55 offen sc1
    buffer_load_dwordx4 v[32:35], v252, s[16:19], s62 offen offset:0
    buffer_load_dwordx4 v[36:39], v252, s[16:19], s62 offen offset:256
    buffer_load_dwordx4 v[40:43], v252, s[16:19], s62 offen offset:512
    buffer_load_dwordx4 v[44:47], v252, s[16:19], s62 offen offset:768
    buffer_load_dwordx4 v[48:51], v252, s[16:19], s62 offen offset:1024
    v_mov_b32 v30, -1
    v_mov_b32 v31, -1
    s_add_u32 s55, s49, 0x1590000
    buffer_store_dwordx2 v[30:31], v14, s[12:15], s55 offen sc1
    s_add_u32 s55, s49, 0x280000
    buffer_store_dwordx2 v[30:31], v14, s[12:15], s55 offen sc1
    s_add_u32 s55, s49, 0x1610000
    buffer_store_dwordx2 v[30:31], v14, s[12:15], s55 offen sc1
    s_add_u32 s55, s49, 0x300000
    buffer_store_dwordx2 v[30:31], v14, s[12:15], s55 offen sc1
    s_cmp_ge_u32 s31, 88
    s_cbranch_scc1 L_idle_5
    s_waitcnt vmcnt(9)
    v_add_u32 v19, 1, v19
    s_cmp_ge_u32 s31, 64
    s_cbranch_scc1 L_w2role_3
    s_lshr_b32 s92, s31, 2
    s_cmp_ge_u32 s3, 2
    s_cselect_b32 s88, s80, s78
    s_cselect_b32 s89, s81, s79
    s_cmp_ge_u32 s92, 27
    s_cselect_b32 s90, 0, 0x21c000
    s_mov_b32 s91, 0x20000
    v_lshrrev_b32 v24, 3, v0
    v_mul_u32_u24 v24, 3456, v24
    v_and_b32 v25, 7, v0
    v_lshl_add_u32 v24, v25, 4, v24
    s_and_b32 s93, s31, 3
    s_lshl_b32 s93, s93, 1
    s_add_u32 s93, s93, s29
    s_mul_i32 s93, s93, 276480
    s_min_u32 s94, s92, 26
    s_lshl_b32 s94, s94, 7
    s_add_u32 s93, s93, s94
    s_mul_i32 s94, s3, 10240
    s_add_u32 m0, s94, 40960
    s_nop 0
    buffer_load_dwordx4 v24, s[88:91], s93 offen nt lds
    s_add_u32 s93, s93, 27648
    s_add_u32 m0, s94, 41984
    s_nop 0
    buffer_load_dwordx4 v24, s[88:91], s93 offen nt lds
    s_add_u32 s93, s93, 27648
    s_add_u32 m0, s94, 43008
    s_nop 0
    buffer_load_dwordx4 v24, s[88:91], s93 offen nt lds
    s_add_u32 s93, s93, 27648
    s_add_u32 m0, s94, 44032
    s_nop 0
    buffer_load_dwordx4 v24, s[88:91], s93 offen nt lds
    s_add_u32 s93, s93, 27648
    s_add_u32 m0, s94, 45056
    s_nop 0
    buffer_load_dwordx4 v24, s[88:91], s93 offen nt lds
    s_add_u32 s93, s93, 27648
    s_add_u32 m0, s94, 46080
    s_nop 0
    buffer_load_dwordx4 v24, s[88:91], s93 offen nt lds
    s_add_u32 s93, s93, 27648
    s_add_u32 m0, s94, 47104
    s_nop 0
    buffer_load_dwordx4 v24, s[88:91], s93 offen nt lds
    s_add_u32 s93, s93, 27648
    s_add_u32 m0, s94, 48128
    s_nop 0
    buffer_load_dwordx4 v24, s[88:91], s93 offen nt lds
    s_add_u32 s93, s93, 27648
    s_add_u32 m0, s94, 49152
    s_nop 0
    buffer_load_dwordx4 v24, s[88:91], s93 offen nt lds
    s_add_u32 s93, s93, 27648
    s_add_u32 m0, s94, 50176
    s_nop 0
    buffer_load_dwordx4 v24, s[88:91], s93 offen nt lds
    s_add_u32 s93, s93, 27648
    s_mov_b32 s8, s82
    s_mov_b32 s9, s83
    s_mov_b32 s10, 0x21c000
    s_mov_b32 s11, 0x20000
    v_mul_u32_u24 v24, 205, v0
    v_lshrrev_b32 v24, 11, v24
    v_mul_u32_u24 v25, 10, v24
    v_sub_u32 v25, v0, v25
    v_mul_u32_u24 v24, 1280, v24
    v_lshl_add_u32 v24, v25, 4, v24
    s_lshr_b32 s93, s31, 3
    s_mul_i32 s93, s93, 286720
    s_mul_i32 s94, s3, 76800
    s_add_u32 s93, s93, s94
    s_and_b32 s94, s31, 7
    s_mul_i32 s94, s94, 160
    s_add_u32 s93, s93, s94
    v_add_u32 v24, s93, v24
    s_mul_i32 s94, s3, 9600
    s_add_u32 m0, s94, 0
    s_nop 0
    buffer_load_dwordx4 v24, s[8:11], 0 offen nt lds
    v_add_u32 v24, 7680, v24
    s_add_u32 m0, s94, 960
    s_nop 0
    buffer_load_dwordx4 v24, s[8:11], 0 offen nt lds
    v_add_u32 v24, 7680, v24
    s_add_u32 m0, s94, 1920
    s_nop 0
    buffer_load_dwordx4 v24, s[8:11], 0 offen nt lds
    v_add_u32 v24, 7680, v24
    s_add_u32 m0, s94, 2880
    s_nop 0
    buffer_load_dwordx4 v24, s[8:11], 0 offen nt lds
    v_add_u32 v24, 7680, v24
    s_add_u32 m0, s94, 3840
    s_nop 0
    buffer_load_dwordx4 v24, s[8:11], 0 offen nt lds
    v_add_u32 v24, 7680, v24
    s_add_u32 m0, s94, 4800
    s_nop 0
    buffer_load_dwordx4 v24, s[8:11], 0 offen nt lds
    v_add_u32 v24, 7680, v24
    s_add_u32 m0, s94, 5760
    s_nop 0
    buffer_load_dwordx4 v24, s[8:11], 0 offen nt lds
    v_add_u32 v24, 7680, v24
    s_add_u32 m0, s94, 6720
    s_nop 0
    buffer_load_dwordx4 v24, s[8:11], 0 offen nt lds
    v_add_u32 v24, 7680, v24
    s_add_u32 m0, s94, 7680
    s_nop 0
    buffer_load_dwordx4 v24, s[8:11], 0 offen nt lds
    v_add_u32 v24, 7680, v24
    s_add_u32 m0, s94, 8640
    s_nop 0
    buffer_load_dwordx4 v24, s[8:11], 0 offen nt lds
    v_add_u32 v24, 7680, v24
    s_waitcnt vmcnt(10)
    s_barrier
    v_bfe_u32 v25, v0, 2, 2
    v_lshl_add_u32 v25, v21, 3, v25
    v_lshlrev_b32 v25, 7, v25
    v_and_b32 v26, 1, v0
    v_lshl_add_u32 v25, v26, 3, v25
    v_bfe_u32 v26, v0, 1, 1
    v_mul_u32_u24 v26, 20480, v26
    s_lshl_b32 s93, s3, 5
    s_add_u32 s93, s93, 40960
    v_add3_u32 v25, v25, v26, s93
    ds_read_b64_tr_b16 v[96:97], v25 offset:0
    ds_read_b64_tr_b16 v[98:99], v25 offset:512
    ds_read_b64_tr_b16 v[100:101], v25 offset:16
    ds_read_b64_tr_b16 v[102:103], v25 offset:528
    ds_read_b64_tr_b16 v[104:105], v25 offset:4096
    ds_read_b64_tr_b16 v[106:107], v25 offset:4608
    ds_read_b64_tr_b16 v[108:109], v25 offset:4112
    ds_read_b64_tr_b16 v[110:111], v25 offset:4624
    ds_read_b64_tr_b16 v[112:113], v25 offset:8192
    ds_read_b64_tr_b16 v[114:115], v25 offset:8704
    ds_read_b64_tr_b16 v[116:117], v25 offset:8208
    ds_read_b64_tr_b16 v[118:119], v25 offset:8720
    ds_read_b64_tr_b16 v[120:121], v25 offset:12288
    ds_read_b64_tr_b16 v[122:123], v25 offset:12800
    s_waitcnt lgkmcnt(8)
    ds_read_b64_tr_b16 v[124:125], v25 offset:12304
    ds_read_b64_tr_b16 v[126:127], v25 offset:12816
    ds_read_b64_tr_b16 v[128:129], v25 offset:16384
    ds_read_b64_tr_b16 v[130:131], v25 offset:16896
    ds_read_b64_tr_b16 v[132:133], v25 offset:16400
    ds_read_b64_tr_b16 v[134:135], v25 offset:16912
    s_lshr_b32 s93, s31, 2
    s_lshl_b32 s93, s93, 3
    s_lshl_b32 s94, s3, 1
    s_add_u32 s93, s93, s94
    s_add_u32 s93, s93, 0
    s_mul_i32 s94, s93, 9363
    s_lshr_b32 s94, s94, 16
    s_mul_i32 s95, s94, 7
    s_sub_u32 s93, s93, s95
    s_mul_i32 s94, s94, 143360
    s_lshl_b32 s93, s93, 10
    s_add_u32 s93, s93, s94
    s_and_b32 s94, s31, 3
    s_mul_i32 s94, s94, 35840
    s_add_u32 s93, s93, s94
    s_add_u32 s96, s93, 0xf00000
    s_lshr_b32 s93, s31, 2
    s_lshl_b32 s93, s93, 3
    s_lshl_b32 s94, s3, 1
    s_add_u32 s93, s93, s94
    s_add_u32 s93, s93, 1
    s_mul_i32 s94, s93, 9363
    s_lshr_b32 s94, s94, 16
    s_mul_i32 s95, s94, 7
    s_sub_u32 s93, s93, s95
    s_mul_i32 s94, s94, 143360
    s_lshl_b32 s93, s93, 10
    s_add_u32 s93, s93, s94
    s_and_b32 s94, s31, 3
    s_mul_i32 s94, s94, 35840
    s_add_u32 s93, s93, s94
    s_add_u32 s97, s93, 0xf00000
    s_waitcnt lgkmcnt(0)
    buffer_store_dwordx4 v[96:99], v2, s[12:15], s96 offen sc1
    s_add_u32 s96, s96, 7168
    buffer_store_dwordx4 v[100:103], v2, s[12:15], s97 offen sc1
    s_add_u32 s97, s97, 7168
    buffer_store_dwordx4 v[104:107], v2, s[12:15], s96 offen sc1
    s_add_u32 s96, s96, 7168
    buffer_store_dwordx4 v[108:111], v2, s[12:15], s97 offen sc1
    s_add_u32 s97, s97, 7168
    buffer_store_dwordx4 v[112:115], v2, s[12:15], s96 offen sc1
    s_add_u32 s96, s96, 7168
    buffer_store_dwordx4 v[116:119], v2, s[12:15], s97 offen sc1
    s_add_u32 s97, s97, 7168
    buffer_store_dwordx4 v[120:123], v2, s[12:15], s96 offen sc1
    s_add_u32 s96, s96, 7168
    buffer_store_dwordx4 v[124:127], v2, s[12:15], s97 offen sc1
    s_add_u32 s97, s97, 7168
    buffer_store_dwordx4 v[128:131], v2, s[12:15], s96 offen sc1
    s_add_u32 s96, s96, 7168
    buffer_store_dwordx4 v[132:135], v2, s[12:15], s97 offen sc1
    s_add_u32 s97, s97, 7168
    v_bfe_u32 v216, v0, 2, 2
    v_and_b32 v217, 3, v0
    s_lshl_b32 s93, s3, 1
    s_min_u32 s93, s93, 5
    s_add_u32 s95, s93, 0
    s_lshl_b32 s95, s95, 2
    v_add_u32 v24, s95, v21
    v_mul_u32_u24 v25, 37, v24
    v_lshrrev_b32 v25, 8, v25
    v_mul_u32_u24 v26, 7, v25
    v_sub_u32 v26, v24, v26
    v_cmp_gt_u32 s[6:7], 4, v26
    v_subrev_u32 v27, 4, v26
    v_lshrrev_b32 v28, 1, v216
    v_add_u32 v28, 0, v28
    v_cmp_eq_u32 vcc, 3, v28
    v_add_u32 v29, 4, v28
    s_nop 0
    v_cndmask_b32 v29, v29, v26, vcc
    v_cndmask_b32_e64 v30, v27, 3, vcc
    v_cndmask_b32 v29, v29, v28, s[6:7]
    v_cndmask_b32 v30, v30, v26, s[6:7]
    v_mul_u32_u24 v31, 56, v25
    v_lshl_add_u32 v31, v29, 3, v31
    v_lshl_add_u32 v31, v30, 1, v31
    v_and_b32 v29, 1, v216
    v_add_u32 v31, v31, v29
    v_mul_u32_u24 v31, 160, v31
    v_lshl_add_u32 v200, v217, 4, v31
    v_lshl_add_u32 v204, v217, 3, v31
    v_lshrrev_b32 v28, 1, v216
    v_add_u32 v28, 2, v28
    v_cmp_eq_u32 vcc, 3, v28
    v_add_u32 v29, 4, v28
    s_nop 0
    v_cndmask_b32 v29, v29, v26, vcc
    v_cndmask_b32_e64 v30, v27, 3, vcc
    v_cndmask_b32 v29, v29, v28, s[6:7]
    v_cndmask_b32 v30, v30, v26, s[6:7]
    v_mul_u32_u24 v31, 56, v25
    v_lshl_add_u32 v31, v29, 3, v31
    v_lshl_add_u32 v31, v30, 1, v31
    v_and_b32 v29, 1, v216
    v_add_u32 v31, v31, v29
    v_mul_u32_u24 v31, 160, v31
    v_lshl_add_u32 v201, v217, 4, v31
    v_lshl_add_u32 v205, v217, 3, v31
    s_add_u32 s95, s93, 1
    s_lshl_b32 s95, s95, 2
    v_add_u32 v24, s95, v21
    v_mul_u32_u24 v25, 37, v24
    v_lshrrev_b32 v25, 8, v25
    v_mul_u32_u24 v26, 7, v25
    v_sub_u32 v26, v24, v26
    v_cmp_gt_u32 s[6:7], 4, v26
    v_subrev_u32 v27, 4, v26
    v_lshrrev_b32 v28, 1, v216
    v_add_u32 v28, 0, v28
    v_cmp_eq_u32 vcc, 3, v28
    v_add_u32 v29, 4, v28
    s_nop 0
    v_cndmask_b32 v29, v29, v26, vcc
    v_cndmask_b32_e64 v30, v27, 3, vcc
    v_cndmask_b32 v29, v29, v28, s[6:7]
    v_cndmask_b32 v30, v30, v26, s[6:7]
    v_mul_u32_u24 v31, 56, v25
    v_lshl_add_u32 v31, v29, 3, v31
    v_lshl_add_u32 v31, v30, 1, v31
    v_and_b32 v29, 1, v216
    v_add_u32 v31, v31, v29
    v_mul_u32_u24 v31, 160, v31
    v_lshl_add_u32 v202, v217, 4, v31
    v_lshl_add_u32 v206, v217, 3, v31
    v_lshrrev_b32 v28, 1, v216
    v_add_u32 v28, 2, v28
    v_cmp_eq_u32 vcc, 3, v28
    v_add_u32 v29, 4, v28
    s_nop 0
    v_cndmask_b32 v29, v29, v26, vcc
    v_cndmask_b32_e64 v30, v27, 3, vcc
    v_cndmask_b32 v29, v29, v28, s[6:7]
    v_cndmask_b32 v30, v30, v26, s[6:7]
    v_mul_u32_u24 v31, 56, v25
    v_lshl_add_u32 v31, v29, 3, v31
    v_lshl_add_u32 v31, v30, 1, v31
    v_and_b32 v29, 1, v216
    v_add_u32 v31, v31, v29
    v_mul_u32_u24 v31, 160, v31
    v_lshl_add_u32 v203, v217, 4, v31
    v_lshl_add_u32 v207, v217, 3, v31
    s_and_b32 s95, s31, 7
    s_mul_i32 s95, s95, 56
    s_lshr_b32 s96, s31, 3
    s_mul_i32 s96, s96, 7
    s_add_u32 s95, s95, s96
    s_add_u32 s95, s95, s93
    s_mul_i32 s95, s95, 5120
    s_add_u32 s95, s95, 0x1360000
    v_add_u32 v24, 4096, v2
    s_waitcnt vmcnt(0)
    s_barrier
    s_cmp_lg_u32 s3, 0
    s_cbranch_scc1 L_noflag_19
    s_lshl_b32 s63, s31, 7
    s_add_u32 s63, s63, 0x17ba000
    s_mov_b64 exec, 1
    buffer_store_dword v19, v20, s[12:15], s63 offen sc1
    s_mov_b64 exec, -1
L_noflag_19:
    ds_read_b64_tr_b16 v[56:57], v200 offset:0
    ds_read_b64_tr_b16 v[58:59], v201 offset:0
    ds_read_b64_tr_b16 v[60:61], v200 offset:8
    ds_read_b64_tr_b16 v[62:63], v201 offset:8
    ds_read_b64_tr_b16 v[64:65], v200 offset:64
    ds_read_b64_tr_b16 v[66:67], v201 offset:64
    ds_read_b64_tr_b16 v[68:69], v200 offset:72
    ds_read_b64_tr_b16 v[70:71], v201 offset:72
    ds_read_b64_tr_b16 v[72:73], v204 offset:128
    ds_read_b64_tr_b16 v[74:75], v205 offset:128
    s_waitcnt lgkmcnt(8)
    buffer_store_dwordx4 v[56:59], v2, s[12:15], s95 offen offset:0 sc1
    s_waitcnt lgkmcnt(6)
    buffer_store_dwordx4 v[60:63], v2, s[12:15], s95 offen offset:1024 sc1
    s_waitcnt lgkmcnt(4)
    buffer_store_dwordx4 v[64:67], v2, s[12:15], s95 offen offset:2048 sc1
    s_waitcnt lgkmcnt(2)
    buffer_store_dwordx4 v[68:71], v2, s[12:15], s95 offen offset:3072 sc1
    s_waitcnt lgkmcnt(0)
    buffer_store_dwordx4 v[72:75], v24, s[12:15], s95 offen sc1
    s_add_u32 s95, s95, 5120
    ds_read_b64_tr_b16 v[76:77], v202 offset:0
    ds_read_b64_tr_b16 v[78:79], v203 offset:0
    ds_read_b64_tr_b16 v[80:81], v202 offset:8
    ds_read_b64_tr_b16 v[82:83], v203 offset:8
    ds_read_b64_tr_b16 v[84:85], v202 offset:64
    ds_read_b64_tr_b16 v[86:87], v203 offset:64
    ds_read_b64_tr_b16 v[88:89], v202 offset:72
    ds_read_b64_tr_b16 v[90:91], v203 offset:72
    ds_read_b64_tr_b16 v[92:93], v206 offset:128
    ds_read_b64_tr_b16 v[94:95], v207 offset:128
    s_waitcnt lgkmcnt(8)
    buffer_store_dwordx4 v[76:79], v2, s[12:15], s95 offen offset:0 sc1
    s_waitcnt lgkmcnt(6)
    buffer_store_dwordx4 v[80:83], v2, s[12:15], s95 offen offset:1024 sc1
    s_waitcnt lgkmcnt(4)
    buffer_store_dwordx4 v[84:87], v2, s[12:15], s95 offen offset:2048 sc1
    s_waitcnt lgkmcnt(2)
    buffer_store_dwordx4 v[88:91], v2, s[12:15], s95 offen offset:3072 sc1
    s_waitcnt lgkmcnt(0)
    buffer_store_dwordx4 v[92:95], v24, s[12:15], s95 offen sc1
    s_add_u32 s95, s95, 5120
    s_waitcnt vmcnt(0)
    s_barrier
    s_cmp_lg_u32 s3, 0
    s_cbranch_scc1 L_noflag_20
    s_lshl_b32 s63, s31, 7
    s_add_u32 s63, s63, 0x17b8000
    s_mov_b64 exec, 1
    buffer_store_dword v19, v20, s[12:15], s63 offen sc1
    s_mov_b64 exec, -1
L_noflag_20:
    s_branch L_hdone_4
L_w2role_3:
    s_lshl_b32 s41, s31, 1
    s_sub_u32 s41, s41, 64
    s_add_u32 s31, s41, 1
    s_lshr_b32 s92, s41, 2
    s_cmp_ge_u32 s3, 2
    s_cselect_b32 s88, s80, s78
    s_cselect_b32 s89, s81, s79
    s_cmp_ge_u32 s92, 27
    s_cselect_b32 s90, 0, 0x21c000
    s_mov_b32 s91, 0x20000
    v_lshrrev_b32 v24, 3, v0
    v_mul_u32_u24 v24, 3456, v24
    v_and_b32 v25, 7, v0
    v_lshl_add_u32 v24, v25, 4, v24
    s_and_b32 s93, s41, 3
    s_lshl_b32 s93, s93, 1
    s_add_u32 s93, s93, s29
    s_mul_i32 s93, s93, 276480
    s_min_u32 s94, s92, 26
    s_lshl_b32 s94, s94, 7
    s_add_u32 s93, s93, s94
    s_mul_i32 s94, s3, 10240
    s_add_u32 m0, s94, 0
    s_nop 0
    buffer_load_dwordx4 v24, s[88:91], s93 offen nt lds
    s_add_u32 s93, s93, 27648
    s_add_u32 m0, s94, 1024
    s_nop 0
    buffer_load_dwordx4 v24, s[88:91], s93 offen nt lds
    s_add_u32 s93, s93, 27648
    s_add_u32 m0, s94, 2048
    s_nop 0
    buffer_load_dwordx4 v24, s[88:91], s93 offen nt lds
    s_add_u32 s93, s93, 27648
    s_add_u32 m0, s94, 3072
    s_nop 0
    buffer_load_dwordx4 v24, s[88:91], s93 offen nt lds
    s_add_u32 s93, s93, 27648
    s_add_u32 m0, s94, 4096
    s_nop 0
    buffer_load_dwordx4 v24, s[88:91], s93 offen nt lds
    s_add_u32 s93, s93, 27648
    s_add_u32 m0, s94, 5120
    s_nop 0
    buffer_load_dwordx4 v24, s[88:91], s93 offen nt lds
    s_add_u32 s93, s93, 27648
    s_add_u32 m0, s94, 6144
    s_nop 0
    buffer_load_dwordx4 v24, s[88:91], s93 offen nt lds
    s_add_u32 s93, s93, 27648
    s_add_u32 m0, s94, 7168
    s_nop 0
    buffer_load_dwordx4 v24, s[88:91], s93 offen nt lds
    s_add_u32 s93, s93, 27648
    s_add_u32 m0, s94, 8192
    s_nop 0
    buffer_load_dwordx4 v24, s[88:91], s93 offen nt lds
    s_add_u32 s93, s93, 27648
    s_add_u32 m0, s94, 9216
    s_nop 0
    buffer_load_dwordx4 v24, s[88:91], s93 offen nt lds
    s_add_u32 s93, s93, 27648
    s_lshr_b32 s92, s31, 2
    s_cmp_ge_u32 s3, 2
    s_cselect_b32 s88, s80, s78
    s_cselect_b32 s89, s81, s79
    s_cmp_ge_u32 s92, 27
    s_cselect_b32 s90, 0, 0x21c000
    s_mov_b32 s91, 0x20000
    v_lshrrev_b32 v24, 3, v0
    v_mul_u32_u24 v24, 3456, v24
    v_and_b32 v25, 7, v0
    v_lshl_add_u32 v24, v25, 4, v24
    s_and_b32 s93, s31, 3
    s_lshl_b32 s93, s93, 1
    s_add_u32 s93, s93, s29
    s_mul_i32 s93, s93, 276480
    s_min_u32 s94, s92, 26
    s_lshl_b32 s94, s94, 7
    s_add_u32 s93, s93, s94
    s_mul_i32 s94, s3, 10240
    s_add_u32 m0, s94, 40960
    s_nop 0
    buffer_load_dwordx4 v24, s[88:91], s93 offen nt lds
    s_add_u32 s93, s93, 27648
    s_add_u32 m0, s94, 41984
    s_nop 0
    buffer_load_dwordx4 v24, s[88:91], s93 offen nt lds
    s_add_u32 s93, s93, 27648
    s_add_u32 m0, s94, 43008
    s_nop 0
    buffer_load_dwordx4 v24, s[88:91], s93 offen nt lds
    s_add_u32 s93, s93, 27648
    s_add_u32 m0, s94, 44032
    s_nop 0
    buffer_load_dwordx4 v24, s[88:91], s93 offen nt lds
    s_add_u32 s93, s93, 27648
    s_add_u32 m0, s94, 45056
    s_nop 0
    buffer_load_dwordx4 v24, s[88:91], s93 offen nt lds
    s_add_u32 s93, s93, 27648
    s_add_u32 m0, s94, 46080
    s_nop 0
    buffer_load_dwordx4 v24, s[88:91], s93 offen nt lds
    s_add_u32 s93, s93, 27648
    s_add_u32 m0, s94, 47104
    s_nop 0
    buffer_load_dwordx4 v24, s[88:91], s93 offen nt lds
    s_add_u32 s93, s93, 27648
    s_add_u32 m0, s94, 48128
    s_nop 0
    buffer_load_dwordx4 v24, s[88:91], s93 offen nt lds
    s_add_u32 s93, s93, 27648
    s_add_u32 m0, s94, 49152
    s_nop 0
    buffer_load_dwordx4 v24, s[88:91], s93 offen nt lds
    s_add_u32 s93, s93, 27648
    s_add_u32 m0, s94, 50176
    s_nop 0
    buffer_load_dwordx4 v24, s[88:91], s93 offen nt lds
    s_add_u32 s93, s93, 27648
    s_waitcnt vmcnt(10)
    s_barrier
    v_bfe_u32 v25, v0, 2, 2
    v_lshl_add_u32 v25, v21, 3, v25
    v_lshlrev_b32 v25, 7, v25
    v_and_b32 v26, 1, v0
    v_lshl_add_u32 v25, v26, 3, v25
    v_bfe_u32 v26, v0, 1, 1
    v_mul_u32_u24 v26, 20480, v26
    s_lshl_b32 s93, s3, 5
    s_add_u32 s93, s93, 0
    v_add3_u32 v25, v25, v26, s93
    ds_read_b64_tr_b16 v[56:57], v25 offset:0
    ds_read_b64_tr_b16 v[58:59], v25 offset:512
    ds_read_b64_tr_b16 v[60:61], v25 offset:16
    ds_read_b64_tr_b16 v[62:63], v25 offset:528
    ds_read_b64_tr_b16 v[64:65], v25 offset:4096
    ds_read_b64_tr_b16 v[66:67], v25 offset:4608
    ds_read_b64_tr_b16 v[68:69], v25 offset:4112
    ds_read_b64_tr_b16 v[70:71], v25 offset:4624
    ds_read_b64_tr_b16 v[72:73], v25 offset:8192
    ds_read_b64_tr_b16 v[74:75], v25 offset:8704
    ds_read_b64_tr_b16 v[76:77], v25 offset:8208
    ds_read_b64_tr_b16 v[78:79], v25 offset:8720
    ds_read_b64_tr_b16 v[80:81], v25 offset:12288
    ds_read_b64_tr_b16 v[82:83], v25 offset:12800
    s_waitcnt lgkmcnt(8)
    ds_read_b64_tr_b16 v[84:85], v25 offset:12304
    ds_read_b64_tr_b16 v[86:87], v25 offset:12816
    ds_read_b64_tr_b16 v[88:89], v25 offset:16384
    ds_read_b64_tr_b16 v[90:91], v25 offset:16896
    ds_read_b64_tr_b16 v[92:93], v25 offset:16400
    ds_read_b64_tr_b16 v[94:95], v25 offset:16912
    s_lshr_b32 s93, s41, 2
    s_lshl_b32 s93, s93, 3
    s_lshl_b32 s94, s3, 1
    s_add_u32 s93, s93, s94
    s_add_u32 s93, s93, 0
    s_mul_i32 s94, s93, 9363
    s_lshr_b32 s94, s94, 16
    s_mul_i32 s95, s94, 7
    s_sub_u32 s93, s93, s95
    s_mul_i32 s94, s94, 143360
    s_lshl_b32 s93, s93, 10
    s_add_u32 s93, s93, s94
    s_and_b32 s94, s41, 3
    s_mul_i32 s94, s94, 35840
    s_add_u32 s93, s93, s94
    s_add_u32 s96, s93, 0xf00000
    s_lshr_b32 s93, s41, 2
    s_lshl_b32 s93, s93, 3
    s_lshl_b32 s94, s3, 1
    s_add_u32 s93, s93, s94
    s_add_u32 s93, s93, 1
    s_mul_i32 s94, s93, 9363
    s_lshr_b32 s94, s94, 16
    s_mul_i32 s95, s94, 7
    s_sub_u32 s93, s93, s95
    s_mul_i32 s94, s94, 143360
    s_lshl_b32 s93, s93, 10
    s_add_u32 s93, s93, s94
    s_and_b32 s94, s41, 3
    s_mul_i32 s94, s94, 35840
    s_add_u32 s93, s93, s94
    s_add_u32 s97, s93, 0xf00000
    s_waitcnt lgkmcnt(0)
    buffer_store_dwordx4 v[56:59], v2, s[12:15], s96 offen sc1
    s_add_u32 s96, s96, 7168
    buffer_store_dwordx4 v[60:63], v2, s[12:15], s97 offen sc1
    s_add_u32 s97, s97, 7168
    buffer_store_dwordx4 v[64:67], v2, s[12:15], s96 offen sc1
    s_add_u32 s96, s96, 7168
    buffer_store_dwordx4 v[68:71], v2, s[12:15], s97 offen sc1
    s_add_u32 s97, s97, 7168
    buffer_store_dwordx4 v[72:75], v2, s[12:15], s96 offen sc1
    s_add_u32 s96, s96, 7168
    buffer_store_dwordx4 v[76:79], v2, s[12:15], s97 offen sc1
    s_add_u32 s97, s97, 7168
    buffer_store_dwordx4 v[80:83], v2, s[12:15], s96 offen sc1
    s_add_u32 s96, s96, 7168
    buffer_store_dwordx4 v[84:87], v2, s[12:15], s97 offen sc1
    s_add_u32 s97, s97, 7168
    buffer_store_dwordx4 v[88:91], v2, s[12:15], s96 offen sc1
    s_add_u32 s96, s96, 7168
    buffer_store_dwordx4 v[92:95], v2, s[12:15], s97 offen sc1
    s_add_u32 s97, s97, 7168
    s_waitcnt vmcnt(10)
    s_barrier
    v_bfe_u32 v25, v0, 2, 2
    v_lshl_add_u32 v25, v21, 3, v25
    v_lshlrev_b32 v25, 7, v25
    v_and_b32 v26, 1, v0
    v_lshl_add_u32 v25, v26, 3, v25
    v_bfe_u32 v26, v0, 1, 1
    v_mul_u32_u24 v26, 20480, v26
    s_lshl_b32 s93, s3, 5
    s_add_u32 s93, s93, 40960
    v_add3_u32 v25, v25, v26, s93
    ds_read_b64_tr_b16 v[96:97], v25 offset:0
    ds_read_b64_tr_b16 v[98:99], v25 offset:512
    ds_read_b64_tr_b16 v[100:101], v25 offset:16
    ds_read_b64_tr_b16 v[102:103], v25 offset:528
    ds_read_b64_tr_b16 v[104:105], v25 offset:4096
    ds_read_b64_tr_b16 v[106:107], v25 offset:4608
    ds_read_b64_tr_b16 v[108:109], v25 offset:4112
    ds_read_b64_tr_b16 v[110:111], v25 offset:4624
    ds_read_b64_tr_b16 v[112:113], v25 offset:8192
    ds_read_b64_tr_b16 v[114:115], v25 offset:8704
    ds_read_b64_tr_b16 v[116:117], v25 offset:8208
    ds_read_b64_tr_b16 v[118:119], v25 offset:8720
    ds_read_b64_tr_b16 v[120:121], v25 offset:12288
    ds_read_b64_tr_b16 v[122:123], v25 offset:12800
    s_waitcnt lgkmcnt(8)
    ds_read_b64_tr_b16 v[124:125], v25 offset:12304
    ds_read_b64_tr_b16 v[126:127], v25 offset:12816
    ds_read_b64_tr_b16 v[128:129], v25 offset:16384
    ds_read_b64_tr_b16 v[130:131], v25 offset:16896
    ds_read_b64_tr_b16 v[132:133], v25 offset:16400
    ds_read_b64_tr_b16 v[134:135], v25 offset:16912
    s_lshr_b32 s93, s31, 2
    s_lshl_b32 s93, s93, 3
    s_lshl_b32 s94, s3, 1
    s_add_u32 s93, s93, s94
    s_add_u32 s93, s93, 0
    s_mul_i32 s94, s93, 9363
    s_lshr_b32 s94, s94, 16
    s_mul_i32 s95, s94, 7
    s_sub_u32 s93, s93, s95
    s_mul_i32 s94, s94, 143360
    s_lshl_b32 s93, s93, 10
    s_add_u32 s93, s93, s94
    s_and_b32 s94, s31, 3
    s_mul_i32 s94, s94, 35840
    s_add_u32 s93, s93, s94
    s_add_u32 s96, s93, 0xf00000
    s_lshr_b32 s93, s31, 2
    s_lshl_b32 s93, s93, 3
    s_lshl_b32 s94, s3, 1
    s_add_u32 s93, s93, s94
    s_add_u32 s93, s93, 1
    s_mul_i32 s94, s93, 9363
    s_lshr_b32 s94, s94, 16
    s_mul_i32 s95, s94, 7
    s_sub_u32 s93, s93, s95
    s_mul_i32 s94, s94, 143360
    s_lshl_b32 s93, s93, 10
    s_add_u32 s93, s93, s94
    s_and_b32 s94, s31, 3
    s_mul_i32 s94, s94, 35840
    s_add_u32 s93, s93, s94
    s_add_u32 s97, s93, 0xf00000
    s_waitcnt lgkmcnt(0)
    buffer_store_dwordx4 v[96:99], v2, s[12:15], s96 offen sc1
    s_add_u32 s96, s96, 7168
    buffer_store_dwordx4 v[100:103], v2, s[12:15], s97 offen sc1
    s_add_u32 s97, s97, 7168
    buffer_store_dwordx4 v[104:107], v2, s[12:15], s96 offen sc1
    s_add_u32 s96, s96, 7168
    buffer_store_dwordx4 v[108:111], v2, s[12:15], s97 offen sc1
    s_add_u32 s97, s97, 7168
    buffer_store_dwordx4 v[112:115], v2, s[12:15], s96 offen sc1
    s_add_u32 s96, s96, 7168
    buffer_store_dwordx4 v[116:119], v2, s[12:15], s97 offen sc1
    s_add_u32 s97, s97, 7168
    buffer_store_dwordx4 v[120:123], v2, s[12:15], s96 offen sc1
    s_add_u32 s96, s96, 7168
    buffer_store_dwordx4 v[124:127], v2, s[12:15], s97 offen sc1
    s_add_u32 s97, s97, 7168
    buffer_store_dwordx4 v[128:131], v2, s[12:15], s96 offen sc1
    s_add_u32 s96, s96, 7168
    buffer_store_dwordx4 v[132:135], v2, s[12:15], s97 offen sc1
    s_add_u32 s97, s97, 7168
    s_waitcnt vmcnt(10)
    s_barrier
    s_cmp_lg_u32 s3, 0
    s_cbranch_scc1 L_noflag_21
    s_lshl_b32 s63, s41, 7
    s_add_u32 s63, s63, 0x17ba000
    s_mov_b64 exec, 1
    buffer_store_dword v19, v20, s[12:15], s63 offen sc1
    s_mov_b64 exec, -1
L_noflag_21:
L_hw1_9:
    s_waitcnt vmcnt(0)
    s_barrier
    s_cmp_lg_u32 s3, 0
    s_cbranch_scc1 L_noflag_22
    s_lshl_b32 s63, s31, 7
    s_add_u32 s63, s63, 0x17ba000
    s_mov_b64 exec, 1
    buffer_store_dword v19, v20, s[12:15], s63 offen sc1
    s_mov_b64 exec, -1
L_noflag_22:
    s_branch L_hdone_4
L_idle_5:
    s_getpc_b64 s[88:89]
L_pc_23:
    s_sub_u32 s88, s88, L_pc_23-interleave_layers__ssm_conv_h3__glu_gated_bilinear__prompt_kernel
    s_subb_u32 s89, s89, 0
    s_mov_b32 s90, L_end_1-interleave_layers__ssm_conv_h3__glu_gated_bilinear__prompt_kernel
    s_mov_b32 s91, 0x20000
    s_lshl_b32 s51, s3, 13
    v_lshlrev_b32 v24, 7, v0
    buffer_load_dword v56, v24, s[88:91], s51 offen
    s_add_u32 s51, s51, 0x8000
    buffer_load_dword v57, v24, s[88:91], s51 offen
    s_add_u32 s51, s51, 0x8000
    s_waitcnt vmcnt(0)
    v_add_u32 v19, 1, v19
    s_barrier
L_hdone_4:
    s_lshl_b32 s54, s28, 11
    v_add_u32 v244, s54, v2
    v_xor_b32 v245, 2048, v244
    v_add_u32 v246, 4096, v2
    v_lshlrev_b32 v247, 3, v13
    s_mul_i32 s51, s27, 3
    s_lshr_b32 s51, s51, 2
    s_lshl_b32 s54, s51, 12
    s_add_u32 s54, s54, 0
    s_add_u32 s64, s32, s54
    s_mul_i32 s54, s51, 10240
    s_add_u32 s54, s54, 0
    s_add_u32 s71, s60, s54
    s_add_u32 s51, s51, 1
    s_cmp_eq_u32 s51, 3
    s_cselect_b32 s51, 0, s51
    s_lshl_b32 s54, s51, 12
    s_add_u32 s54, s54, 0
    s_add_u32 s65, s32, s54
    s_mul_i32 s54, s51, 10240
    s_add_u32 s54, s54, 0
    s_add_u32 s72, s60, s54
    s_add_u32 s51, s51, 1
    s_cmp_eq_u32 s51, 3
    s_cselect_b32 s51, 0, s51
    s_lshl_b32 s54, s51, 12
    s_add_u32 s54, s54, 0
    s_add_u32 s66, s32, s54
    s_mul_i32 s54, s51, 10240
    s_add_u32 s54, s54, 0
    s_add_u32 s73, s60, s54
    s_add_u32 s51, s51, 1
    s_cmp_eq_u32 s51, 3
    s_cselect_b32 s51, 0, s51
    s_mul_i32 s51, s27, 4
    s_lshr_b32 s51, s51, 2
    s_lshl_b32 s54, s51, 12
    s_add_u32 s54, s54, 12288
    s_add_u32 s67, s32, s54
    s_mul_i32 s54, s51, 10240
    s_add_u32 s54, s54, 30720
    s_add_u32 s74, s60, s54
    s_add_u32 s51, s51, 1
    s_cmp_eq_u32 s51, 4
    s_cselect_b32 s51, 0, s51
    s_lshl_b32 s54, s51, 12
    s_add_u32 s54, s54, 12288
    s_add_u32 s68, s32, s54
    s_mul_i32 s54, s51, 10240
    s_add_u32 s54, s54, 30720
    s_add_u32 s75, s60, s54
    s_add_u32 s51, s51, 1
    s_cmp_eq_u32 s51, 4
    s_cselect_b32 s51, 0, s51
    s_lshl_b32 s54, s51, 12
    s_add_u32 s54, s54, 12288
    s_add_u32 s69, s32, s54
    s_mul_i32 s54, s51, 10240
    s_add_u32 s54, s54, 30720
    s_add_u32 s76, s60, s54
    s_add_u32 s51, s51, 1
    s_cmp_eq_u32 s51, 4
    s_cselect_b32 s51, 0, s51
    s_lshl_b32 s54, s51, 12
    s_add_u32 s54, s54, 12288
    s_add_u32 s70, s32, s54
    s_mul_i32 s54, s51, 10240
    s_add_u32 s54, s54, 30720
    s_add_u32 s77, s60, s54
    s_add_u32 s51, s51, 1
    s_cmp_eq_u32 s51, 4
    s_cselect_b32 s51, 0, s51
    s_mul_i32 s51, s25, 7
    s_add_u32 s54, s51, 6
    s_lshr_b32 s51, s51, 3
    s_lshr_b32 s54, s54, 3
    s_sub_u32 s54, s54, s51
    v_and_b32 v54, 1, v0
    v_mul_u32_u24 v54, s54, v54
    v_lshlrev_b32 v54, 2, v54
    s_lshl_b32 s51, s51, 2
    s_add_u32 s51, s51, s3
    v_lshlrev_b32 v54, 7, v54
    s_lshl_b32 s43, s51, 7
    s_add_u32 s43, s43, 0x17ba000
L_w1poll_10:
    buffer_load_dword v18, v54, s[12:15], s43 offen sc1
    s_waitcnt vmcnt(0)
L_chk_24:
    v_cmp_ne_u32 vcc, v19, v18
    s_cbranch_vccz L_ok_25
    s_cmp_eq_u32 s50, 0
    s_cbranch_scc1 L_ok_25
    s_sub_u32 s50, s50, 1
    s_sleep 1
    s_mov_b64 exec, vcc
    buffer_load_dword v18, v54, s[12:15], s43 offen sc1
    s_mov_b64 exec, -1
    s_waitcnt vmcnt(0)
    s_branch L_chk_24
L_ok_25:
    s_mul_i32 s51, s25, 143360
    s_mul_i32 s54, s3, 35840
    s_add_u32 s52, s51, 0xf00000
    s_lshr_b32 s51, s47, 3
    s_mul_i32 s51, s51, 5
    s_lshr_b32 s51, s51, 2
    s_mul_i32 s51, s51, 7168
    s_add_u32 s51, s51, s54
    s_add_u32 s61, s54, 35840
    s_mov_b32 m0, s51
    s_add_u32 s55, s52, s51
    buffer_load_dwordx4 v2, s[12:15], s55 offen offset:0 sc1 lds
    buffer_load_dwordx4 v2, s[12:15], s55 offen offset:1024 sc1 lds
    buffer_load_dwordx4 v2, s[12:15], s55 offen offset:2048 sc1 lds
    buffer_load_dwordx4 v2, s[12:15], s55 offen offset:3072 sc1 lds
    s_add_u32 m0, s51, 4096
    s_add_u32 s55, s55, 4096
    buffer_load_dwordx4 v2, s[12:15], s55 offen offset:0 sc1 lds
    buffer_load_dwordx4 v2, s[12:15], s55 offen offset:1024 sc1 lds
    buffer_load_dwordx4 v2, s[12:15], s55 offen offset:2048 sc1 lds
    s_add_u32 s51, s51, 7168
    s_cmp_eq_u32 s51, s61
    s_cselect_b32 s51, s54, s51
    s_mov_b32 s62, 4
L_dmaloop_26:
    s_mov_b32 m0, s51
    s_add_u32 s55, s52, s51
    buffer_load_dwordx4 v2, s[12:15], s55 offen offset:0 sc1 lds
    buffer_load_dwordx4 v2, s[12:15], s55 offen offset:1024 sc1 lds
    buffer_load_dwordx4 v2, s[12:15], s55 offen offset:2048 sc1 lds
    buffer_load_dwordx4 v2, s[12:15], s55 offen offset:3072 sc1 lds
    s_add_u32 m0, s51, 4096
    s_add_u32 s55, s55, 4096
    buffer_load_dwordx4 v2, s[12:15], s55 offen offset:0 sc1 lds
    buffer_load_dwordx4 v2, s[12:15], s55 offen offset:1024 sc1 lds
    buffer_load_dwordx4 v2, s[12:15], s55 offen offset:2048 sc1 lds
    s_add_u32 s51, s51, 7168
    s_cmp_eq_u32 s51, s61
    s_cselect_b32 s51, s54, s51
    s_waitcnt vmcnt(42)
    s_sub_u32 s62, s62, 1
    s_cmp_lg_u32 s62, 0
    s_cbranch_scc1 L_dmaloop_26
L_join_6:
    s_cmp_ge_u32 s3, 2
    s_cbranch_scc1 L_dma_7
    v_add_u32 v232, 0, v0
    v_min_u32 v232, 159, v232
    v_lshlrev_b32 v232, 7, v232
    v_add_u32 v233, 64, v0
    v_min_u32 v233, 159, v233
    v_lshlrev_b32 v233, 7, v233
    v_add_u32 v234, 128, v0
    v_min_u32 v234, 159, v234
    v_lshlrev_b32 v234, 7, v234
    s_lshr_b32 s7, s24, 1
    s_lshl_b32 s51, s29, 2
    s_add_u32 s7, s7, s51
    s_mul_i32 s7, s7, 20480
    s_add_u32 s7, s7, 0x1790000
    v_and_b32 v24, 3, v0
    v_lshrrev_b32 v25, 2, v0
    v_lshlrev_b32 v26, 8, v25
    v_lshl_add_u32 v26, v24, 3, v26
    v_lshrrev_b32 v27, 2, v25
    v_lshlrev_b32 v27, 11, v27
    v_and_b32 v28, 3, v25
    v_lshl_add_u32 v27, v28, 8, v27
    v_lshl_add_u32 v27, v24, 4, v27
    s_lshl_b32 s54, s3, 5
    s_add_u32 s54, s54, s53
    s_mul_i32 s54, s54, 40960
    s_bfe_u32 s55, s58, 0x10002
    s_mul_i32 s51, s55, 20480
    s_add_u32 s51, s51, s54
    s_lshl_b32 s55, s55, 10
    s_add_u32 s54, s54, s55
    s_and_b32 s55, s58, 3
    s_lshl_b32 s55, s55, 5
    s_add_u32 s51, s51, s55
    s_lshl_b32 s55, s55, 1
    s_add_u32 s54, s54, s55
    v_lshlrev_b32 v96, 16, v32
    v_and_b32 v97, 0xffff0000, v32
    v_mov_b32 v176, v96
    v_mov_b32 v177, v97
    v_pk_mul_f32 v[178:179], v[96:97], v[96:97]
    v_lshlrev_b32 v98, 16, v33
    v_and_b32 v99, 0xffff0000, v33
    v_pk_add_f32 v[176:177], v[176:177], v[98:99]
    v_pk_fma_f32 v[178:179], v[98:99], v[98:99], v[178:179]
    v_lshlrev_b32 v100, 16, v34
    v_and_b32 v101, 0xffff0000, v34
    v_pk_add_f32 v[176:177], v[176:177], v[100:101]
    v_pk_fma_f32 v[178:179], v[100:101], v[100:101], v[178:179]
    v_lshlrev_b32 v102, 16, v35
    v_and_b32 v103, 0xffff0000, v35
    v_pk_add_f32 v[176:177], v[176:177], v[102:103]
    v_pk_fma_f32 v[178:179], v[102:103], v[102:103], v[178:179]
    v_lshlrev_b32 v104, 16, v36
    v_and_b32 v105, 0xffff0000, v36
    v_pk_add_f32 v[176:177], v[176:177], v[104:105]
    v_pk_fma_f32 v[178:179], v[104:105], v[104:105], v[178:179]
    v_lshlrev_b32 v106, 16, v37
    v_and_b32 v107, 0xffff0000, v37
    v_pk_add_f32 v[176:177], v[176:177], v[106:107]
    v_pk_fma_f32 v[178:179], v[106:107], v[106:107], v[178:179]
    v_lshlrev_b32 v108, 16, v38
    v_and_b32 v109, 0xffff0000, v38
    v_pk_add_f32 v[176:177], v[176:177], v[108:109]
    v_pk_fma_f32 v[178:179], v[108:109], v[108:109], v[178:179]
    v_lshlrev_b32 v110, 16, v39
    v_and_b32 v111, 0xffff0000, v39
    v_pk_add_f32 v[176:177], v[176:177], v[110:111]
    v_pk_fma_f32 v[178:179], v[110:111], v[110:111], v[178:179]
    v_lshlrev_b32 v112, 16, v40
    v_and_b32 v113, 0xffff0000, v40
    v_pk_add_f32 v[176:177], v[176:177], v[112:113]
    v_pk_fma_f32 v[178:179], v[112:113], v[112:113], v[178:179]
    v_lshlrev_b32 v114, 16, v41
    v_and_b32 v115, 0xffff0000, v41
    v_pk_add_f32 v[176:177], v[176:177], v[114:115]
    v_pk_fma_f32 v[178:179], v[114:115], v[114:115], v[178:179]
    v_lshlrev_b32 v116, 16, v42
    v_and_b32 v117, 0xffff0000, v42
    v_pk_add_f32 v[176:177], v[176:177], v[116:117]
    v_pk_fma_f32 v[178:179], v[116:117], v[116:117], v[178:179]
    v_lshlrev_b32 v118, 16, v43
    v_and_b32 v119, 0xffff0000, v43
    v_pk_add_f32 v[176:177], v[176:177], v[118:119]
    v_pk_fma_f32 v[178:179], v[118:119], v[118:119], v[178:179]
    v_lshlrev_b32 v120, 16, v44
    v_and_b32 v121, 0xffff0000, v44
    v_pk_add_f32 v[176:177], v[176:177], v[120:121]
    v_pk_fma_f32 v[178:179], v[120:121], v[120:121], v[178:179]
    v_lshlrev_b32 v122, 16, v45
    v_and_b32 v123, 0xffff0000, v45
    v_pk_add_f32 v[176:177], v[176:177], v[122:123]
    v_pk_fma_f32 v[178:179], v[122:123], v[122:123], v[178:179]
    v_lshlrev_b32 v124, 16, v46
    v_and_b32 v125, 0xffff0000, v46
    v_pk_add_f32 v[176:177], v[176:177], v[124:125]
    v_pk_fma_f32 v[178:179], v[124:125], v[124:125], v[178:179]
    v_lshlrev_b32 v126, 16, v47
    v_and_b32 v127, 0xffff0000, v47
    v_pk_add_f32 v[176:177], v[176:177], v[126:127]
    v_pk_fma_f32 v[178:179], v[126:127], v[126:127], v[178:179]
    v_lshlrev_b32 v128, 16, v48
    v_and_b32 v129, 0xffff0000, v48
    v_pk_add_f32 v[176:177], v[176:177], v[128:129]
    v_pk_fma_f32 v[178:179], v[128:129], v[128:129], v[178:179]
    v_lshlrev_b32 v130, 16, v49
    v_and_b32 v131, 0xffff0000, v49
    v_pk_add_f32 v[176:177], v[176:177], v[130:131]
    v_pk_fma_f32 v[178:179], v[130:131], v[130:131], v[178:179]
    v_lshlrev_b32 v132, 16, v50
    v_and_b32 v133, 0xffff0000, v50
    v_pk_add_f32 v[176:177], v[176:177], v[132:133]
    v_pk_fma_f32 v[178:179], v[132:133], v[132:133], v[178:179]
    v_lshlrev_b32 v134, 16, v51
    v_and_b32 v135, 0xffff0000, v51
    v_pk_add_f32 v[176:177], v[176:177], v[134:135]
    v_pk_fma_f32 v[178:179], v[134:135], v[134:135], v[178:179]
    v_add_f32 v176, v176, v177
    v_add_f32 v178, v178, v179
    s_nop 1
    v_add_f32_dpp v176, v176, v176 row_ror:4 row_mask:0xf bank_mask:0xf
    v_add_f32_dpp v178, v178, v178 row_ror:4 row_mask:0xf bank_mask:0xf
    s_nop 0
    v_add_f32_dpp v176, v176, v176 row_ror:8 row_mask:0xf bank_mask:0xf
    v_add_f32_dpp v178, v178, v178 row_ror:8 row_mask:0xf bank_mask:0xf
    v_mov_b32 v177, v176
    v_mov_b32 v179, v178
    s_nop 0
    v_permlane16_swap_b32 v176, v177
    v_permlane16_swap_b32 v178, v179
    v_add_f32 v176, v176, v177
    v_add_f32 v178, v178, v179
    v_mov_b32 v177, v176
    v_mov_b32 v179, v178
    s_nop 0
    v_permlane32_swap_b32 v176, v177
    v_permlane32_swap_b32 v178, v179
    v_add_f32 v176, v176, v177
    v_add_f32 v178, v178, v179
    v_mul_f32 v176, 0x3acccccd, v176
    v_mul_f32 v178, 0x3acccccd, v178
    v_fma_f32 v178, -v176, v176, v178
    v_max_f32 v178, 0, v178
    v_cvt_pk_bf16_f32 v180, v176, v176
    v_lshlrev_b32 v180, 16, v180
    v_cvt_pk_bf16_f32 v177, v178, v178
    v_lshlrev_b32 v177, 16, v177
    v_add_f32 v177, 0x3727c5ac, v177
    v_cvt_pk_bf16_f32 v177, v177, v177
    v_lshlrev_b32 v177, 16, v177
    v_sqrt_f32 v177, v177
    s_nop 0
    v_cvt_pk_bf16_f32 v177, v177, v177
    v_lshlrev_b32 v177, 16, v177
    v_rcp_f32 v182, v177
    s_nop 0
    v_mul_f32 v180, -v180, v182
    v_mov_b32 v183, v182
    v_mov_b32 v181, v180
    buffer_load_dword v235, v232, s[12:15], s7 offen sc1
    buffer_load_dword v236, v233, s[12:15], s7 offen sc1
    buffer_load_dword v237, v234, s[12:15], s7 offen sc1
    v_mov_b32 v184, v181
    v_mov_b32 v185, v182
    v_lshlrev_b32 v28, 3, v0
    s_lshl_b32 s52, s24, 7
    s_lshl_b32 s61, s3, 10
    s_add_u32 s52, s52, s61
    s_lshl_b32 s61, s58, 2
    s_add_u32 s52, s52, s61
    s_lshl_b32 s52, s52, 5
    s_add_u32 s52, s52, 0x780000
    s_mov_b64 exec, 15
    buffer_store_dwordx2 v[184:185], v28, s[12:15], s52 offen sc1
    s_mov_b64 exec, -1
    v_pk_fma_f32 v[136:137], v[96:97], v[182:183], v[180:181]
    v_pk_fma_f32 v[138:139], v[98:99], v[182:183], v[180:181]
    v_pk_fma_f32 v[140:141], v[100:101], v[182:183], v[180:181]
    v_pk_fma_f32 v[142:143], v[102:103], v[182:183], v[180:181]
    v_pk_fma_f32 v[144:145], v[104:105], v[182:183], v[180:181]
    v_pk_fma_f32 v[146:147], v[106:107], v[182:183], v[180:181]
    v_pk_fma_f32 v[148:149], v[108:109], v[182:183], v[180:181]
    v_pk_fma_f32 v[150:151], v[110:111], v[182:183], v[180:181]
    v_pk_fma_f32 v[152:153], v[112:113], v[182:183], v[180:181]
    v_pk_fma_f32 v[154:155], v[114:115], v[182:183], v[180:181]
    v_pk_fma_f32 v[156:157], v[116:117], v[182:183], v[180:181]
    v_pk_fma_f32 v[158:159], v[118:119], v[182:183], v[180:181]
    v_pk_fma_f32 v[160:161], v[120:121], v[182:183], v[180:181]
    v_pk_fma_f32 v[162:163], v[122:123], v[182:183], v[180:181]
    v_pk_fma_f32 v[164:165], v[124:125], v[182:183], v[180:181]
    v_pk_fma_f32 v[166:167], v[126:127], v[182:183], v[180:181]
    v_pk_fma_f32 v[168:169], v[128:129], v[182:183], v[180:181]
    v_pk_fma_f32 v[170:171], v[130:131], v[182:183], v[180:181]
    v_pk_fma_f32 v[172:173], v[132:133], v[182:183], v[180:181]
    v_pk_fma_f32 v[174:175], v[134:135], v[182:183], v[180:181]
    s_waitcnt vmcnt(0)
L_chk_28:
    v_xor_b32 v238, v235, v19
    v_xor_b32 v239, v236, v19
    v_xor_b32 v240, v237, v19
    v_or3_b32 v238, v238, v239, v240
    v_cmp_ne_u32 vcc, 0, v238
    s_cbranch_vccz L_ok_29
    s_cmp_eq_u32 s50, 0
    s_cbranch_scc1 L_ok_29
    s_sub_u32 s50, s50, 1
    s_sleep 1
    s_mov_b64 exec, vcc
    buffer_load_dword v235, v232, s[12:15], s7 offen sc1
    buffer_load_dword v236, v233, s[12:15], s7 offen sc1
    buffer_load_dword v237, v234, s[12:15], s7 offen sc1
    s_mov_b64 exec, -1
    s_waitcnt vmcnt(0)
    s_branch L_chk_28
L_ok_29:
    s_add_u32 s55, s51, 0x500000
    buffer_load_dwordx2 v[76:77], v26, s[12:15], s55 offen offset:0 sc1
    buffer_load_dwordx2 v[78:79], v26, s[12:15], s55 offen offset:128 sc1
    s_add_u32 s55, s51, 0x501000
    buffer_load_dwordx2 v[80:81], v26, s[12:15], s55 offen offset:0 sc1
    buffer_load_dwordx2 v[82:83], v26, s[12:15], s55 offen offset:128 sc1
    s_add_u32 s55, s51, 0x502000
    buffer_load_dwordx2 v[84:85], v26, s[12:15], s55 offen offset:0 sc1
    buffer_load_dwordx2 v[86:87], v26, s[12:15], s55 offen offset:128 sc1
    s_add_u32 s55, s51, 0x503000
    buffer_load_dwordx2 v[88:89], v26, s[12:15], s55 offen offset:0 sc1
    buffer_load_dwordx2 v[90:91], v26, s[12:15], s55 offen offset:128 sc1
    s_add_u32 s55, s51, 0x504000
    buffer_load_dwordx2 v[92:93], v26, s[12:15], s55 offen offset:0 sc1
    buffer_load_dwordx2 v[94:95], v26, s[12:15], s55 offen offset:128 sc1
L_e0rest_27:
    s_waitcnt vmcnt(9)
    v_lshlrev_b32 v28, 16, v76
    v_and_b32 v29, 0xffff0000, v76
    v_pk_fma_f32 v[96:97], v[28:29], v[136:137], v[96:97]
    v_mov_b32 v176, v96
    v_mov_b32 v177, v97
    v_pk_mul_f32 v[178:179], v[96:97], v[96:97]
    v_lshlrev_b32 v30, 16, v77
    v_and_b32 v31, 0xffff0000, v77
    v_pk_fma_f32 v[98:99], v[30:31], v[138:139], v[98:99]
    v_pk_add_f32 v[176:177], v[176:177], v[98:99]
    v_pk_fma_f32 v[178:179], v[98:99], v[98:99], v[178:179]
    s_waitcnt vmcnt(8)
    v_lshlrev_b32 v28, 16, v78
    v_and_b32 v29, 0xffff0000, v78
    v_pk_fma_f32 v[100:101], v[28:29], v[140:141], v[100:101]
    v_pk_add_f32 v[176:177], v[176:177], v[100:101]
    v_pk_fma_f32 v[178:179], v[100:101], v[100:101], v[178:179]
    v_lshlrev_b32 v30, 16, v79
    v_and_b32 v31, 0xffff0000, v79
    v_pk_fma_f32 v[102:103], v[30:31], v[142:143], v[102:103]
    v_pk_add_f32 v[176:177], v[176:177], v[102:103]
    v_pk_fma_f32 v[178:179], v[102:103], v[102:103], v[178:179]
    s_waitcnt vmcnt(7)
    v_lshlrev_b32 v28, 16, v80
    v_and_b32 v29, 0xffff0000, v80
    v_pk_fma_f32 v[104:105], v[28:29], v[144:145], v[104:105]
    v_pk_add_f32 v[176:177], v[176:177], v[104:105]
    v_pk_fma_f32 v[178:179], v[104:105], v[104:105], v[178:179]
    v_lshlrev_b32 v30, 16, v81
    v_and_b32 v31, 0xffff0000, v81
    v_pk_fma_f32 v[106:107], v[30:31], v[146:147], v[106:107]
    v_pk_add_f32 v[176:177], v[176:177], v[106:107]
    v_pk_fma_f32 v[178:179], v[106:107], v[106:107], v[178:179]
    s_waitcnt vmcnt(6)
    v_lshlrev_b32 v28, 16, v82
    v_and_b32 v29, 0xffff0000, v82
    v_pk_fma_f32 v[108:109], v[28:29], v[148:149], v[108:109]
    v_pk_add_f32 v[176:177], v[176:177], v[108:109]
    v_pk_fma_f32 v[178:179], v[108:109], v[108:109], v[178:179]
    v_lshlrev_b32 v30, 16, v83
    v_and_b32 v31, 0xffff0000, v83
    v_pk_fma_f32 v[110:111], v[30:31], v[150:151], v[110:111]
    v_pk_add_f32 v[176:177], v[176:177], v[110:111]
    v_pk_fma_f32 v[178:179], v[110:111], v[110:111], v[178:179]
    s_waitcnt vmcnt(5)
    v_lshlrev_b32 v28, 16, v84
    v_and_b32 v29, 0xffff0000, v84
    v_pk_fma_f32 v[112:113], v[28:29], v[152:153], v[112:113]
    v_pk_add_f32 v[176:177], v[176:177], v[112:113]
    v_pk_fma_f32 v[178:179], v[112:113], v[112:113], v[178:179]
    v_lshlrev_b32 v30, 16, v85
    v_and_b32 v31, 0xffff0000, v85
    v_pk_fma_f32 v[114:115], v[30:31], v[154:155], v[114:115]
    v_pk_add_f32 v[176:177], v[176:177], v[114:115]
    v_pk_fma_f32 v[178:179], v[114:115], v[114:115], v[178:179]
    s_waitcnt vmcnt(4)
    v_lshlrev_b32 v28, 16, v86
    v_and_b32 v29, 0xffff0000, v86
    v_pk_fma_f32 v[116:117], v[28:29], v[156:157], v[116:117]
    v_pk_add_f32 v[176:177], v[176:177], v[116:117]
    v_pk_fma_f32 v[178:179], v[116:117], v[116:117], v[178:179]
    v_lshlrev_b32 v30, 16, v87
    v_and_b32 v31, 0xffff0000, v87
    v_pk_fma_f32 v[118:119], v[30:31], v[158:159], v[118:119]
    v_pk_add_f32 v[176:177], v[176:177], v[118:119]
    v_pk_fma_f32 v[178:179], v[118:119], v[118:119], v[178:179]
    s_waitcnt vmcnt(3)
    v_lshlrev_b32 v28, 16, v88
    v_and_b32 v29, 0xffff0000, v88
    v_pk_fma_f32 v[120:121], v[28:29], v[160:161], v[120:121]
    v_pk_add_f32 v[176:177], v[176:177], v[120:121]
    v_pk_fma_f32 v[178:179], v[120:121], v[120:121], v[178:179]
    v_lshlrev_b32 v30, 16, v89
    v_and_b32 v31, 0xffff0000, v89
    v_pk_fma_f32 v[122:123], v[30:31], v[162:163], v[122:123]
    v_pk_add_f32 v[176:177], v[176:177], v[122:123]
    v_pk_fma_f32 v[178:179], v[122:123], v[122:123], v[178:179]
    s_waitcnt vmcnt(2)
    v_lshlrev_b32 v28, 16, v90
    v_and_b32 v29, 0xffff0000, v90
    v_pk_fma_f32 v[124:125], v[28:29], v[164:165], v[124:125]
    v_pk_add_f32 v[176:177], v[176:177], v[124:125]
    v_pk_fma_f32 v[178:179], v[124:125], v[124:125], v[178:179]
    v_lshlrev_b32 v30, 16, v91
    v_and_b32 v31, 0xffff0000, v91
    v_pk_fma_f32 v[126:127], v[30:31], v[166:167], v[126:127]
    v_pk_add_f32 v[176:177], v[176:177], v[126:127]
    v_pk_fma_f32 v[178:179], v[126:127], v[126:127], v[178:179]
    s_waitcnt vmcnt(1)
    v_lshlrev_b32 v28, 16, v92
    v_and_b32 v29, 0xffff0000, v92
    v_pk_fma_f32 v[128:129], v[28:29], v[168:169], v[128:129]
    v_pk_add_f32 v[176:177], v[176:177], v[128:129]
    v_pk_fma_f32 v[178:179], v[128:129], v[128:129], v[178:179]
    v_lshlrev_b32 v30, 16, v93
    v_and_b32 v31, 0xffff0000, v93
    v_pk_fma_f32 v[130:131], v[30:31], v[170:171], v[130:131]
    v_pk_add_f32 v[176:177], v[176:177], v[130:131]
    v_pk_fma_f32 v[178:179], v[130:131], v[130:131], v[178:179]
    s_waitcnt vmcnt(0)
    v_lshlrev_b32 v28, 16, v94
    v_and_b32 v29, 0xffff0000, v94
    v_pk_fma_f32 v[132:133], v[28:29], v[172:173], v[132:133]
    v_pk_add_f32 v[176:177], v[176:177], v[132:133]
    v_pk_fma_f32 v[178:179], v[132:133], v[132:133], v[178:179]
    v_lshlrev_b32 v30, 16, v95
    v_and_b32 v31, 0xffff0000, v95
    v_pk_fma_f32 v[134:135], v[30:31], v[174:175], v[134:135]
    v_pk_add_f32 v[176:177], v[176:177], v[134:135]
    v_pk_fma_f32 v[178:179], v[134:135], v[134:135], v[178:179]
    v_add_f32 v176, v176, v177
    v_add_f32 v178, v178, v179
    s_nop 1
    v_add_f32_dpp v176, v176, v176 row_ror:4 row_mask:0xf bank_mask:0xf
    v_add_f32_dpp v178, v178, v178 row_ror:4 row_mask:0xf bank_mask:0xf
    s_nop 0
    v_add_f32_dpp v176, v176, v176 row_ror:8 row_mask:0xf bank_mask:0xf
    v_add_f32_dpp v178, v178, v178 row_ror:8 row_mask:0xf bank_mask:0xf
    v_mov_b32 v177, v176
    v_mov_b32 v179, v178
    s_nop 0
    v_permlane16_swap_b32 v176, v177
    v_permlane16_swap_b32 v178, v179
    v_add_f32 v176, v176, v177
    v_add_f32 v178, v178, v179
    v_mov_b32 v177, v176
    v_mov_b32 v179, v178
    s_nop 0
    v_permlane32_swap_b32 v176, v177
    v_permlane32_swap_b32 v178, v179
    v_add_f32 v176, v176, v177
    v_add_f32 v178, v178, v179
    v_mul_f32 v176, 0x3acccccd, v176
    v_mul_f32 v178, 0x3acccccd, v178
    v_fma_f32 v178, -v176, v176, v178
    v_max_f32 v178, 0, v178
    v_cvt_pk_bf16_f32 v180, v176, v176
    v_lshlrev_b32 v180, 16, v180
    v_cvt_pk_bf16_f32 v177, v178, v178
    v_lshlrev_b32 v177, 16, v177
    v_add_f32 v177, 0x3727c5ac, v177
    v_cvt_pk_bf16_f32 v177, v177, v177
    v_lshlrev_b32 v177, 16, v177
    v_sqrt_f32 v177, v177
    s_nop 0
    v_cvt_pk_bf16_f32 v177, v177, v177
    v_lshlrev_b32 v177, 16, v177
    v_rcp_f32 v182, v177
    s_nop 0
    v_mul_f32 v180, -v180, v182
    v_mov_b32 v183, v182
    v_mov_b32 v181, v180
    v_pk_fma_f32 v[136:137], v[96:97], v[182:183], v[180:181]
    v_cvt_pk_bf16_f32 v76, v136, v137
    v_pk_fma_f32 v[138:139], v[98:99], v[182:183], v[180:181]
    v_cvt_pk_bf16_f32 v77, v138, v139
    v_pk_fma_f32 v[140:141], v[100:101], v[182:183], v[180:181]
    v_cvt_pk_bf16_f32 v78, v140, v141
    v_pk_fma_f32 v[142:143], v[102:103], v[182:183], v[180:181]
    v_cvt_pk_bf16_f32 v79, v142, v143
    s_add_u32 s55, s54, 0xa00000
    buffer_store_dwordx4 v[76:79], v27, s[12:15], s55 offen sc1
    v_pk_fma_f32 v[144:145], v[104:105], v[182:183], v[180:181]
    v_cvt_pk_bf16_f32 v80, v144, v145
    v_pk_fma_f32 v[146:147], v[106:107], v[182:183], v[180:181]
    v_cvt_pk_bf16_f32 v81, v146, v147
    v_pk_fma_f32 v[148:149], v[108:109], v[182:183], v[180:181]
    v_cvt_pk_bf16_f32 v82, v148, v149
    v_pk_fma_f32 v[150:151], v[110:111], v[182:183], v[180:181]
    v_cvt_pk_bf16_f32 v83, v150, v151
    s_add_u32 s55, s54, 0xa02000
    buffer_store_dwordx4 v[80:83], v27, s[12:15], s55 offen sc1
    v_pk_fma_f32 v[152:153], v[112:113], v[182:183], v[180:181]
    v_cvt_pk_bf16_f32 v84, v152, v153
    v_pk_fma_f32 v[154:155], v[114:115], v[182:183], v[180:181]
    v_cvt_pk_bf16_f32 v85, v154, v155
    v_pk_fma_f32 v[156:157], v[116:117], v[182:183], v[180:181]
    v_cvt_pk_bf16_f32 v86, v156, v157
    v_pk_fma_f32 v[158:159], v[118:119], v[182:183], v[180:181]
    v_cvt_pk_bf16_f32 v87, v158, v159
    s_add_u32 s55, s54, 0xa04000
    buffer_store_dwordx4 v[84:87], v27, s[12:15], s55 offen sc1
    v_pk_fma_f32 v[160:161], v[120:121], v[182:183], v[180:181]
    v_cvt_pk_bf16_f32 v88, v160, v161
    v_pk_fma_f32 v[162:163], v[122:123], v[182:183], v[180:181]
    v_cvt_pk_bf16_f32 v89, v162, v163
    v_pk_fma_f32 v[164:165], v[124:125], v[182:183], v[180:181]
    v_cvt_pk_bf16_f32 v90, v164, v165
    v_pk_fma_f32 v[166:167], v[126:127], v[182:183], v[180:181]
    v_cvt_pk_bf16_f32 v91, v166, v167
    s_add_u32 s55, s54, 0xa06000
    buffer_store_dwordx4 v[88:91], v27, s[12:15], s55 offen sc1
    v_pk_fma_f32 v[168:169], v[128:129], v[182:183], v[180:181]
    v_cvt_pk_bf16_f32 v92, v168, v169
    v_pk_fma_f32 v[170:171], v[130:131], v[182:183], v[180:181]
    v_cvt_pk_bf16_f32 v93, v170, v171
    v_pk_fma_f32 v[172:173], v[132:133], v[182:183], v[180:181]
    v_cvt_pk_bf16_f32 v94, v172, v173
    v_pk_fma_f32 v[174:175], v[134:135], v[182:183], v[180:181]
    v_cvt_pk_bf16_f32 v95, v174, v175
    s_add_u32 s55, s54, 0xa08000
    buffer_store_dwordx4 v[92:95], v27, s[12:15], s55 offen sc1
    s_lshl_b32 s63, s3, 17
    s_add_u32 s63, s63, s42
    s_add_u32 s63, s63, 0x1690000
    s_waitcnt vmcnt(0)
    s_mov_b64 exec, 1
    buffer_store_dword v19, v20, s[12:15], s63 offen sc1
    s_mov_b64 exec, -1
    s_barrier
    s_branch L_go_8
L_dma_7:
    v_mul_u32_u24 v24, 205, v0
    v_lshrrev_b32 v24, 11, v24
    v_mul_u32_u24 v25, 10, v24
    v_sub_u32 v25, v0, v25
    v_mul_u32_u24 v24, 1280, v24
    v_lshl_add_u32 v24, v25, 4, v24
    s_lshl_b32 s51, s29, 5
    s_add_u32 s51, s51, s53
    s_mul_i32 s51, s51, 40960
    s_mul_i32 s54, s26, 160
    s_add_u32 s51, s51, s54
    v_add_u32 v24, s51, v24
    s_mul_i32 s54, s29, 6144
    s_add_u32 m0, s54, 143360
    s_nop 0
    buffer_load_dwordx4 v24, s[16:19], 0 offen lds
    v_add_u32 v24, 7680, v24
    s_add_u32 m0, s54, 144320
    s_nop 0
    buffer_load_dwordx4 v24, s[16:19], 0 offen lds
    v_add_u32 v24, 7680, v24
    s_add_u32 m0, s54, 145280
    s_nop 0
    buffer_load_dwordx4 v24, s[16:19], 0 offen lds
    v_add_u32 v24, 7680, v24
    s_add_u32 m0, s54, 146240
    s_nop 0
    buffer_load_dwordx4 v24, s[16:19], 0 offen lds
    v_add_u32 v24, 7680, v24
    s_add_u32 m0, s54, 147200
    s_nop 0
    buffer_load_dwordx4 v24, s[16:19], 0 offen lds
    v_add_u32 v24, 7680, v24
    s_add_u32 m0, s54, 148160
    s_nop 0
    buffer_load_dwordx4 v24, s[16:19], 0 offen lds
    v_add_u32 v24, 7680, v24
    s_waitcnt vmcnt(29)
    buffer_load_dword v18, v247, s[12:15], s37 offen sc1
    s_waitcnt vmcnt(0)
L_chk_30:
    v_cmp_ne_u32 vcc, v19, v18
    s_cbranch_vccz L_ok_31
    s_cmp_eq_u32 s50, 0
    s_cbranch_scc1 L_ok_31
    s_sub_u32 s50, s50, 1
    s_sleep 1
    s_mov_b64 exec, vcc
    buffer_load_dword v18, v247, s[12:15], s37 offen sc1
    s_mov_b64 exec, -1
    s_waitcnt vmcnt(0)
    s_branch L_chk_30
L_ok_31:
    s_barrier
L_go_8:
    buffer_load_dwordx4 a[0:3], v244, s[12:15], s71 offen offset:0 sc1
    buffer_load_dwordx4 a[4:7], v244, s[12:15], s71 offen offset:1024 sc1
    buffer_load_dwordx4 a[8:11], v245, s[12:15], s71 offen offset:0 sc1
    buffer_load_dwordx4 a[12:15], v245, s[12:15], s71 offen offset:1024 sc1
    buffer_load_dwordx4 a[16:19], v246, s[12:15], s71 offen offset:0 sc1
    s_add_u32 s71, s71, 5120
    buffer_load_dwordx4 a[20:23], v244, s[12:15], s71 offen offset:0 sc1
    buffer_load_dwordx4 a[24:27], v244, s[12:15], s71 offen offset:1024 sc1
    buffer_load_dwordx4 a[28:31], v245, s[12:15], s71 offen offset:0 sc1
    buffer_load_dwordx4 a[32:35], v245, s[12:15], s71 offen offset:1024 sc1
    buffer_load_dwordx4 a[36:39], v246, s[12:15], s71 offen offset:0 sc1
    buffer_load_dwordx4 a[40:43], v244, s[12:15], s72 offen offset:0 sc1
    buffer_load_dwordx4 a[44:47], v244, s[12:15], s72 offen offset:1024 sc1
    buffer_load_dwordx4 a[48:51], v245, s[12:15], s72 offen offset:0 sc1
    buffer_load_dwordx4 a[52:55], v245, s[12:15], s72 offen offset:1024 sc1
    buffer_load_dwordx4 a[56:59], v246, s[12:15], s72 offen offset:0 sc1
    s_add_u32 s72, s72, 5120
    buffer_load_dwordx4 a[60:63], v244, s[12:15], s72 offen offset:0 sc1
    buffer_load_dwordx4 a[64:67], v244, s[12:15], s72 offen offset:1024 sc1
    buffer_load_dwordx4 a[68:71], v245, s[12:15], s72 offen offset:0 sc1
    buffer_load_dwordx4 a[72:75], v245, s[12:15], s72 offen offset:1024 sc1
    buffer_load_dwordx4 a[76:79], v246, s[12:15], s72 offen offset:0 sc1
    s_mul_i32 s51, s26, 10
    s_lshl_b32 s54, s28, 2
    s_add_u32 s54, s54, s51
    v_add_u32 v24, s54, v21
    v_lshlrev_b32 v24, 8, v24
    v_lshl_add_u32 v24, v22, 3, v24
    s_lshl_b32 s51, s51, 1
    s_add_u32 s51, s51, 16
    v_add_u32 v25, s51, v21
    v_lshlrev_b32 v25, 7, v25
    v_lshl_add_u32 v25, v22, 3, v25
    v_and_b32 v12, 3, v22
    v_lshlrev_b32 v12, 3, v12
    v_lshrrev_b32 v21, 2, v22
    v_lshl_add_u32 v12, v21, 7, v12
    s_lshl_b32 s51, s39, 4
    v_add_u32 v26, s51, v22
    v_mul_u32_u24 v26, 160, v26
    v_add_u32 v26, 143360, v26
    v_lshrrev_b32 v28, 4, v0
    v_lshl_add_u32 v27, v28, 3, v26
    v_lshl_add_u32 v26, v28, 4, v26
    s_lshl_b32 s51, s28, 6
    v_add_u32 v26, s51, v26
    v_mov_b32 v224, 0
    v_mov_b32 v225, 0
    ds_read_b128 v[220:223], v26 offset:0
    s_mov_b64 exec, s[56:57]
    ds_read_b64 v[224:225], v27 offset:128
    s_mov_b64 exec, -1
    v_mov_b32 v230, 0
    v_mov_b32 v231, 0
    ds_read_b128 v[226:229], v26 offset:6144
    s_mov_b64 exec, s[56:57]
    ds_read_b64 v[230:231], v27 offset:6272
    s_mov_b64 exec, -1
    v_mov_b32 v22, v24
    v_mov_b32 v23, v25
    v_and_b32 v21, 0x31, v0
    v_bfe_u32 v3, v0, 2, 2
    v_lshl_add_u32 v21, v3, 1, v21
    v_and_b32 v3, 2, v0
    v_lshl_add_u32 v21, v3, 2, v21
    v_lshlrev_b32 v21, 4, v21
    v_add_u32 v3, 0x10000, v21
    v_add_u32 v4, 0x20000, v21
    v_mov_b32 v236, 0
    v_mov_b32 v237, 0
    v_mov_b32 v242, 0
    v_mov_b32 v243, 0
    ds_read_b128 v[192:195], v21 offset:0
    ds_read_b128 v[196:199], v21 offset:1024
    ds_read_b128 v[200:203], v21 offset:2048
    ds_read_b128 v[204:207], v21 offset:3072
    ds_read_b128 v[208:211], v21 offset:4096
    ds_read_b128 v[212:215], v21 offset:5120
    ds_read_b128 v[216:219], v21 offset:6144
    s_add_u32 s55, s40, 0x1690000
    buffer_load_dword v18, v13, s[12:15], s55 offen sc1
    buffer_load_dwordx4 a[80:83], v244, s[12:15], s73 offen offset:0 sc1
    buffer_load_dwordx4 a[84:87], v244, s[12:15], s73 offen offset:1024 sc1
    buffer_load_dwordx4 a[88:91], v245, s[12:15], s73 offen offset:0 sc1
    buffer_load_dwordx4 a[92:95], v245, s[12:15], s73 offen offset:1024 sc1
    buffer_load_dwordx4 a[96:99], v246, s[12:15], s73 offen offset:0 sc1
    s_add_u32 s73, s73, 5120
    buffer_load_dwordx4 a[100:103], v244, s[12:15], s73 offen offset:0 sc1
    buffer_load_dwordx4 a[104:107], v244, s[12:15], s73 offen offset:1024 sc1
    buffer_load_dwordx4 a[108:111], v245, s[12:15], s73 offen offset:0 sc1
    buffer_load_dwordx4 a[112:115], v245, s[12:15], s73 offen offset:1024 sc1
    buffer_load_dwordx4 a[116:119], v246, s[12:15], s73 offen offset:0 sc1
    s_waitcnt vmcnt(10)
L_chk_32:
    v_cmp_ne_u32 vcc, v19, v18
    s_cbranch_vccz L_ok_33
    s_cmp_eq_u32 s50, 0
    s_cbranch_scc1 L_ok_33
    s_sub_u32 s50, s50, 1
    s_sleep 1
    s_mov_b64 exec, vcc
    s_add_u32 s55, s40, 0x1690000
    buffer_load_dword v18, v13, s[12:15], s55 offen sc1
    s_mov_b64 exec, -1
    s_waitcnt vmcnt(0)
    s_branch L_chk_32
L_ok_33:
    s_add_u32 s52, s30, 0xa00000
    buffer_load_dwordx4 v[56:59], v2, s[12:15], s52 offen offset:0 sc1
    buffer_load_dwordx4 v[60:63], v2, s[12:15], s52 offen offset:1024 sc1
    buffer_load_dwordx4 v[64:67], v2, s[12:15], s52 offen offset:2048 sc1
    buffer_load_dwordx4 v[68:71], v2, s[12:15], s52 offen offset:3072 sc1
    s_add_u32 s52, s30, 0xa01000
    buffer_load_dwordx4 v[72:75], v2, s[12:15], s52 offen offset:0 sc1
    buffer_load_dwordx4 v[76:79], v2, s[12:15], s52 offen offset:1024 sc1
    buffer_load_dwordx4 v[80:83], v2, s[12:15], s52 offen offset:2048 sc1
    buffer_load_dwordx4 v[84:87], v2, s[12:15], s52 offen offset:3072 sc1
    s_add_u32 s52, s30, 0xa02000
    buffer_load_dwordx4 v[88:91], v2, s[12:15], s52 offen offset:0 sc1
    buffer_load_dwordx4 v[92:95], v2, s[12:15], s52 offen offset:1024 sc1
    buffer_load_dwordx4 v[96:99], v2, s[12:15], s52 offen offset:2048 sc1
    buffer_load_dwordx4 v[100:103], v2, s[12:15], s52 offen offset:3072 sc1
    s_add_u32 s52, s30, 0xa03000
    buffer_load_dwordx4 v[104:107], v2, s[12:15], s52 offen offset:0 sc1
    buffer_load_dwordx4 v[108:111], v2, s[12:15], s52 offen offset:1024 sc1
    buffer_load_dwordx4 v[112:115], v2, s[12:15], s52 offen offset:2048 sc1
    buffer_load_dwordx4 v[116:119], v2, s[12:15], s52 offen offset:3072 sc1
    s_add_u32 s52, s30, 0xa04000
    buffer_load_dwordx4 v[120:123], v2, s[12:15], s52 offen offset:0 sc1
    buffer_load_dwordx4 v[124:127], v2, s[12:15], s52 offen offset:1024 sc1
    buffer_load_dwordx4 v[128:131], v2, s[12:15], s52 offen offset:2048 sc1
    buffer_load_dwordx4 v[132:135], v2, s[12:15], s52 offen offset:3072 sc1
    s_waitcnt vmcnt(18)
    s_waitcnt lgkmcnt(6)
    v_mfma_f32_16x16x32_bf16 v[136:139], v[192:195], v[56:59], 0
    s_waitcnt lgkmcnt(5)
    buffer_load_dwordx4 a[120:123], v244, s[12:15], s74 offen offset:0 sc1
    v_mfma_f32_16x16x32_bf16 v[140:143], v[192:195], v[60:63], 0
    ds_read_b128 v[192:195], v21 offset:7168
    v_mfma_f32_16x16x32_bf16 v[148:151], v[196:199], v[60:63], 0
    s_waitcnt lgkmcnt(5)
    v_mfma_f32_16x16x32_bf16 v[144:147], v[196:199], v[56:59], 0
    ds_read_b128 v[196:199], v21 offset:8192
    v_mfma_f32_16x16x32_bf16 v[152:155], v[200:203], v[56:59], 0
    s_waitcnt lgkmcnt(5)
    v_mfma_f32_16x16x32_bf16 v[156:159], v[200:203], v[60:63], 0
    ds_read_b128 v[200:203], v21 offset:9216
    v_mfma_f32_16x16x32_bf16 v[164:167], v[204:207], v[60:63], 0
    s_waitcnt lgkmcnt(5)
    v_mfma_f32_16x16x32_bf16 v[160:163], v[204:207], v[56:59], 0
    ds_read_b128 v[204:207], v21 offset:10240
    v_mfma_f32_16x16x32_bf16 v[168:171], v[208:211], v[56:59], 0
    s_waitcnt lgkmcnt(5)
    v_mfma_f32_16x16x32_bf16 v[172:175], v[208:211], v[60:63], 0
    ds_read_b128 v[208:211], v21 offset:11264
    v_mfma_f32_16x16x32_bf16 v[180:183], v[212:215], v[60:63], 0
    s_waitcnt lgkmcnt(5)
    v_mfma_f32_16x16x32_bf16 v[176:179], v[212:215], v[56:59], 0
    ds_read_b128 v[212:215], v21 offset:12288
    v_mfma_f32_16x16x32_bf16 v[184:187], v[216:219], v[56:59], 0
    s_waitcnt lgkmcnt(5)
    v_mfma_f32_16x16x32_bf16 v[188:191], v[216:219], v[60:63], 0
    ds_read_b128 v[216:219], v21 offset:13312
    s_waitcnt vmcnt(17)
    v_mfma_f32_16x16x32_bf16 v[136:139], v[192:195], v[64:67], v[136:139]
    s_waitcnt lgkmcnt(5)
    buffer_load_dwordx4 a[124:127], v244, s[12:15], s74 offen offset:1024 sc1
    v_mfma_f32_16x16x32_bf16 v[140:143], v[192:195], v[68:71], v[140:143]
    ds_read_b128 v[192:195], v21 offset:14336
    s_add_u32 s52, s30, 0xa05000
    v_mfma_f32_16x16x32_bf16 v[148:151], v[196:199], v[68:71], v[148:151]
    s_waitcnt lgkmcnt(5)
    buffer_load_dwordx4 v[56:59], v2, s[12:15], s52 offen offset:0 sc1
    v_mfma_f32_16x16x32_bf16 v[144:147], v[196:199], v[64:67], v[144:147]
    ds_read_b128 v[196:199], v21 offset:15360
    v_mfma_f32_16x16x32_bf16 v[152:155], v[200:203], v[64:67], v[152:155]
    s_waitcnt lgkmcnt(5)
    v_mfma_f32_16x16x32_bf16 v[156:159], v[200:203], v[68:71], v[156:159]
    ds_read_b128 v[200:203], v21 offset:16384
    v_mfma_f32_16x16x32_bf16 v[164:167], v[204:207], v[68:71], v[164:167]
    s_waitcnt lgkmcnt(5)
    buffer_load_dwordx4 v[60:63], v2, s[12:15], s52 offen offset:1024 sc1
    v_mfma_f32_16x16x32_bf16 v[160:163], v[204:207], v[64:67], v[160:163]
    ds_read_b128 v[204:207], v21 offset:17408
    v_mfma_f32_16x16x32_bf16 v[168:171], v[208:211], v[64:67], v[168:171]
    s_waitcnt lgkmcnt(5)
    v_mfma_f32_16x16x32_bf16 v[172:175], v[208:211], v[68:71], v[172:175]
    ds_read_b128 v[208:211], v21 offset:18432
    v_mfma_f32_16x16x32_bf16 v[180:183], v[212:215], v[68:71], v[180:183]
    s_waitcnt lgkmcnt(5)
    v_mfma_f32_16x16x32_bf16 v[176:179], v[212:215], v[64:67], v[176:179]
    ds_read_b128 v[212:215], v21 offset:19456
    v_mfma_f32_16x16x32_bf16 v[184:187], v[216:219], v[64:67], v[184:187]
    s_waitcnt lgkmcnt(5)
    v_mfma_f32_16x16x32_bf16 v[188:191], v[216:219], v[68:71], v[188:191]
    ds_read_b128 v[216:219], v21 offset:20480
    s_waitcnt vmcnt(18)
    v_mfma_f32_16x16x32_bf16 v[136:139], v[192:195], v[72:75], v[136:139]
    s_waitcnt lgkmcnt(5)
    buffer_load_dwordx4 a[128:131], v245, s[12:15], s74 offen offset:0 sc1
    v_mfma_f32_16x16x32_bf16 v[140:143], v[192:195], v[76:79], v[140:143]
    ds_read_b128 v[192:195], v21 offset:21504
    v_mfma_f32_16x16x32_bf16 v[148:151], v[196:199], v[76:79], v[148:151]
    s_waitcnt lgkmcnt(5)
    buffer_load_dwordx4 v[64:67], v2, s[12:15], s52 offen offset:2048 sc1
    v_mfma_f32_16x16x32_bf16 v[144:147], v[196:199], v[72:75], v[144:147]
    ds_read_b128 v[196:199], v21 offset:22528
    v_mfma_f32_16x16x32_bf16 v[152:155], v[200:203], v[72:75], v[152:155]
    s_waitcnt lgkmcnt(5)
    v_mfma_f32_16x16x32_bf16 v[156:159], v[200:203], v[76:79], v[156:159]
    ds_read_b128 v[200:203], v21 offset:23552
    v_mfma_f32_16x16x32_bf16 v[164:167], v[204:207], v[76:79], v[164:167]
    s_waitcnt lgkmcnt(5)
    buffer_load_dwordx4 v[68:71], v2, s[12:15], s52 offen offset:3072 sc1
    v_mfma_f32_16x16x32_bf16 v[160:163], v[204:207], v[72:75], v[160:163]
    ds_read_b128 v[204:207], v21 offset:24576
    v_mfma_f32_16x16x32_bf16 v[168:171], v[208:211], v[72:75], v[168:171]
    s_waitcnt lgkmcnt(5)
    v_mfma_f32_16x16x32_bf16 v[172:175], v[208:211], v[76:79], v[172:175]
    ds_read_b128 v[208:211], v21 offset:25600
    v_mfma_f32_16x16x32_bf16 v[180:183], v[212:215], v[76:79], v[180:183]
    s_waitcnt lgkmcnt(5)
    v_mfma_f32_16x16x32_bf16 v[176:179], v[212:215], v[72:75], v[176:179]
    ds_read_b128 v[212:215], v21 offset:26624
    v_mfma_f32_16x16x32_bf16 v[184:187], v[216:219], v[72:75], v[184:187]
    s_waitcnt lgkmcnt(5)
    v_mfma_f32_16x16x32_bf16 v[188:191], v[216:219], v[76:79], v[188:191]
    ds_read_b128 v[216:219], v21 offset:27648
    s_waitcnt vmcnt(19)
    v_mfma_f32_16x16x32_bf16 v[136:139], v[192:195], v[80:83], v[136:139]
    s_waitcnt lgkmcnt(5)
    buffer_load_dwordx4 a[132:135], v245, s[12:15], s74 offen offset:1024 sc1
    v_mfma_f32_16x16x32_bf16 v[140:143], v[192:195], v[84:87], v[140:143]
    ds_read_b128 v[192:195], v21 offset:28672
    s_add_u32 s52, s30, 0xa06000
    v_mfma_f32_16x16x32_bf16 v[148:151], v[196:199], v[84:87], v[148:151]
    s_waitcnt lgkmcnt(5)
    buffer_load_dwordx4 v[72:75], v2, s[12:15], s52 offen offset:0 sc1
    v_mfma_f32_16x16x32_bf16 v[144:147], v[196:199], v[80:83], v[144:147]
    ds_read_b128 v[196:199], v21 offset:29696
    v_mfma_f32_16x16x32_bf16 v[152:155], v[200:203], v[80:83], v[152:155]
    s_waitcnt lgkmcnt(5)
    v_mfma_f32_16x16x32_bf16 v[156:159], v[200:203], v[84:87], v[156:159]
    ds_read_b128 v[200:203], v21 offset:30720
    v_mfma_f32_16x16x32_bf16 v[164:167], v[204:207], v[84:87], v[164:167]
    s_waitcnt lgkmcnt(5)
    buffer_load_dwordx4 v[76:79], v2, s[12:15], s52 offen offset:1024 sc1
    v_mfma_f32_16x16x32_bf16 v[160:163], v[204:207], v[80:83], v[160:163]
    ds_read_b128 v[204:207], v21 offset:31744
    v_mfma_f32_16x16x32_bf16 v[168:171], v[208:211], v[80:83], v[168:171]
    s_waitcnt lgkmcnt(5)
    v_mfma_f32_16x16x32_bf16 v[172:175], v[208:211], v[84:87], v[172:175]
    ds_read_b128 v[208:211], v21 offset:32768
    v_mfma_f32_16x16x32_bf16 v[180:183], v[212:215], v[84:87], v[180:183]
    s_waitcnt lgkmcnt(5)
    v_mfma_f32_16x16x32_bf16 v[176:179], v[212:215], v[80:83], v[176:179]
    ds_read_b128 v[212:215], v21 offset:33792
    v_mfma_f32_16x16x32_bf16 v[184:187], v[216:219], v[80:83], v[184:187]
    s_waitcnt lgkmcnt(5)
    v_mfma_f32_16x16x32_bf16 v[188:191], v[216:219], v[84:87], v[188:191]
    ds_read_b128 v[216:219], v21 offset:34816
    s_waitcnt vmcnt(20)
    v_mfma_f32_16x16x32_bf16 v[136:139], v[192:195], v[88:91], v[136:139]
    s_waitcnt lgkmcnt(5)
    buffer_load_dwordx4 a[136:139], v246, s[12:15], s74 offen offset:0 sc1
    s_add_u32 s74, s74, 5120
    v_mfma_f32_16x16x32_bf16 v[140:143], v[192:195], v[92:95], v[140:143]
    ds_read_b128 v[192:195], v21 offset:35840
    v_mfma_f32_16x16x32_bf16 v[148:151], v[196:199], v[92:95], v[148:151]
    s_waitcnt lgkmcnt(5)
    buffer_load_dwordx4 v[80:83], v2, s[12:15], s52 offen offset:2048 sc1
    v_mfma_f32_16x16x32_bf16 v[144:147], v[196:199], v[88:91], v[144:147]
    ds_read_b128 v[196:199], v21 offset:36864
    v_mfma_f32_16x16x32_bf16 v[152:155], v[200:203], v[88:91], v[152:155]
    s_waitcnt lgkmcnt(5)
    v_mfma_f32_16x16x32_bf16 v[156:159], v[200:203], v[92:95], v[156:159]
    ds_read_b128 v[200:203], v21 offset:37888
    v_mfma_f32_16x16x32_bf16 v[164:167], v[204:207], v[92:95], v[164:167]
    s_waitcnt lgkmcnt(5)
    buffer_load_dwordx4 v[84:87], v2, s[12:15], s52 offen offset:3072 sc1
    v_mfma_f32_16x16x32_bf16 v[160:163], v[204:207], v[88:91], v[160:163]
    ds_read_b128 v[204:207], v21 offset:38912
    v_mfma_f32_16x16x32_bf16 v[168:171], v[208:211], v[88:91], v[168:171]
    s_waitcnt lgkmcnt(5)
    v_mfma_f32_16x16x32_bf16 v[172:175], v[208:211], v[92:95], v[172:175]
    ds_read_b128 v[208:211], v21 offset:39936
    v_mfma_f32_16x16x32_bf16 v[180:183], v[212:215], v[92:95], v[180:183]
    s_waitcnt lgkmcnt(5)
    v_mfma_f32_16x16x32_bf16 v[176:179], v[212:215], v[88:91], v[176:179]
    ds_read_b128 v[212:215], v21 offset:40960
    v_mfma_f32_16x16x32_bf16 v[184:187], v[216:219], v[88:91], v[184:187]
    s_waitcnt lgkmcnt(5)
    v_mfma_f32_16x16x32_bf16 v[188:191], v[216:219], v[92:95], v[188:191]
    ds_read_b128 v[216:219], v21 offset:41984
    s_waitcnt vmcnt(21)
    v_mfma_f32_16x16x32_bf16 v[136:139], v[192:195], v[96:99], v[136:139]
    s_waitcnt lgkmcnt(5)
    buffer_load_dwordx4 a[140:143], v244, s[12:15], s74 offen offset:0 sc1
    v_mfma_f32_16x16x32_bf16 v[140:143], v[192:195], v[100:103], v[140:143]
    ds_read_b128 v[192:195], v21 offset:43008
    s_add_u32 s52, s30, 0xa07000
    v_mfma_f32_16x16x32_bf16 v[148:151], v[196:199], v[100:103], v[148:151]
    s_waitcnt lgkmcnt(5)
    buffer_load_dwordx4 v[88:91], v2, s[12:15], s52 offen offset:0 sc1
    v_mfma_f32_16x16x32_bf16 v[144:147], v[196:199], v[96:99], v[144:147]
    ds_read_b128 v[196:199], v21 offset:44032
    v_mfma_f32_16x16x32_bf16 v[152:155], v[200:203], v[96:99], v[152:155]
    s_waitcnt lgkmcnt(5)
    v_mfma_f32_16x16x32_bf16 v[156:159], v[200:203], v[100:103], v[156:159]
    ds_read_b128 v[200:203], v21 offset:45056
    v_mfma_f32_16x16x32_bf16 v[164:167], v[204:207], v[100:103], v[164:167]
    s_waitcnt lgkmcnt(5)
    buffer_load_dwordx4 v[92:95], v2, s[12:15], s52 offen offset:1024 sc1
    v_mfma_f32_16x16x32_bf16 v[160:163], v[204:207], v[96:99], v[160:163]
    ds_read_b128 v[204:207], v21 offset:46080
    v_mfma_f32_16x16x32_bf16 v[168:171], v[208:211], v[96:99], v[168:171]
    s_waitcnt lgkmcnt(5)
    v_mfma_f32_16x16x32_bf16 v[172:175], v[208:211], v[100:103], v[172:175]
    ds_read_b128 v[208:211], v21 offset:47104
    v_mfma_f32_16x16x32_bf16 v[180:183], v[212:215], v[100:103], v[180:183]
    s_waitcnt lgkmcnt(5)
    v_mfma_f32_16x16x32_bf16 v[176:179], v[212:215], v[96:99], v[176:179]
    ds_read_b128 v[212:215], v21 offset:48128
    v_mfma_f32_16x16x32_bf16 v[184:187], v[216:219], v[96:99], v[184:187]
    s_waitcnt lgkmcnt(5)
    v_mfma_f32_16x16x32_bf16 v[188:191], v[216:219], v[100:103], v[188:191]
    ds_read_b128 v[216:219], v21 offset:49152
    s_waitcnt vmcnt(22)
    v_mfma_f32_16x16x32_bf16 v[136:139], v[192:195], v[104:107], v[136:139]
    s_waitcnt lgkmcnt(5)
    buffer_load_dwordx4 a[144:147], v244, s[12:15], s74 offen offset:1024 sc1
    v_mfma_f32_16x16x32_bf16 v[140:143], v[192:195], v[108:111], v[140:143]
    ds_read_b128 v[192:195], v21 offset:50176
    v_mfma_f32_16x16x32_bf16 v[148:151], v[196:199], v[108:111], v[148:151]
    s_waitcnt lgkmcnt(5)
    buffer_load_dwordx4 v[96:99], v2, s[12:15], s52 offen offset:2048 sc1
    v_mfma_f32_16x16x32_bf16 v[144:147], v[196:199], v[104:107], v[144:147]
    ds_read_b128 v[196:199], v21 offset:51200
    v_mfma_f32_16x16x32_bf16 v[152:155], v[200:203], v[104:107], v[152:155]
    s_waitcnt lgkmcnt(5)
    v_mfma_f32_16x16x32_bf16 v[156:159], v[200:203], v[108:111], v[156:159]
    ds_read_b128 v[200:203], v21 offset:52224
    v_mfma_f32_16x16x32_bf16 v[164:167], v[204:207], v[108:111], v[164:167]
    s_waitcnt lgkmcnt(5)
    buffer_load_dwordx4 v[100:103], v2, s[12:15], s52 offen offset:3072 sc1
    v_mfma_f32_16x16x32_bf16 v[160:163], v[204:207], v[104:107], v[160:163]
    ds_read_b128 v[204:207], v21 offset:53248
    v_mfma_f32_16x16x32_bf16 v[168:171], v[208:211], v[104:107], v[168:171]
    s_waitcnt lgkmcnt(5)
    v_mfma_f32_16x16x32_bf16 v[172:175], v[208:211], v[108:111], v[172:175]
    ds_read_b128 v[208:211], v21 offset:54272
    v_mfma_f32_16x16x32_bf16 v[180:183], v[212:215], v[108:111], v[180:183]
    s_waitcnt lgkmcnt(5)
    v_mfma_f32_16x16x32_bf16 v[176:179], v[212:215], v[104:107], v[176:179]
    ds_read_b128 v[212:215], v21 offset:55296
    v_mfma_f32_16x16x32_bf16 v[184:187], v[216:219], v[104:107], v[184:187]
    s_waitcnt lgkmcnt(5)
    v_mfma_f32_16x16x32_bf16 v[188:191], v[216:219], v[108:111], v[188:191]
    ds_read_b128 v[216:219], v21 offset:56320
    s_waitcnt vmcnt(23)
    v_mfma_f32_16x16x32_bf16 v[136:139], v[192:195], v[112:115], v[136:139]
    s_waitcnt lgkmcnt(5)
    buffer_load_dwordx4 a[148:151], v245, s[12:15], s74 offen offset:0 sc1
    v_mfma_f32_16x16x32_bf16 v[140:143], v[192:195], v[116:119], v[140:143]
    ds_read_b128 v[192:195], v21 offset:57344
    s_add_u32 s52, s30, 0xa08000
    v_mfma_f32_16x16x32_bf16 v[148:151], v[196:199], v[116:119], v[148:151]
    s_waitcnt lgkmcnt(5)
    buffer_load_dwordx4 v[104:107], v2, s[12:15], s52 offen offset:0 sc1
    v_mfma_f32_16x16x32_bf16 v[144:147], v[196:199], v[112:115], v[144:147]
    ds_read_b128 v[196:199], v21 offset:58368
    v_mfma_f32_16x16x32_bf16 v[152:155], v[200:203], v[112:115], v[152:155]
    s_waitcnt lgkmcnt(5)
    v_mfma_f32_16x16x32_bf16 v[156:159], v[200:203], v[116:119], v[156:159]
    ds_read_b128 v[200:203], v21 offset:59392
    v_mfma_f32_16x16x32_bf16 v[164:167], v[204:207], v[116:119], v[164:167]
    s_waitcnt lgkmcnt(5)
    buffer_load_dwordx4 v[108:111], v2, s[12:15], s52 offen offset:1024 sc1
    v_mfma_f32_16x16x32_bf16 v[160:163], v[204:207], v[112:115], v[160:163]
    ds_read_b128 v[204:207], v21 offset:60416
    v_mfma_f32_16x16x32_bf16 v[168:171], v[208:211], v[112:115], v[168:171]
    s_waitcnt lgkmcnt(5)
    v_mfma_f32_16x16x32_bf16 v[172:175], v[208:211], v[116:119], v[172:175]
    ds_read_b128 v[208:211], v21 offset:61440
    v_mfma_f32_16x16x32_bf16 v[180:183], v[212:215], v[116:119], v[180:183]
    s_waitcnt lgkmcnt(5)
    v_mfma_f32_16x16x32_bf16 v[176:179], v[212:215], v[112:115], v[176:179]
    ds_read_b128 v[212:215], v21 offset:62464
    v_mfma_f32_16x16x32_bf16 v[184:187], v[216:219], v[112:115], v[184:187]
    s_waitcnt lgkmcnt(5)
    v_mfma_f32_16x16x32_bf16 v[188:191], v[216:219], v[116:119], v[188:191]
    ds_read_b128 v[216:219], v21 offset:63488
    s_add_u32 s55, s40, 0x16b0000
    buffer_load_dword v18, v13, s[12:15], s55 offen sc1
    s_waitcnt vmcnt(25)
    v_mfma_f32_16x16x32_bf16 v[136:139], v[192:195], v[120:123], v[136:139]
    s_waitcnt lgkmcnt(5)
    buffer_load_dwordx4 a[152:155], v245, s[12:15], s74 offen offset:1024 sc1
    v_mfma_f32_16x16x32_bf16 v[140:143], v[192:195], v[124:127], v[140:143]
    ds_read_b128 v[192:195], v21 offset:64512
    v_mfma_f32_16x16x32_bf16 v[148:151], v[196:199], v[124:127], v[148:151]
    s_waitcnt lgkmcnt(5)
    buffer_load_dwordx4 v[112:115], v2, s[12:15], s52 offen offset:2048 sc1
    v_mfma_f32_16x16x32_bf16 v[144:147], v[196:199], v[120:123], v[144:147]
    ds_read_b128 v[196:199], v3 offset:0
    v_mfma_f32_16x16x32_bf16 v[152:155], v[200:203], v[120:123], v[152:155]
    s_waitcnt lgkmcnt(5)
    v_mfma_f32_16x16x32_bf16 v[156:159], v[200:203], v[124:127], v[156:159]
    ds_read_b128 v[200:203], v3 offset:1024
    v_mfma_f32_16x16x32_bf16 v[164:167], v[204:207], v[124:127], v[164:167]
    s_waitcnt lgkmcnt(5)
    buffer_load_dwordx4 v[116:119], v2, s[12:15], s52 offen offset:3072 sc1
    v_mfma_f32_16x16x32_bf16 v[160:163], v[204:207], v[120:123], v[160:163]
    ds_read_b128 v[204:207], v3 offset:2048
    v_mfma_f32_16x16x32_bf16 v[168:171], v[208:211], v[120:123], v[168:171]
    s_waitcnt lgkmcnt(5)
    v_mfma_f32_16x16x32_bf16 v[172:175], v[208:211], v[124:127], v[172:175]
    ds_read_b128 v[208:211], v3 offset:3072
    v_mfma_f32_16x16x32_bf16 v[180:183], v[212:215], v[124:127], v[180:183]
    s_waitcnt lgkmcnt(5)
    v_mfma_f32_16x16x32_bf16 v[176:179], v[212:215], v[120:123], v[176:179]
    ds_read_b128 v[212:215], v3 offset:4096
    v_mfma_f32_16x16x32_bf16 v[184:187], v[216:219], v[120:123], v[184:187]
    s_waitcnt lgkmcnt(5)
    v_mfma_f32_16x16x32_bf16 v[188:191], v[216:219], v[124:127], v[188:191]
    ds_read_b128 v[216:219], v3 offset:5120
    s_waitcnt vmcnt(26)
    v_mfma_f32_16x16x32_bf16 v[136:139], v[192:195], v[128:131], v[136:139]
    s_waitcnt lgkmcnt(5)
    buffer_load_dwordx4 a[156:159], v246, s[12:15], s74 offen offset:0 sc1
    v_mfma_f32_16x16x32_bf16 v[140:143], v[192:195], v[132:135], v[140:143]
    ds_read_b128 v[192:195], v3 offset:6144
    s_add_u32 s52, s30, 0xa09000
    v_mfma_f32_16x16x32_bf16 v[148:151], v[196:199], v[132:135], v[148:151]
    s_waitcnt lgkmcnt(5)
    buffer_load_dwordx4 v[120:123], v2, s[12:15], s52 offen offset:0 sc1
    v_mfma_f32_16x16x32_bf16 v[144:147], v[196:199], v[128:131], v[144:147]
    ds_read_b128 v[196:199], v3 offset:7168
    v_mfma_f32_16x16x32_bf16 v[152:155], v[200:203], v[128:131], v[152:155]
    s_waitcnt lgkmcnt(5)
    v_mfma_f32_16x16x32_bf16 v[156:159], v[200:203], v[132:135], v[156:159]
    ds_read_b128 v[200:203], v3 offset:8192
    v_mfma_f32_16x16x32_bf16 v[164:167], v[204:207], v[132:135], v[164:167]
    s_waitcnt lgkmcnt(5)
    buffer_load_dwordx4 v[124:127], v2, s[12:15], s52 offen offset:1024 sc1
    v_mfma_f32_16x16x32_bf16 v[160:163], v[204:207], v[128:131], v[160:163]
    ds_read_b128 v[204:207], v3 offset:9216
    v_mfma_f32_16x16x32_bf16 v[168:171], v[208:211], v[128:131], v[168:171]
    s_waitcnt lgkmcnt(5)
    v_mfma_f32_16x16x32_bf16 v[172:175], v[208:211], v[132:135], v[172:175]
    ds_read_b128 v[208:211], v3 offset:10240
    v_mfma_f32_16x16x32_bf16 v[180:183], v[212:215], v[132:135], v[180:183]
    s_waitcnt lgkmcnt(5)
    v_mfma_f32_16x16x32_bf16 v[176:179], v[212:215], v[128:131], v[176:179]
    ds_read_b128 v[212:215], v3 offset:11264
    v_mfma_f32_16x16x32_bf16 v[184:187], v[216:219], v[128:131], v[184:187]
    s_waitcnt lgkmcnt(5)
    v_mfma_f32_16x16x32_bf16 v[188:191], v[216:219], v[132:135], v[188:191]
    ds_read_b128 v[216:219], v3 offset:12288
    s_waitcnt vmcnt(25)
    v_mfma_f32_16x16x32_bf16 v[136:139], v[192:195], v[56:59], v[136:139]
    s_waitcnt lgkmcnt(5)
    buffer_load_dwordx4 a[160:163], v244, s[12:15], s75 offen offset:0 sc1
    v_mfma_f32_16x16x32_bf16 v[140:143], v[192:195], v[60:63], v[140:143]
    ds_read_b128 v[192:195], v3 offset:13312
    v_mfma_f32_16x16x32_bf16 v[148:151], v[196:199], v[60:63], v[148:151]
    s_waitcnt lgkmcnt(5)
    buffer_load_dwordx4 v[128:131], v2, s[12:15], s52 offen offset:2048 sc1
    v_mfma_f32_16x16x32_bf16 v[144:147], v[196:199], v[56:59], v[144:147]
    ds_read_b128 v[196:199], v3 offset:14336
    v_mfma_f32_16x16x32_bf16 v[152:155], v[200:203], v[56:59], v[152:155]
    s_waitcnt lgkmcnt(5)
    v_mfma_f32_16x16x32_bf16 v[156:159], v[200:203], v[60:63], v[156:159]
    ds_read_b128 v[200:203], v3 offset:15360
    v_mfma_f32_16x16x32_bf16 v[164:167], v[204:207], v[60:63], v[164:167]
    s_waitcnt lgkmcnt(5)
    buffer_load_dwordx4 v[132:135], v2, s[12:15], s52 offen offset:3072 sc1
    v_mfma_f32_16x16x32_bf16 v[160:163], v[204:207], v[56:59], v[160:163]
    ds_read_b128 v[204:207], v3 offset:16384
    v_mfma_f32_16x16x32_bf16 v[168:171], v[208:211], v[56:59], v[168:171]
    s_waitcnt lgkmcnt(5)
    v_mfma_f32_16x16x32_bf16 v[172:175], v[208:211], v[60:63], v[172:175]
    ds_read_b128 v[208:211], v3 offset:17408
    v_mfma_f32_16x16x32_bf16 v[180:183], v[212:215], v[60:63], v[180:183]
    s_waitcnt lgkmcnt(5)
    v_mfma_f32_16x16x32_bf16 v[176:179], v[212:215], v[56:59], v[176:179]
    ds_read_b128 v[212:215], v3 offset:18432
    v_mfma_f32_16x16x32_bf16 v[184:187], v[216:219], v[56:59], v[184:187]
    s_waitcnt lgkmcnt(5)
    v_mfma_f32_16x16x32_bf16 v[188:191], v[216:219], v[60:63], v[188:191]
    ds_read_b128 v[216:219], v3 offset:19456
    s_waitcnt vmcnt(25)
    v_mfma_f32_16x16x32_bf16 v[136:139], v[192:195], v[64:67], v[136:139]
    s_waitcnt lgkmcnt(5)
    buffer_load_dwordx4 a[164:167], v244, s[12:15], s75 offen offset:1024 sc1
    v_mfma_f32_16x16x32_bf16 v[140:143], v[192:195], v[68:71], v[140:143]
    ds_read_b128 v[192:195], v3 offset:20480
    v_mfma_f32_16x16x32_bf16 v[148:151], v[196:199], v[68:71], v[148:151]
    s_waitcnt lgkmcnt(5)
    v_mfma_f32_16x16x32_bf16 v[144:147], v[196:199], v[64:67], v[144:147]
    ds_read_b128 v[196:199], v3 offset:21504
    v_mfma_f32_16x16x32_bf16 v[152:155], v[200:203], v[64:67], v[152:155]
    s_waitcnt lgkmcnt(5)
    v_mfma_f32_16x16x32_bf16 v[156:159], v[200:203], v[68:71], v[156:159]
    ds_read_b128 v[200:203], v3 offset:22528
    v_mfma_f32_16x16x32_bf16 v[164:167], v[204:207], v[68:71], v[164:167]
    s_waitcnt lgkmcnt(5)
    v_mfma_f32_16x16x32_bf16 v[160:163], v[204:207], v[64:67], v[160:163]
    ds_read_b128 v[204:207], v3 offset:23552
    v_mfma_f32_16x16x32_bf16 v[168:171], v[208:211], v[64:67], v[168:171]
    s_waitcnt lgkmcnt(5)
    v_mfma_f32_16x16x32_bf16 v[172:175], v[208:211], v[68:71], v[172:175]
    ds_read_b128 v[208:211], v3 offset:24576
    v_mfma_f32_16x16x32_bf16 v[180:183], v[212:215], v[68:71], v[180:183]
    s_waitcnt lgkmcnt(5)
    v_mfma_f32_16x16x32_bf16 v[176:179], v[212:215], v[64:67], v[176:179]
    ds_read_b128 v[212:215], v3 offset:25600
    v_mfma_f32_16x16x32_bf16 v[184:187], v[216:219], v[64:67], v[184:187]
    s_waitcnt lgkmcnt(5)
    v_mfma_f32_16x16x32_bf16 v[188:191], v[216:219], v[68:71], v[188:191]
    ds_read_b128 v[216:219], v3 offset:26624
    s_waitcnt vmcnt(10)
L_chk_34:
    v_cmp_ne_u32 vcc, v19, v18
    s_cbranch_vccz L_ok_35
    s_cmp_eq_u32 s50, 0
    s_cbranch_scc1 L_ok_35
    s_sub_u32 s50, s50, 1
    s_sleep 1
    s_mov_b64 exec, vcc
    s_add_u32 s55, s40, 0x16b0000
    buffer_load_dword v18, v13, s[12:15], s55 offen sc1
    s_mov_b64 exec, -1
    s_waitcnt vmcnt(0)
    s_branch L_chk_34
L_ok_35:
    v_mfma_f32_16x16x32_bf16 v[136:139], v[192:195], v[72:75], v[136:139]
    s_waitcnt lgkmcnt(5)
    buffer_load_dwordx4 a[168:171], v245, s[12:15], s75 offen offset:0 sc1
    v_mfma_f32_16x16x32_bf16 v[140:143], v[192:195], v[76:79], v[140:143]
    ds_read_b128 v[192:195], v3 offset:27648
    s_add_u32 s52, s30, 0xb40000
    v_mfma_f32_16x16x32_bf16 v[148:151], v[196:199], v[76:79], v[148:151]
    s_waitcnt lgkmcnt(5)
    buffer_load_dwordx4 v[56:59], v2, s[12:15], s52 offen offset:0 sc1
    v_mfma_f32_16x16x32_bf16 v[144:147], v[196:199], v[72:75], v[144:147]
    ds_read_b128 v[196:199], v3 offset:28672
    v_mfma_f32_16x16x32_bf16 v[152:155], v[200:203], v[72:75], v[152:155]
    s_waitcnt lgkmcnt(5)
    v_mfma_f32_16x16x32_bf16 v[156:159], v[200:203], v[76:79], v[156:159]
    ds_read_b128 v[200:203], v3 offset:29696
    v_mfma_f32_16x16x32_bf16 v[164:167], v[204:207], v[76:79], v[164:167]
    s_waitcnt lgkmcnt(5)
    buffer_load_dwordx4 v[60:63], v2, s[12:15], s52 offen offset:1024 sc1
    v_mfma_f32_16x16x32_bf16 v[160:163], v[204:207], v[72:75], v[160:163]
    ds_read_b128 v[204:207], v3 offset:30720
    v_mfma_f32_16x16x32_bf16 v[168:171], v[208:211], v[72:75], v[168:171]
    s_waitcnt lgkmcnt(5)
    v_mfma_f32_16x16x32_bf16 v[172:175], v[208:211], v[76:79], v[172:175]
    ds_read_b128 v[208:211], v3 offset:31744
    v_mfma_f32_16x16x32_bf16 v[180:183], v[212:215], v[76:79], v[180:183]
    s_waitcnt lgkmcnt(5)
    buffer_load_dwordx4 v[64:67], v2, s[12:15], s52 offen offset:2048 sc1
    v_mfma_f32_16x16x32_bf16 v[176:179], v[212:215], v[72:75], v[176:179]
    ds_read_b128 v[212:215], v3 offset:32768
    v_mfma_f32_16x16x32_bf16 v[184:187], v[216:219], v[72:75], v[184:187]
    s_waitcnt lgkmcnt(5)
    buffer_load_dwordx4 v[68:71], v2, s[12:15], s52 offen offset:3072 sc1
    v_mfma_f32_16x16x32_bf16 v[188:191], v[216:219], v[76:79], v[188:191]
    ds_read_b128 v[216:219], v3 offset:33792
    v_mfma_f32_16x16x32_bf16 v[136:139], v[192:195], v[80:83], v[136:139]
    s_waitcnt lgkmcnt(5)
    buffer_load_dwordx4 a[172:175], v245, s[12:15], s75 offen offset:1024 sc1
    v_mfma_f32_16x16x32_bf16 v[140:143], v[192:195], v[84:87], v[140:143]
    ds_read_b128 v[192:195], v3 offset:34816
    s_add_u32 s52, s30, 0xb41000
    v_mfma_f32_16x16x32_bf16 v[148:151], v[196:199], v[84:87], v[148:151]
    s_waitcnt lgkmcnt(5)
    buffer_load_dwordx4 v[72:75], v2, s[12:15], s52 offen offset:0 sc1
    v_mfma_f32_16x16x32_bf16 v[144:147], v[196:199], v[80:83], v[144:147]
    ds_read_b128 v[196:199], v3 offset:35840
    v_mfma_f32_16x16x32_bf16 v[152:155], v[200:203], v[80:83], v[152:155]
    s_waitcnt lgkmcnt(5)
    v_mfma_f32_16x16x32_bf16 v[156:159], v[200:203], v[84:87], v[156:159]
    ds_read_b128 v[200:203], v3 offset:36864
    v_mfma_f32_16x16x32_bf16 v[164:167], v[204:207], v[84:87], v[164:167]
    s_waitcnt lgkmcnt(5)
    buffer_load_dwordx4 v[76:79], v2, s[12:15], s52 offen offset:1024 sc1
    v_mfma_f32_16x16x32_bf16 v[160:163], v[204:207], v[80:83], v[160:163]
    ds_read_b128 v[204:207], v3 offset:37888
    v_mfma_f32_16x16x32_bf16 v[168:171], v[208:211], v[80:83], v[168:171]
    s_waitcnt lgkmcnt(5)
    v_mfma_f32_16x16x32_bf16 v[172:175], v[208:211], v[84:87], v[172:175]
    ds_read_b128 v[208:211], v3 offset:38912
    v_mfma_f32_16x16x32_bf16 v[180:183], v[212:215], v[84:87], v[180:183]
    s_waitcnt lgkmcnt(5)
    v_mfma_f32_16x16x32_bf16 v[176:179], v[212:215], v[80:83], v[176:179]
    ds_read_b128 v[212:215], v3 offset:39936
    v_mfma_f32_16x16x32_bf16 v[184:187], v[216:219], v[80:83], v[184:187]
    s_waitcnt lgkmcnt(5)
    v_mfma_f32_16x16x32_bf16 v[188:191], v[216:219], v[84:87], v[188:191]
    ds_read_b128 v[216:219], v3 offset:40960
    v_mfma_f32_16x16x32_bf16 v[136:139], v[192:195], v[88:91], v[136:139]
    s_waitcnt lgkmcnt(5)
    buffer_load_dwordx4 a[176:179], v246, s[12:15], s75 offen offset:0 sc1
    s_add_u32 s75, s75, 5120
    v_mfma_f32_16x16x32_bf16 v[140:143], v[192:195], v[92:95], v[140:143]
    ds_read_b128 v[192:195], v3 offset:41984
    v_mfma_f32_16x16x32_bf16 v[148:151], v[196:199], v[92:95], v[148:151]
    s_waitcnt lgkmcnt(5)
    buffer_load_dwordx4 v[80:83], v2, s[12:15], s52 offen offset:2048 sc1
    v_mfma_f32_16x16x32_bf16 v[144:147], v[196:199], v[88:91], v[144:147]
    ds_read_b128 v[196:199], v3 offset:43008
    v_mfma_f32_16x16x32_bf16 v[152:155], v[200:203], v[88:91], v[152:155]
    s_waitcnt lgkmcnt(5)
    v_mfma_f32_16x16x32_bf16 v[156:159], v[200:203], v[92:95], v[156:159]
    ds_read_b128 v[200:203], v3 offset:44032
    v_mfma_f32_16x16x32_bf16 v[164:167], v[204:207], v[92:95], v[164:167]
    s_waitcnt lgkmcnt(5)
    buffer_load_dwordx4 v[84:87], v2, s[12:15], s52 offen offset:3072 sc1
    v_mfma_f32_16x16x32_bf16 v[160:163], v[204:207], v[88:91], v[160:163]
    ds_read_b128 v[204:207], v3 offset:45056
    v_mfma_f32_16x16x32_bf16 v[168:171], v[208:211], v[88:91], v[168:171]
    s_waitcnt lgkmcnt(5)
    v_mfma_f32_16x16x32_bf16 v[172:175], v[208:211], v[92:95], v[172:175]
    ds_read_b128 v[208:211], v3 offset:46080
    v_mfma_f32_16x16x32_bf16 v[180:183], v[212:215], v[92:95], v[180:183]
    s_waitcnt lgkmcnt(5)
    v_mfma_f32_16x16x32_bf16 v[176:179], v[212:215], v[88:91], v[176:179]
    ds_read_b128 v[212:215], v3 offset:47104
    v_mfma_f32_16x16x32_bf16 v[184:187], v[216:219], v[88:91], v[184:187]
    s_waitcnt lgkmcnt(5)
    v_mfma_f32_16x16x32_bf16 v[188:191], v[216:219], v[92:95], v[188:191]
    ds_read_b128 v[216:219], v3 offset:48128
    v_mfma_f32_16x16x32_bf16 v[136:139], v[192:195], v[96:99], v[136:139]
    s_waitcnt lgkmcnt(5)
    buffer_load_dwordx4 a[180:183], v244, s[12:15], s75 offen offset:0 sc1
    v_mfma_f32_16x16x32_bf16 v[140:143], v[192:195], v[100:103], v[140:143]
    ds_read_b128 v[192:195], v3 offset:49152
    s_add_u32 s52, s30, 0xb42000
    v_mfma_f32_16x16x32_bf16 v[148:151], v[196:199], v[100:103], v[148:151]
    s_waitcnt lgkmcnt(5)
    buffer_load_dwordx4 v[88:91], v2, s[12:15], s52 offen offset:0 sc1
    v_mfma_f32_16x16x32_bf16 v[144:147], v[196:199], v[96:99], v[144:147]
    ds_read_b128 v[196:199], v3 offset:50176
    v_mfma_f32_16x16x32_bf16 v[152:155], v[200:203], v[96:99], v[152:155]
    s_waitcnt lgkmcnt(5)
    v_mfma_f32_16x16x32_bf16 v[156:159], v[200:203], v[100:103], v[156:159]
    ds_read_b128 v[200:203], v3 offset:51200
    v_mfma_f32_16x16x32_bf16 v[164:167], v[204:207], v[100:103], v[164:167]
    s_waitcnt lgkmcnt(5)
    buffer_load_dwordx4 v[92:95], v2, s[12:15], s52 offen offset:1024 sc1
    v_mfma_f32_16x16x32_bf16 v[160:163], v[204:207], v[96:99], v[160:163]
    ds_read_b128 v[204:207], v3 offset:52224
    v_mfma_f32_16x16x32_bf16 v[168:171], v[208:211], v[96:99], v[168:171]
    s_waitcnt lgkmcnt(5)
    v_mfma_f32_16x16x32_bf16 v[172:175], v[208:211], v[100:103], v[172:175]
    ds_read_b128 v[208:211], v3 offset:53248
    v_mfma_f32_16x16x32_bf16 v[180:183], v[212:215], v[100:103], v[180:183]
    s_waitcnt lgkmcnt(5)
    v_mfma_f32_16x16x32_bf16 v[176:179], v[212:215], v[96:99], v[176:179]
    ds_read_b128 v[212:215], v3 offset:54272
    v_mfma_f32_16x16x32_bf16 v[184:187], v[216:219], v[96:99], v[184:187]
    s_waitcnt lgkmcnt(5)
    v_mfma_f32_16x16x32_bf16 v[188:191], v[216:219], v[100:103], v[188:191]
    ds_read_b128 v[216:219], v3 offset:55296
    s_add_u32 s55, s35, 0x500000
    buffer_load_dwordx2 v[232:233], v22, s[12:15], s55 offen sc1
    s_add_u32 s55, s35, 0x500000
    buffer_load_dwordx2 v[234:235], v22, s[12:15], s55 offen offset:128 sc1
    s_add_u32 s55, s35, 0x500000
    s_mov_b64 exec, s[56:57]
    buffer_load_dwordx2 v[236:237], v23, s[12:15], s55 offen sc1
    s_mov_b64 exec, -1
    s_add_u32 s55, s35, 0x640000
    buffer_load_dwordx2 v[238:239], v22, s[12:15], s55 offen sc1
    s_add_u32 s55, s35, 0x640000
    buffer_load_dwordx2 v[240:241], v22, s[12:15], s55 offen offset:128 sc1
    s_add_u32 s55, s35, 0x640000
    s_mov_b64 exec, s[56:57]
    buffer_load_dwordx2 v[242:243], v23, s[12:15], s55 offen sc1
    s_mov_b64 exec, -1
    v_mfma_f32_16x16x32_bf16 v[136:139], v[192:195], v[104:107], v[136:139]
    s_waitcnt lgkmcnt(5)
    buffer_load_dwordx4 a[184:187], v244, s[12:15], s75 offen offset:1024 sc1
    v_mfma_f32_16x16x32_bf16 v[140:143], v[192:195], v[108:111], v[140:143]
    ds_read_b128 v[192:195], v3 offset:56320
    v_mfma_f32_16x16x32_bf16 v[148:151], v[196:199], v[108:111], v[148:151]
    s_waitcnt lgkmcnt(5)
    buffer_load_dwordx4 v[96:99], v2, s[12:15], s52 offen offset:2048 sc1
    v_mfma_f32_16x16x32_bf16 v[144:147], v[196:199], v[104:107], v[144:147]
    ds_read_b128 v[196:199], v3 offset:57344
    v_mfma_f32_16x16x32_bf16 v[152:155], v[200:203], v[104:107], v[152:155]
    s_waitcnt lgkmcnt(5)
    v_mfma_f32_16x16x32_bf16 v[156:159], v[200:203], v[108:111], v[156:159]
    ds_read_b128 v[200:203], v3 offset:58368
    v_mfma_f32_16x16x32_bf16 v[164:167], v[204:207], v[108:111], v[164:167]
    s_waitcnt lgkmcnt(5)
    buffer_load_dwordx4 v[100:103], v2, s[12:15], s52 offen offset:3072 sc1
    v_mfma_f32_16x16x32_bf16 v[160:163], v[204:207], v[104:107], v[160:163]
    ds_read_b128 v[204:207], v3 offset:59392
    v_mfma_f32_16x16x32_bf16 v[168:171], v[208:211], v[104:107], v[168:171]
    s_waitcnt lgkmcnt(5)
    v_mfma_f32_16x16x32_bf16 v[172:175], v[208:211], v[108:111], v[172:175]
    ds_read_b128 v[208:211], v3 offset:60416
    v_mfma_f32_16x16x32_bf16 v[180:183], v[212:215], v[108:111], v[180:183]
    s_waitcnt lgkmcnt(5)
    v_mfma_f32_16x16x32_bf16 v[176:179], v[212:215], v[104:107], v[176:179]
    ds_read_b128 v[212:215], v3 offset:61440
    v_mfma_f32_16x16x32_bf16 v[184:187], v[216:219], v[104:107], v[184:187]
    s_waitcnt lgkmcnt(5)
    v_mfma_f32_16x16x32_bf16 v[188:191], v[216:219], v[108:111], v[188:191]
    ds_read_b128 v[216:219], v3 offset:62464
    s_waitcnt vmcnt(30)
    v_mfma_f32_16x16x32_bf16 v[136:139], v[192:195], v[112:115], v[136:139]
    s_waitcnt lgkmcnt(5)
    buffer_load_dwordx4 a[188:191], v245, s[12:15], s75 offen offset:0 sc1
    v_mfma_f32_16x16x32_bf16 v[140:143], v[192:195], v[116:119], v[140:143]
    ds_read_b128 v[192:195], v3 offset:63488
    s_add_u32 s52, s30, 0xb43000
    v_mfma_f32_16x16x32_bf16 v[148:151], v[196:199], v[116:119], v[148:151]
    s_waitcnt lgkmcnt(5)
    buffer_load_dwordx4 v[104:107], v2, s[12:15], s52 offen offset:0 sc1
    v_mfma_f32_16x16x32_bf16 v[144:147], v[196:199], v[112:115], v[144:147]
    ds_read_b128 v[196:199], v3 offset:64512
    v_mfma_f32_16x16x32_bf16 v[152:155], v[200:203], v[112:115], v[152:155]
    s_waitcnt lgkmcnt(5)
    v_mfma_f32_16x16x32_bf16 v[156:159], v[200:203], v[116:119], v[156:159]
    ds_read_b128 v[200:203], v4 offset:0
    v_mfma_f32_16x16x32_bf16 v[164:167], v[204:207], v[116:119], v[164:167]
    s_waitcnt lgkmcnt(5)
    buffer_load_dwordx4 v[108:111], v2, s[12:15], s52 offen offset:1024 sc1
    v_mfma_f32_16x16x32_bf16 v[160:163], v[204:207], v[112:115], v[160:163]
    ds_read_b128 v[204:207], v4 offset:1024
    v_mfma_f32_16x16x32_bf16 v[168:171], v[208:211], v[112:115], v[168:171]
    s_waitcnt lgkmcnt(5)
    v_mfma_f32_16x16x32_bf16 v[172:175], v[208:211], v[116:119], v[172:175]
    ds_read_b128 v[208:211], v4 offset:2048
    v_mfma_f32_16x16x32_bf16 v[180:183], v[212:215], v[116:119], v[180:183]
    s_waitcnt lgkmcnt(5)
    v_mfma_f32_16x16x32_bf16 v[176:179], v[212:215], v[112:115], v[176:179]
    ds_read_b128 v[212:215], v4 offset:3072
    v_mfma_f32_16x16x32_bf16 v[184:187], v[216:219], v[112:115], v[184:187]
    s_waitcnt lgkmcnt(5)
    v_mfma_f32_16x16x32_bf16 v[188:191], v[216:219], v[116:119], v[188:191]
    ds_read_b128 v[216:219], v4 offset:4096
    s_waitcnt vmcnt(30)
    v_mfma_f32_16x16x32_bf16 v[136:139], v[192:195], v[120:123], v[136:139]
    s_waitcnt lgkmcnt(5)
    buffer_load_dwordx4 a[192:195], v245, s[12:15], s75 offen offset:1024 sc1
    v_mfma_f32_16x16x32_bf16 v[140:143], v[192:195], v[124:127], v[140:143]
    ds_read_b128 v[192:195], v4 offset:5120
    v_mfma_f32_16x16x32_bf16 v[148:151], v[196:199], v[124:127], v[148:151]
    s_waitcnt lgkmcnt(5)
    buffer_load_dwordx4 v[112:115], v2, s[12:15], s52 offen offset:2048 sc1
    v_mfma_f32_16x16x32_bf16 v[144:147], v[196:199], v[120:123], v[144:147]
    ds_read_b128 v[196:199], v4 offset:6144
    v_mfma_f32_16x16x32_bf16 v[152:155], v[200:203], v[120:123], v[152:155]
    s_waitcnt lgkmcnt(5)
    v_mfma_f32_16x16x32_bf16 v[156:159], v[200:203], v[124:127], v[156:159]
    ds_read_b128 v[200:203], v4 offset:7168
    v_mfma_f32_16x16x32_bf16 v[164:167], v[204:207], v[124:127], v[164:167]
    s_waitcnt lgkmcnt(5)
    buffer_load_dwordx4 v[116:119], v2, s[12:15], s52 offen offset:3072 sc1
    v_mfma_f32_16x16x32_bf16 v[160:163], v[204:207], v[120:123], v[160:163]
    ds_read_b128 v[204:207], v4 offset:8192
    v_mfma_f32_16x16x32_bf16 v[168:171], v[208:211], v[120:123], v[168:171]
    s_waitcnt lgkmcnt(5)
    v_mfma_f32_16x16x32_bf16 v[172:175], v[208:211], v[124:127], v[172:175]
    ds_read_b128 v[208:211], v4 offset:9216
    v_mfma_f32_16x16x32_bf16 v[180:183], v[212:215], v[124:127], v[180:183]
    s_waitcnt lgkmcnt(5)
    v_mfma_f32_16x16x32_bf16 v[176:179], v[212:215], v[120:123], v[176:179]
    ds_read_b128 v[212:215], v4 offset:10240
    v_mfma_f32_16x16x32_bf16 v[184:187], v[216:219], v[120:123], v[184:187]
    s_waitcnt lgkmcnt(5)
    v_mfma_f32_16x16x32_bf16 v[188:191], v[216:219], v[124:127], v[188:191]
    ds_read_b128 v[216:219], v4 offset:11264
    s_waitcnt vmcnt(30)
    v_mfma_f32_16x16x32_bf16 v[136:139], v[192:195], v[128:131], v[136:139]
    s_waitcnt lgkmcnt(5)
    buffer_load_dwordx4 a[196:199], v246, s[12:15], s75 offen offset:0 sc1
    v_mfma_f32_16x16x32_bf16 v[140:143], v[192:195], v[132:135], v[140:143]
    ds_read_b128 v[192:195], v21 offset:0
    s_add_u32 s52, s30, 0xb44000
    v_mfma_f32_16x16x32_bf16 v[148:151], v[196:199], v[132:135], v[148:151]
    s_waitcnt lgkmcnt(5)
    buffer_load_dwordx4 v[120:123], v2, s[12:15], s52 offen offset:0 sc1
    v_mfma_f32_16x16x32_bf16 v[144:147], v[196:199], v[128:131], v[144:147]
    ds_read_b128 v[196:199], v21 offset:1024
    v_mfma_f32_16x16x32_bf16 v[152:155], v[200:203], v[128:131], v[152:155]
    s_waitcnt lgkmcnt(5)
    v_mfma_f32_16x16x32_bf16 v[156:159], v[200:203], v[132:135], v[156:159]
    ds_read_b128 v[200:203], v21 offset:2048
    s_add_u32 s54, s34, 0x17d0000
    v_pk_mul_f32 v[136:137], v[136:137], v[138:139]
    v_pk_mul_f32 v[140:141], v[140:141], v[142:143]
    v_cvt_pk_bf16_f32 v136, v136, v137
    v_cvt_pk_bf16_f32 v140, v140, v141
    v_mfma_f32_16x16x32_bf16 v[164:167], v[204:207], v[132:135], v[164:167]
    s_waitcnt lgkmcnt(5)
    buffer_load_dwordx4 v[124:127], v2, s[12:15], s52 offen offset:1024 sc1
    v_mfma_f32_16x16x32_bf16 v[160:163], v[204:207], v[128:131], v[160:163]
    ds_read_b128 v[204:207], v21 offset:3072
    v_pk_mul_f32 v[144:145], v[144:145], v[146:147]
    v_pk_mul_f32 v[148:149], v[148:149], v[150:151]
    v_cvt_pk_bf16_f32 v137, v144, v145
    v_cvt_pk_bf16_f32 v141, v148, v149
    v_mfma_f32_16x16x32_bf16 v[168:171], v[208:211], v[128:131], v[168:171]
    s_waitcnt lgkmcnt(5)
    v_mfma_f32_16x16x32_bf16 v[172:175], v[208:211], v[132:135], v[172:175]
    ds_read_b128 v[208:211], v21 offset:4096
    v_pk_mul_f32 v[152:153], v[152:153], v[154:155]
    v_pk_mul_f32 v[156:157], v[156:157], v[158:159]
    v_cvt_pk_bf16_f32 v138, v152, v153
    v_cvt_pk_bf16_f32 v142, v156, v157
    v_mfma_f32_16x16x32_bf16 v[180:183], v[212:215], v[132:135], v[180:183]
    s_waitcnt lgkmcnt(5)
    v_mfma_f32_16x16x32_bf16 v[176:179], v[212:215], v[128:131], v[176:179]
    ds_read_b128 v[212:215], v21 offset:5120
    v_pk_mul_f32 v[160:161], v[160:161], v[162:163]
    v_pk_mul_f32 v[164:165], v[164:165], v[166:167]
    v_cvt_pk_bf16_f32 v139, v160, v161
    v_cvt_pk_bf16_f32 v143, v164, v165
    buffer_store_dwordx4 v[136:139], v7, s[12:15], s54 offen offset:0 sc1
    buffer_store_dwordx4 v[140:143], v7, s[12:15], s54 offen offset:1024 sc1
    v_mfma_f32_16x16x32_bf16 v[184:187], v[216:219], v[128:131], v[184:187]
    s_waitcnt lgkmcnt(5)
    v_mfma_f32_16x16x32_bf16 v[188:191], v[216:219], v[132:135], v[188:191]
    ds_read_b128 v[216:219], v21 offset:6144
    v_pk_mul_f32 v[168:169], v[168:169], v[170:171]
    v_pk_mul_f32 v[172:173], v[172:173], v[174:175]
    v_cvt_pk_bf16_f32 v168, v168, v169
    v_cvt_pk_bf16_f32 v172, v172, v173
    v_pk_mul_f32 v[176:177], v[176:177], v[178:179]
    v_pk_mul_f32 v[180:181], v[180:181], v[182:183]
    v_cvt_pk_bf16_f32 v169, v176, v177
    v_cvt_pk_bf16_f32 v173, v180, v181
    s_nop 3
    v_pk_mul_f32 v[184:185], v[184:185], v[186:187]
    v_pk_mul_f32 v[188:189], v[188:189], v[190:191]
    v_cvt_pk_bf16_f32 v170, v184, v185
    v_cvt_pk_bf16_f32 v174, v188, v189
    v_mov_b32 v24, v170
    v_mov_b32 v25, v168
    v_mov_b32 v28, v174
    buffer_load_dwordx4 v[128:131], v2, s[12:15], s52 offen offset:2048 sc1
    v_mov_b32 v29, v172
    s_nop 0
    v_permlane16_swap_b32 v24, v171
    v_permlane16_swap_b32 v25, v26
    v_permlane16_swap_b32 v28, v175
    v_permlane16_swap_b32 v29, v30
    s_nop 0
    v_mov_b32_dpp v26, v169 quad_perm:[0,1,2,3] row_mask:0x8 bank_mask:0xf
    v_mov_b32_dpp v30, v173 quad_perm:[0,1,2,3] row_mask:0x8 bank_mask:0xf
    s_nop 1
    v_permlane32_swap_b32 v26, v171
    v_permlane32_swap_b32 v30, v175
    buffer_load_dwordx4 v[132:135], v2, s[12:15], s52 offen offset:3072 sc1
    s_mov_b32 exec_hi, 0xffff
    buffer_store_dwordx4 v[168:171], v7, s[12:15], s54 offen offset:2048 sc1
    s_mov_b32 exec_hi, -1
    s_mov_b32 exec_hi, 0xffff
    buffer_store_dwordx4 v[172:175], v7, s[12:15], s54 offen offset:3072 sc1
    s_mov_b32 exec_hi, -1
    s_waitcnt vmcnt(35)
    v_mfma_f32_16x16x32_bf16 v[136:139], v[192:195], v[56:59], 0
    s_waitcnt lgkmcnt(5)
    buffer_load_dwordx4 a[200:203], v244, s[12:15], s76 offen offset:0 sc1
    v_mfma_f32_16x16x32_bf16 v[140:143], v[192:195], v[60:63], 0
    ds_read_b128 v[192:195], v21 offset:7168
    v_mfma_f32_16x16x32_bf16 v[148:151], v[196:199], v[60:63], 0
    s_waitcnt lgkmcnt(5)
    v_mfma_f32_16x16x32_bf16 v[144:147], v[196:199], v[56:59], 0
    ds_read_b128 v[196:199], v21 offset:8192
    v_mfma_f32_16x16x32_bf16 v[152:155], v[200:203], v[56:59], 0
    s_waitcnt lgkmcnt(5)
    v_mfma_f32_16x16x32_bf16 v[156:159], v[200:203], v[60:63], 0
    ds_read_b128 v[200:203], v21 offset:9216
    v_mfma_f32_16x16x32_bf16 v[164:167], v[204:207], v[60:63], 0
    s_waitcnt lgkmcnt(5)
    v_mfma_f32_16x16x32_bf16 v[160:163], v[204:207], v[56:59], 0
    ds_read_b128 v[204:207], v21 offset:10240
    v_mfma_f32_16x16x32_bf16 v[168:171], v[208:211], v[56:59], 0
    s_waitcnt lgkmcnt(5)
    v_mfma_f32_16x16x32_bf16 v[172:175], v[208:211], v[60:63], 0
    ds_read_b128 v[208:211], v21 offset:11264
    v_mfma_f32_16x16x32_bf16 v[180:183], v[212:215], v[60:63], 0
    s_waitcnt lgkmcnt(5)
    v_mfma_f32_16x16x32_bf16 v[176:179], v[212:215], v[56:59], 0
    ds_read_b128 v[212:215], v21 offset:12288
    v_mfma_f32_16x16x32_bf16 v[184:187], v[216:219], v[56:59], 0
    s_waitcnt lgkmcnt(5)
    v_mfma_f32_16x16x32_bf16 v[188:191], v[216:219], v[60:63], 0
    ds_read_b128 v[216:219], v21 offset:13312
    s_waitcnt vmcnt(34)
    v_mfma_f32_16x16x32_bf16 v[136:139], v[192:195], v[64:67], v[136:139]
    s_waitcnt lgkmcnt(5)
    buffer_load_dwordx4 a[204:207], v244, s[12:15], s76 offen offset:1024 sc1
    v_mfma_f32_16x16x32_bf16 v[140:143], v[192:195], v[68:71], v[140:143]
    ds_read_b128 v[192:195], v21 offset:14336
    s_add_u32 s52, s30, 0xb45000
    v_mfma_f32_16x16x32_bf16 v[148:151], v[196:199], v[68:71], v[148:151]
    s_waitcnt lgkmcnt(5)
    buffer_load_dwordx4 v[56:59], v2, s[12:15], s52 offen offset:0 sc1
    v_mfma_f32_16x16x32_bf16 v[144:147], v[196:199], v[64:67], v[144:147]
    ds_read_b128 v[196:199], v21 offset:15360
    v_mfma_f32_16x16x32_bf16 v[152:155], v[200:203], v[64:67], v[152:155]
    s_waitcnt lgkmcnt(5)
    v_mfma_f32_16x16x32_bf16 v[156:159], v[200:203], v[68:71], v[156:159]
    ds_read_b128 v[200:203], v21 offset:16384
    v_mfma_f32_16x16x32_bf16 v[164:167], v[204:207], v[68:71], v[164:167]
    s_waitcnt lgkmcnt(5)
    buffer_load_dwordx4 v[60:63], v2, s[12:15], s52 offen offset:1024 sc1
    v_mfma_f32_16x16x32_bf16 v[160:163], v[204:207], v[64:67], v[160:163]
    ds_read_b128 v[204:207], v21 offset:17408
    v_mfma_f32_16x16x32_bf16 v[168:171], v[208:211], v[64:67], v[168:171]
    s_waitcnt lgkmcnt(5)
    v_mfma_f32_16x16x32_bf16 v[172:175], v[208:211], v[68:71], v[172:175]
    ds_read_b128 v[208:211], v21 offset:18432
    v_mfma_f32_16x16x32_bf16 v[180:183], v[212:215], v[68:71], v[180:183]
    s_waitcnt lgkmcnt(5)
    v_mfma_f32_16x16x32_bf16 v[176:179], v[212:215], v[64:67], v[176:179]
    ds_read_b128 v[212:215], v21 offset:19456
    v_mfma_f32_16x16x32_bf16 v[184:187], v[216:219], v[64:67], v[184:187]
    s_waitcnt lgkmcnt(5)
    v_mfma_f32_16x16x32_bf16 v[188:191], v[216:219], v[68:71], v[188:191]
    ds_read_b128 v[216:219], v21 offset:20480
    s_waitcnt vmcnt(34)
    v_mfma_f32_16x16x32_bf16 v[136:139], v[192:195], v[72:75], v[136:139]
    s_waitcnt lgkmcnt(5)
    buffer_load_dwordx4 a[208:211], v245, s[12:15], s76 offen offset:0 sc1
    v_mfma_f32_16x16x32_bf16 v[140:143], v[192:195], v[76:79], v[140:143]
    ds_read_b128 v[192:195], v21 offset:21504
    v_mfma_f32_16x16x32_bf16 v[148:151], v[196:199], v[76:79], v[148:151]
    s_waitcnt lgkmcnt(5)
    buffer_load_dwordx4 v[64:67], v2, s[12:15], s52 offen offset:2048 sc1
    v_mfma_f32_16x16x32_bf16 v[144:147], v[196:199], v[72:75], v[144:147]
    ds_read_b128 v[196:199], v21 offset:22528
    v_mfma_f32_16x16x32_bf16 v[152:155], v[200:203], v[72:75], v[152:155]
    s_waitcnt lgkmcnt(5)
    v_mfma_f32_16x16x32_bf16 v[156:159], v[200:203], v[76:79], v[156:159]
    ds_read_b128 v[200:203], v21 offset:23552
    v_mfma_f32_16x16x32_bf16 v[164:167], v[204:207], v[76:79], v[164:167]
    s_waitcnt lgkmcnt(5)
    buffer_load_dwordx4 v[68:71], v2, s[12:15], s52 offen offset:3072 sc1
    v_mfma_f32_16x16x32_bf16 v[160:163], v[204:207], v[72:75], v[160:163]
    ds_read_b128 v[204:207], v21 offset:24576
    v_mfma_f32_16x16x32_bf16 v[168:171], v[208:211], v[72:75], v[168:171]
    s_waitcnt lgkmcnt(5)
    v_mfma_f32_16x16x32_bf16 v[172:175], v[208:211], v[76:79], v[172:175]
    ds_read_b128 v[208:211], v21 offset:25600
    v_mfma_f32_16x16x32_bf16 v[180:183], v[212:215], v[76:79], v[180:183]
    s_waitcnt lgkmcnt(5)
    v_mfma_f32_16x16x32_bf16 v[176:179], v[212:215], v[72:75], v[176:179]
    ds_read_b128 v[212:215], v21 offset:26624
    v_mfma_f32_16x16x32_bf16 v[184:187], v[216:219], v[72:75], v[184:187]
    s_waitcnt lgkmcnt(5)
    v_mfma_f32_16x16x32_bf16 v[188:191], v[216:219], v[76:79], v[188:191]
    ds_read_b128 v[216:219], v21 offset:27648
    s_waitcnt vmcnt(34)
    v_mfma_f32_16x16x32_bf16 v[136:139], v[192:195], v[80:83], v[136:139]
    s_waitcnt lgkmcnt(5)
    buffer_load_dwordx4 a[212:215], v245, s[12:15], s76 offen offset:1024 sc1
    v_mfma_f32_16x16x32_bf16 v[140:143], v[192:195], v[84:87], v[140:143]
    ds_read_b128 v[192:195], v21 offset:28672
    s_add_u32 s52, s30, 0xb46000
    v_mfma_f32_16x16x32_bf16 v[148:151], v[196:199], v[84:87], v[148:151]
    s_waitcnt lgkmcnt(5)
    buffer_load_dwordx4 v[72:75], v2, s[12:15], s52 offen offset:0 sc1
    v_mfma_f32_16x16x32_bf16 v[144:147], v[196:199], v[80:83], v[144:147]
    ds_read_b128 v[196:199], v21 offset:29696
    v_mfma_f32_16x16x32_bf16 v[152:155], v[200:203], v[80:83], v[152:155]
    s_waitcnt lgkmcnt(5)
    v_mfma_f32_16x16x32_bf16 v[156:159], v[200:203], v[84:87], v[156:159]
    ds_read_b128 v[200:203], v21 offset:30720
    v_mfma_f32_16x16x32_bf16 v[164:167], v[204:207], v[84:87], v[164:167]
    s_waitcnt lgkmcnt(5)
    buffer_load_dwordx4 v[76:79], v2, s[12:15], s52 offen offset:1024 sc1
    v_mfma_f32_16x16x32_bf16 v[160:163], v[204:207], v[80:83], v[160:163]
    ds_read_b128 v[204:207], v21 offset:31744
    v_mfma_f32_16x16x32_bf16 v[168:171], v[208:211], v[80:83], v[168:171]
    s_waitcnt lgkmcnt(5)
    v_mfma_f32_16x16x32_bf16 v[172:175], v[208:211], v[84:87], v[172:175]
    ds_read_b128 v[208:211], v21 offset:32768
    v_mfma_f32_16x16x32_bf16 v[180:183], v[212:215], v[84:87], v[180:183]
    s_waitcnt lgkmcnt(5)
    v_mfma_f32_16x16x32_bf16 v[176:179], v[212:215], v[80:83], v[176:179]
    ds_read_b128 v[212:215], v21 offset:33792
    v_mfma_f32_16x16x32_bf16 v[184:187], v[216:219], v[80:83], v[184:187]
    s_waitcnt lgkmcnt(5)
    v_mfma_f32_16x16x32_bf16 v[188:191], v[216:219], v[84:87], v[188:191]
    ds_read_b128 v[216:219], v21 offset:34816
    s_waitcnt vmcnt(10)
    s_add_u32 s55, s46, 0x1710000
    s_mov_b64 exec, 1
    buffer_store_dword v19, v20, s[12:15], s55 offen sc1
    s_mov_b64 exec, -1
    v_mfma_f32_16x16x32_bf16 v[136:139], v[192:195], v[88:91], v[136:139]
    s_waitcnt lgkmcnt(5)
    buffer_load_dwordx4 a[216:219], v246, s[12:15], s76 offen offset:0 sc1
    s_add_u32 s76, s76, 5120
    v_mfma_f32_16x16x32_bf16 v[140:143], v[192:195], v[92:95], v[140:143]
    ds_read_b128 v[192:195], v21 offset:35840
    v_mfma_f32_16x16x32_bf16 v[148:151], v[196:199], v[92:95], v[148:151]
    s_waitcnt lgkmcnt(5)
    buffer_load_dwordx4 v[80:83], v2, s[12:15], s52 offen offset:2048 sc1
    v_mfma_f32_16x16x32_bf16 v[144:147], v[196:199], v[88:91], v[144:147]
    ds_read_b128 v[196:199], v21 offset:36864
    v_mfma_f32_16x16x32_bf16 v[152:155], v[200:203], v[88:91], v[152:155]
    s_waitcnt lgkmcnt(5)
    v_mfma_f32_16x16x32_bf16 v[156:159], v[200:203], v[92:95], v[156:159]
    ds_read_b128 v[200:203], v21 offset:37888
    v_mfma_f32_16x16x32_bf16 v[164:167], v[204:207], v[92:95], v[164:167]
    s_waitcnt lgkmcnt(5)
    buffer_load_dwordx4 v[84:87], v2, s[12:15], s52 offen offset:3072 sc1
    v_mfma_f32_16x16x32_bf16 v[160:163], v[204:207], v[88:91], v[160:163]
    ds_read_b128 v[204:207], v21 offset:38912
    v_mfma_f32_16x16x32_bf16 v[168:171], v[208:211], v[88:91], v[168:171]
    s_waitcnt lgkmcnt(5)
    v_mfma_f32_16x16x32_bf16 v[172:175], v[208:211], v[92:95], v[172:175]
    ds_read_b128 v[208:211], v21 offset:39936
    v_mfma_f32_16x16x32_bf16 v[180:183], v[212:215], v[92:95], v[180:183]
    s_waitcnt lgkmcnt(5)
    v_mfma_f32_16x16x32_bf16 v[176:179], v[212:215], v[88:91], v[176:179]
    ds_read_b128 v[212:215], v21 offset:40960
    v_mfma_f32_16x16x32_bf16 v[184:187], v[216:219], v[88:91], v[184:187]
    s_waitcnt lgkmcnt(5)
    v_mfma_f32_16x16x32_bf16 v[188:191], v[216:219], v[92:95], v[188:191]
    ds_read_b128 v[216:219], v21 offset:41984
    s_lshl_b32 s51, s2, 2
    s_add_u32 s51, s51, s3
    s_cmp_lg_u32 s51, 1023
    s_cbranch_scc1 L_fin_36
    v_lshrrev_b32 v254, 3, v0
    v_lshl_add_u32 v254, v254, 14, v13
    s_mov_b32 s55, 0x1690000
    buffer_load_dword v248, v254, s[12:15], s55 offen sc1
    s_mov_b32 s55, 0x1691000
    buffer_load_dword v249, v254, s[12:15], s55 offen sc1
    s_mov_b32 s55, 0x1692000
    buffer_load_dword v250, v254, s[12:15], s55 offen sc1
    s_mov_b32 s55, 0x1693000
    buffer_load_dword v251, v254, s[12:15], s55 offen sc1
L_fin_36:
    v_mfma_f32_16x16x32_bf16 v[136:139], v[192:195], v[96:99], v[136:139]
    s_waitcnt lgkmcnt(5)
    buffer_load_dwordx4 a[220:223], v244, s[12:15], s76 offen offset:0 sc1
    v_mfma_f32_16x16x32_bf16 v[140:143], v[192:195], v[100:103], v[140:143]
    ds_read_b128 v[192:195], v21 offset:43008
    s_add_u32 s52, s30, 0xb47000
    v_mfma_f32_16x16x32_bf16 v[148:151], v[196:199], v[100:103], v[148:151]
    s_waitcnt lgkmcnt(5)
    buffer_load_dwordx4 v[88:91], v2, s[12:15], s52 offen offset:0 sc1
    v_mfma_f32_16x16x32_bf16 v[144:147], v[196:199], v[96:99], v[144:147]
    ds_read_b128 v[196:199], v21 offset:44032
    v_mfma_f32_16x16x32_bf16 v[152:155], v[200:203], v[96:99], v[152:155]
    s_waitcnt lgkmcnt(5)
    v_mfma_f32_16x16x32_bf16 v[156:159], v[200:203], v[100:103], v[156:159]
    ds_read_b128 v[200:203], v21 offset:45056
    v_mfma_f32_16x16x32_bf16 v[164:167], v[204:207], v[100:103], v[164:167]
    s_waitcnt lgkmcnt(5)
    buffer_load_dwordx4 v[92:95], v2, s[12:15], s52 offen offset:1024 sc1
    v_mfma_f32_16x16x32_bf16 v[160:163], v[204:207], v[96:99], v[160:163]
    ds_read_b128 v[204:207], v21 offset:46080
    v_mfma_f32_16x16x32_bf16 v[168:171], v[208:211], v[96:99], v[168:171]
    s_waitcnt lgkmcnt(5)
    v_mfma_f32_16x16x32_bf16 v[172:175], v[208:211], v[100:103], v[172:175]
    ds_read_b128 v[208:211], v21 offset:47104
    v_mfma_f32_16x16x32_bf16 v[180:183], v[212:215], v[100:103], v[180:183]
    s_waitcnt lgkmcnt(5)
    v_mfma_f32_16x16x32_bf16 v[176:179], v[212:215], v[96:99], v[176:179]
    ds_read_b128 v[212:215], v21 offset:48128
    v_mfma_f32_16x16x32_bf16 v[184:187], v[216:219], v[96:99], v[184:187]
    s_waitcnt lgkmcnt(5)
    v_mfma_f32_16x16x32_bf16 v[188:191], v[216:219], v[100:103], v[188:191]
    ds_read_b128 v[216:219], v21 offset:49152
    v_mfma_f32_16x16x32_bf16 v[136:139], v[192:195], v[104:107], v[136:139]
    s_waitcnt lgkmcnt(5)
    buffer_load_dwordx4 a[224:227], v244, s[12:15], s76 offen offset:1024 sc1
    v_mfma_f32_16x16x32_bf16 v[140:143], v[192:195], v[108:111], v[140:143]
    ds_read_b128 v[192:195], v21 offset:50176
    v_mfma_f32_16x16x32_bf16 v[148:151], v[196:199], v[108:111], v[148:151]
    s_waitcnt lgkmcnt(5)
    buffer_load_dwordx4 v[96:99], v2, s[12:15], s52 offen offset:2048 sc1
    v_mfma_f32_16x16x32_bf16 v[144:147], v[196:199], v[104:107], v[144:147]
    ds_read_b128 v[196:199], v21 offset:51200
    v_mfma_f32_16x16x32_bf16 v[152:155], v[200:203], v[104:107], v[152:155]
    s_waitcnt lgkmcnt(5)
    v_mfma_f32_16x16x32_bf16 v[156:159], v[200:203], v[108:111], v[156:159]
    ds_read_b128 v[200:203], v21 offset:52224
    v_mfma_f32_16x16x32_bf16 v[164:167], v[204:207], v[108:111], v[164:167]
    s_waitcnt lgkmcnt(5)
    buffer_load_dwordx4 v[100:103], v2, s[12:15], s52 offen offset:3072 sc1
    v_mfma_f32_16x16x32_bf16 v[160:163], v[204:207], v[104:107], v[160:163]
    ds_read_b128 v[204:207], v21 offset:53248
    v_mfma_f32_16x16x32_bf16 v[168:171], v[208:211], v[104:107], v[168:171]
    s_waitcnt lgkmcnt(5)
    v_mfma_f32_16x16x32_bf16 v[172:175], v[208:211], v[108:111], v[172:175]
    ds_read_b128 v[208:211], v21 offset:54272
    v_mfma_f32_16x16x32_bf16 v[180:183], v[212:215], v[108:111], v[180:183]
    s_waitcnt lgkmcnt(5)
    v_mfma_f32_16x16x32_bf16 v[176:179], v[212:215], v[104:107], v[176:179]
    ds_read_b128 v[212:215], v21 offset:55296
    v_mfma_f32_16x16x32_bf16 v[184:187], v[216:219], v[104:107], v[184:187]
    s_waitcnt lgkmcnt(5)
    v_mfma_f32_16x16x32_bf16 v[188:191], v[216:219], v[108:111], v[188:191]
    ds_read_b128 v[216:219], v21 offset:56320
    v_mfma_f32_16x16x32_bf16 v[136:139], v[192:195], v[112:115], v[136:139]
    s_waitcnt lgkmcnt(5)
    buffer_load_dwordx4 a[228:231], v245, s[12:15], s76 offen offset:0 sc1
    v_mfma_f32_16x16x32_bf16 v[140:143], v[192:195], v[116:119], v[140:143]
    ds_read_b128 v[192:195], v21 offset:57344
    s_add_u32 s52, s30, 0xb48000
    v_mfma_f32_16x16x32_bf16 v[148:151], v[196:199], v[116:119], v[148:151]
    s_waitcnt lgkmcnt(5)
    buffer_load_dwordx4 v[104:107], v2, s[12:15], s52 offen offset:0 sc1
    v_mfma_f32_16x16x32_bf16 v[144:147], v[196:199], v[112:115], v[144:147]
    ds_read_b128 v[196:199], v21 offset:58368
    v_mfma_f32_16x16x32_bf16 v[152:155], v[200:203], v[112:115], v[152:155]
    s_waitcnt lgkmcnt(5)
    v_mfma_f32_16x16x32_bf16 v[156:159], v[200:203], v[116:119], v[156:159]
    ds_read_b128 v[200:203], v21 offset:59392
    v_mfma_f32_16x16x32_bf16 v[164:167], v[204:207], v[116:119], v[164:167]
    s_waitcnt lgkmcnt(5)
    buffer_load_dwordx4 v[108:111], v2, s[12:15], s52 offen offset:1024 sc1
    v_mfma_f32_16x16x32_bf16 v[160:163], v[204:207], v[112:115], v[160:163]
    ds_read_b128 v[204:207], v21 offset:60416
    v_mfma_f32_16x16x32_bf16 v[168:171], v[208:211], v[112:115], v[168:171]
    s_waitcnt lgkmcnt(5)
    v_mfma_f32_16x16x32_bf16 v[172:175], v[208:211], v[116:119], v[172:175]
    ds_read_b128 v[208:211], v21 offset:61440
    v_mfma_f32_16x16x32_bf16 v[180:183], v[212:215], v[116:119], v[180:183]
    s_waitcnt lgkmcnt(5)
    v_mfma_f32_16x16x32_bf16 v[176:179], v[212:215], v[112:115], v[176:179]
    ds_read_b128 v[212:215], v21 offset:62464
    v_mfma_f32_16x16x32_bf16 v[184:187], v[216:219], v[112:115], v[184:187]
    s_waitcnt lgkmcnt(5)
    v_mfma_f32_16x16x32_bf16 v[188:191], v[216:219], v[116:119], v[188:191]
    ds_read_b128 v[216:219], v21 offset:63488
    v_mfma_f32_16x16x32_bf16 v[136:139], v[192:195], v[120:123], v[136:139]
    s_waitcnt lgkmcnt(5)
    buffer_load_dwordx4 a[232:235], v245, s[12:15], s76 offen offset:1024 sc1
    v_mfma_f32_16x16x32_bf16 v[140:143], v[192:195], v[124:127], v[140:143]
    ds_read_b128 v[192:195], v21 offset:64512
    v_mfma_f32_16x16x32_bf16 v[148:151], v[196:199], v[124:127], v[148:151]
    s_waitcnt lgkmcnt(5)
    buffer_load_dwordx4 v[112:115], v2, s[12:15], s52 offen offset:2048 sc1
    v_mfma_f32_16x16x32_bf16 v[144:147], v[196:199], v[120:123], v[144:147]
    ds_read_b128 v[196:199], v3 offset:0
    v_mfma_f32_16x16x32_bf16 v[152:155], v[200:203], v[120:123], v[152:155]
    s_waitcnt lgkmcnt(5)
    v_mfma_f32_16x16x32_bf16 v[156:159], v[200:203], v[124:127], v[156:159]
    ds_read_b128 v[200:203], v3 offset:1024
    v_mfma_f32_16x16x32_bf16 v[164:167], v[204:207], v[124:127], v[164:167]
    s_waitcnt lgkmcnt(5)
    buffer_load_dwordx4 v[116:119], v2, s[12:15], s52 offen offset:3072 sc1
    v_mfma_f32_16x16x32_bf16 v[160:163], v[204:207], v[120:123], v[160:163]
    ds_read_b128 v[204:207], v3 offset:2048
    v_mfma_f32_16x16x32_bf16 v[168:171], v[208:211], v[120:123], v[168:171]
    s_waitcnt lgkmcnt(5)
    v_mfma_f32_16x16x32_bf16 v[172:175], v[208:211], v[124:127], v[172:175]
    ds_read_b128 v[208:211], v3 offset:3072
    v_mfma_f32_16x16x32_bf16 v[180:183], v[212:215], v[124:127], v[180:183]
    s_waitcnt lgkmcnt(5)
    v_mfma_f32_16x16x32_bf16 v[176:179], v[212:215], v[120:123], v[176:179]
    ds_read_b128 v[212:215], v3 offset:4096
    v_mfma_f32_16x16x32_bf16 v[184:187], v[216:219], v[120:123], v[184:187]
    s_waitcnt lgkmcnt(5)
    v_mfma_f32_16x16x32_bf16 v[188:191], v[216:219], v[124:127], v[188:191]
    ds_read_b128 v[216:219], v3 offset:5120
    v_mfma_f32_16x16x32_bf16 v[136:139], v[192:195], v[128:131], v[136:139]
    s_waitcnt lgkmcnt(5)
    buffer_load_dwordx4 a[236:239], v246, s[12:15], s76 offen offset:0 sc1
    v_mfma_f32_16x16x32_bf16 v[140:143], v[192:195], v[132:135], v[140:143]
    ds_read_b128 v[192:195], v3 offset:6144
    s_add_u32 s52, s30, 0xb49000
    v_mfma_f32_16x16x32_bf16 v[148:151], v[196:199], v[132:135], v[148:151]
    s_waitcnt lgkmcnt(5)
    buffer_load_dwordx4 v[120:123], v2, s[12:15], s52 offen offset:0 sc1
    v_mfma_f32_16x16x32_bf16 v[144:147], v[196:199], v[128:131], v[144:147]
    ds_read_b128 v[196:199], v3 offset:7168
    v_mfma_f32_16x16x32_bf16 v[152:155], v[200:203], v[128:131], v[152:155]
    s_waitcnt lgkmcnt(5)
    v_mfma_f32_16x16x32_bf16 v[156:159], v[200:203], v[132:135], v[156:159]
    ds_read_b128 v[200:203], v3 offset:8192
    v_mfma_f32_16x16x32_bf16 v[164:167], v[204:207], v[132:135], v[164:167]
    s_waitcnt lgkmcnt(5)
    buffer_load_dwordx4 v[124:127], v2, s[12:15], s52 offen offset:1024 sc1
    v_mfma_f32_16x16x32_bf16 v[160:163], v[204:207], v[128:131], v[160:163]
    ds_read_b128 v[204:207], v3 offset:9216
    v_mfma_f32_16x16x32_bf16 v[168:171], v[208:211], v[128:131], v[168:171]
    s_waitcnt lgkmcnt(5)
    v_mfma_f32_16x16x32_bf16 v[172:175], v[208:211], v[132:135], v[172:175]
    ds_read_b128 v[208:211], v3 offset:10240
    v_mfma_f32_16x16x32_bf16 v[180:183], v[212:215], v[132:135], v[180:183]
    s_waitcnt lgkmcnt(5)
    v_mfma_f32_16x16x32_bf16 v[176:179], v[212:215], v[128:131], v[176:179]
    ds_read_b128 v[212:215], v3 offset:11264
    v_mfma_f32_16x16x32_bf16 v[184:187], v[216:219], v[128:131], v[184:187]
    s_waitcnt lgkmcnt(5)
    v_mfma_f32_16x16x32_bf16 v[188:191], v[216:219], v[132:135], v[188:191]
    ds_read_b128 v[216:219], v3 offset:12288
    s_add_u32 s55, s44, 0x1710000
    buffer_load_dword v18, v13, s[12:15], s55 offen sc1
    s_waitcnt vmcnt(26)
    v_mfma_f32_16x16x32_bf16 v[136:139], v[192:195], v[56:59], v[136:139]
    s_waitcnt lgkmcnt(5)
    buffer_load_dwordx4 a[240:243], v244, s[12:15], s77 offen offset:0 sc1
    v_mfma_f32_16x16x32_bf16 v[140:143], v[192:195], v[60:63], v[140:143]
    ds_read_b128 v[192:195], v3 offset:13312
    v_mfma_f32_16x16x32_bf16 v[148:151], v[196:199], v[60:63], v[148:151]
    s_waitcnt lgkmcnt(5)
    buffer_load_dwordx4 v[128:131], v2, s[12:15], s52 offen offset:2048 sc1
    v_mfma_f32_16x16x32_bf16 v[144:147], v[196:199], v[56:59], v[144:147]
    ds_read_b128 v[196:199], v3 offset:14336
    v_mfma_f32_16x16x32_bf16 v[152:155], v[200:203], v[56:59], v[152:155]
    s_waitcnt lgkmcnt(5)
    v_mfma_f32_16x16x32_bf16 v[156:159], v[200:203], v[60:63], v[156:159]
    ds_read_b128 v[200:203], v3 offset:15360
    v_mfma_f32_16x16x32_bf16 v[164:167], v[204:207], v[60:63], v[164:167]
    s_waitcnt lgkmcnt(5)
    buffer_load_dwordx4 v[132:135], v2, s[12:15], s52 offen offset:3072 sc1
    v_mfma_f32_16x16x32_bf16 v[160:163], v[204:207], v[56:59], v[160:163]
    ds_read_b128 v[204:207], v3 offset:16384
    v_mfma_f32_16x16x32_bf16 v[168:171], v[208:211], v[56:59], v[168:171]
    s_waitcnt lgkmcnt(5)
    v_mfma_f32_16x16x32_bf16 v[172:175], v[208:211], v[60:63], v[172:175]
    ds_read_b128 v[208:211], v3 offset:17408
    v_mfma_f32_16x16x32_bf16 v[180:183], v[212:215], v[60:63], v[180:183]
    s_waitcnt lgkmcnt(5)
    v_mfma_f32_16x16x32_bf16 v[176:179], v[212:215], v[56:59], v[176:179]
    ds_read_b128 v[212:215], v3 offset:18432
    v_mfma_f32_16x16x32_bf16 v[184:187], v[216:219], v[56:59], v[184:187]
    s_waitcnt lgkmcnt(5)
    v_mfma_f32_16x16x32_bf16 v[188:191], v[216:219], v[60:63], v[188:191]
    ds_read_b128 v[216:219], v3 offset:19456
    s_waitcnt vmcnt(26)
    v_mfma_f32_16x16x32_bf16 v[136:139], v[192:195], v[64:67], v[136:139]
    s_waitcnt lgkmcnt(5)
    buffer_load_dwordx4 a[244:247], v244, s[12:15], s77 offen offset:1024 sc1
    v_mfma_f32_16x16x32_bf16 v[140:143], v[192:195], v[68:71], v[140:143]
    ds_read_b128 v[192:195], v3 offset:20480
    v_mfma_f32_16x16x32_bf16 v[148:151], v[196:199], v[68:71], v[148:151]
    s_waitcnt lgkmcnt(5)
    v_mfma_f32_16x16x32_bf16 v[144:147], v[196:199], v[64:67], v[144:147]
    ds_read_b128 v[196:199], v3 offset:21504
    v_mfma_f32_16x16x32_bf16 v[152:155], v[200:203], v[64:67], v[152:155]
    s_waitcnt lgkmcnt(5)
    v_mfma_f32_16x16x32_bf16 v[156:159], v[200:203], v[68:71], v[156:159]
    ds_read_b128 v[200:203], v3 offset:22528
    v_mfma_f32_16x16x32_bf16 v[164:167], v[204:207], v[68:71], v[164:167]
    s_waitcnt lgkmcnt(5)
    v_mfma_f32_16x16x32_bf16 v[160:163], v[204:207], v[64:67], v[160:163]
    ds_read_b128 v[204:207], v3 offset:23552
    v_mfma_f32_16x16x32_bf16 v[168:171], v[208:211], v[64:67], v[168:171]
    s_waitcnt lgkmcnt(5)
    v_mfma_f32_16x16x32_bf16 v[172:175], v[208:211], v[68:71], v[172:175]
    ds_read_b128 v[208:211], v3 offset:24576
    v_mfma_f32_16x16x32_bf16 v[180:183], v[212:215], v[68:71], v[180:183]
    s_waitcnt lgkmcnt(5)
    v_mfma_f32_16x16x32_bf16 v[176:179], v[212:215], v[64:67], v[176:179]
    ds_read_b128 v[212:215], v3 offset:25600
    v_mfma_f32_16x16x32_bf16 v[184:187], v[216:219], v[64:67], v[184:187]
    s_waitcnt lgkmcnt(5)
    v_mfma_f32_16x16x32_bf16 v[188:191], v[216:219], v[68:71], v[188:191]
    ds_read_b128 v[216:219], v3 offset:26624
    s_waitcnt vmcnt(24)
    v_mfma_f32_16x16x32_bf16 v[136:139], v[192:195], v[72:75], v[136:139]
    s_waitcnt lgkmcnt(5)
    buffer_load_dwordx4 a[248:251], v245, s[12:15], s77 offen offset:0 sc1
    v_mfma_f32_16x16x32_bf16 v[140:143], v[192:195], v[76:79], v[140:143]
    ds_read_b128 v[192:195], v3 offset:27648
    v_mfma_f32_16x16x32_bf16 v[148:151], v[196:199], v[76:79], v[148:151]
    s_waitcnt lgkmcnt(5)
    v_mfma_f32_16x16x32_bf16 v[144:147], v[196:199], v[72:75], v[144:147]
    ds_read_b128 v[196:199], v3 offset:28672
    v_mfma_f32_16x16x32_bf16 v[152:155], v[200:203], v[72:75], v[152:155]
    s_waitcnt lgkmcnt(5)
    v_mfma_f32_16x16x32_bf16 v[156:159], v[200:203], v[76:79], v[156:159]
    ds_read_b128 v[200:203], v3 offset:29696
    v_mfma_f32_16x16x32_bf16 v[164:167], v[204:207], v[76:79], v[164:167]
    s_waitcnt lgkmcnt(5)
    v_mfma_f32_16x16x32_bf16 v[160:163], v[204:207], v[72:75], v[160:163]
    ds_read_b128 v[204:207], v3 offset:30720
    v_mfma_f32_16x16x32_bf16 v[168:171], v[208:211], v[72:75], v[168:171]
    s_waitcnt lgkmcnt(5)
    v_mfma_f32_16x16x32_bf16 v[172:175], v[208:211], v[76:79], v[172:175]
    ds_read_b128 v[208:211], v3 offset:31744
    v_mfma_f32_16x16x32_bf16 v[180:183], v[212:215], v[76:79], v[180:183]
    s_waitcnt lgkmcnt(5)
    v_mfma_f32_16x16x32_bf16 v[176:179], v[212:215], v[72:75], v[176:179]
    ds_read_b128 v[212:215], v3 offset:32768
    v_mfma_f32_16x16x32_bf16 v[184:187], v[216:219], v[72:75], v[184:187]
    s_waitcnt lgkmcnt(5)
    v_mfma_f32_16x16x32_bf16 v[188:191], v[216:219], v[76:79], v[188:191]
    ds_read_b128 v[216:219], v3 offset:33792
    s_waitcnt vmcnt(21)
    v_mfma_f32_16x16x32_bf16 v[136:139], v[192:195], v[80:83], v[136:139]
    s_waitcnt lgkmcnt(5)
    buffer_load_dwordx4 a[252:255], v245, s[12:15], s77 offen offset:1024 sc1
    v_mfma_f32_16x16x32_bf16 v[140:143], v[192:195], v[84:87], v[140:143]
    ds_read_b128 v[192:195], v3 offset:34816
    v_mfma_f32_16x16x32_bf16 v[148:151], v[196:199], v[84:87], v[148:151]
    s_waitcnt lgkmcnt(5)
    v_mfma_f32_16x16x32_bf16 v[144:147], v[196:199], v[80:83], v[144:147]
    ds_read_b128 v[196:199], v3 offset:35840
    v_mfma_f32_16x16x32_bf16 v[152:155], v[200:203], v[80:83], v[152:155]
    s_waitcnt lgkmcnt(5)
    v_mfma_f32_16x16x32_bf16 v[156:159], v[200:203], v[84:87], v[156:159]
    ds_read_b128 v[200:203], v3 offset:36864
    v_mfma_f32_16x16x32_bf16 v[164:167], v[204:207], v[84:87], v[164:167]
    s_waitcnt lgkmcnt(5)
    v_mfma_f32_16x16x32_bf16 v[160:163], v[204:207], v[80:83], v[160:163]
    ds_read_b128 v[204:207], v3 offset:37888
    v_mfma_f32_16x16x32_bf16 v[168:171], v[208:211], v[80:83], v[168:171]
    s_waitcnt lgkmcnt(5)
    v_mfma_f32_16x16x32_bf16 v[172:175], v[208:211], v[84:87], v[172:175]
    ds_read_b128 v[208:211], v3 offset:38912
    v_mfma_f32_16x16x32_bf16 v[180:183], v[212:215], v[84:87], v[180:183]
    s_waitcnt lgkmcnt(5)
    v_mfma_f32_16x16x32_bf16 v[176:179], v[212:215], v[80:83], v[176:179]
    ds_read_b128 v[212:215], v3 offset:39936
    v_mfma_f32_16x16x32_bf16 v[184:187], v[216:219], v[80:83], v[184:187]
    s_waitcnt lgkmcnt(5)
    v_mfma_f32_16x16x32_bf16 v[188:191], v[216:219], v[84:87], v[188:191]
    ds_read_b128 v[216:219], v3 offset:40960
    s_waitcnt vmcnt(6)
L_chk_37:
    v_cmp_ne_u32 vcc, v19, v18
    s_cbranch_vccz L_ok_38
    s_cmp_eq_u32 s50, 0
    s_cbranch_scc1 L_ok_38
    s_sub_u32 s50, s50, 1
    s_sleep 1
    s_mov_b64 exec, vcc
    s_add_u32 s55, s44, 0x1710000
    buffer_load_dword v18, v13, s[12:15], s55 offen sc1
    s_mov_b64 exec, -1
    s_waitcnt vmcnt(0)
    s_branch L_chk_37
L_ok_38:
    s_lshr_b32 s55, s48, 4
    s_add_u32 s55, s55, 0x780000
    buffer_load_dwordx2 v[252:253], v12, s[12:15], s55 offen sc1
    v_mfma_f32_16x16x32_bf16 v[136:139], v[192:195], v[88:91], v[136:139]
    s_waitcnt lgkmcnt(5)
    buffer_load_dwordx4 v[32:35], v246, s[12:15], s77 offen offset:0 sc1
    s_add_u32 s77, s77, 5120
    v_mfma_f32_16x16x32_bf16 v[140:143], v[192:195], v[92:95], v[140:143]
    ds_read_b128 v[192:195], v3 offset:41984
    s_add_u32 s52, s64, 0x17d0000
    v_mfma_f32_16x16x32_bf16 v[148:151], v[196:199], v[92:95], v[148:151]
    s_waitcnt lgkmcnt(5)
    buffer_load_dwordx4 v[56:59], v6, s[12:15], s52 offen sc1
    v_mfma_f32_16x16x32_bf16 v[144:147], v[196:199], v[88:91], v[144:147]
    ds_read_b128 v[196:199], v3 offset:43008
    v_mfma_f32_16x16x32_bf16 v[152:155], v[200:203], v[88:91], v[152:155]
    s_waitcnt lgkmcnt(5)
    v_mfma_f32_16x16x32_bf16 v[156:159], v[200:203], v[92:95], v[156:159]
    ds_read_b128 v[200:203], v3 offset:44032
    v_mfma_f32_16x16x32_bf16 v[164:167], v[204:207], v[92:95], v[164:167]
    s_waitcnt lgkmcnt(5)
    buffer_load_dwordx4 v[60:63], v6, s[12:15], s52 offen offset:2048 sc1
    v_mfma_f32_16x16x32_bf16 v[160:163], v[204:207], v[88:91], v[160:163]
    ds_read_b128 v[204:207], v3 offset:45056
    v_mfma_f32_16x16x32_bf16 v[168:171], v[208:211], v[88:91], v[168:171]
    s_waitcnt lgkmcnt(5)
    v_mfma_f32_16x16x32_bf16 v[172:175], v[208:211], v[92:95], v[172:175]
    ds_read_b128 v[208:211], v3 offset:46080
    s_add_u32 s52, s65, 0x17d0000
    v_mfma_f32_16x16x32_bf16 v[180:183], v[212:215], v[92:95], v[180:183]
    s_waitcnt lgkmcnt(5)
    buffer_load_dwordx4 v[64:67], v6, s[12:15], s52 offen sc1
    v_mfma_f32_16x16x32_bf16 v[176:179], v[212:215], v[88:91], v[176:179]
    ds_read_b128 v[212:215], v3 offset:47104
    v_mfma_f32_16x16x32_bf16 v[184:187], v[216:219], v[88:91], v[184:187]
    s_waitcnt lgkmcnt(5)
    buffer_load_dwordx4 v[68:71], v6, s[12:15], s52 offen offset:2048 sc1
    v_mfma_f32_16x16x32_bf16 v[188:191], v[216:219], v[92:95], v[188:191]
    ds_read_b128 v[216:219], v3 offset:48128
    v_mfma_f32_16x16x32_bf16 v[136:139], v[192:195], v[96:99], v[136:139]
    s_waitcnt lgkmcnt(5)
    buffer_load_dwordx4 v[36:39], v244, s[12:15], s77 offen offset:0 sc1
    v_mfma_f32_16x16x32_bf16 v[140:143], v[192:195], v[100:103], v[140:143]
    ds_read_b128 v[192:195], v3 offset:49152
    s_add_u32 s52, s66, 0x17d0000
    v_mfma_f32_16x16x32_bf16 v[148:151], v[196:199], v[100:103], v[148:151]
    s_waitcnt lgkmcnt(5)
    buffer_load_dwordx4 v[72:75], v6, s[12:15], s52 offen sc1
    v_mfma_f32_16x16x32_bf16 v[144:147], v[196:199], v[96:99], v[144:147]
    ds_read_b128 v[196:199], v3 offset:50176
    v_mfma_f32_16x16x32_bf16 v[152:155], v[200:203], v[96:99], v[152:155]
    s_waitcnt lgkmcnt(5)
    v_mfma_f32_16x16x32_bf16 v[156:159], v[200:203], v[100:103], v[156:159]
    ds_read_b128 v[200:203], v3 offset:51200
    v_mfma_f32_16x16x32_bf16 v[164:167], v[204:207], v[100:103], v[164:167]
    s_waitcnt lgkmcnt(5)
    buffer_load_dwordx4 v[76:79], v6, s[12:15], s52 offen offset:2048 sc1
    v_mfma_f32_16x16x32_bf16 v[160:163], v[204:207], v[96:99], v[160:163]
    ds_read_b128 v[204:207], v3 offset:52224
    v_mfma_f32_16x16x32_bf16 v[168:171], v[208:211], v[96:99], v[168:171]
    s_waitcnt lgkmcnt(5)
    v_mfma_f32_16x16x32_bf16 v[172:175], v[208:211], v[100:103], v[172:175]
    ds_read_b128 v[208:211], v3 offset:53248
    s_add_u32 s52, s67, 0x17d0000
    v_mfma_f32_16x16x32_bf16 v[180:183], v[212:215], v[100:103], v[180:183]
    s_waitcnt lgkmcnt(5)
    buffer_load_dwordx4 v[80:83], v6, s[12:15], s52 offen sc1
    v_mfma_f32_16x16x32_bf16 v[176:179], v[212:215], v[96:99], v[176:179]
    ds_read_b128 v[212:215], v3 offset:54272
    v_mfma_f32_16x16x32_bf16 v[184:187], v[216:219], v[96:99], v[184:187]
    s_waitcnt lgkmcnt(5)
    buffer_load_dwordx4 v[84:87], v6, s[12:15], s52 offen offset:2048 sc1
    v_mfma_f32_16x16x32_bf16 v[188:191], v[216:219], v[100:103], v[188:191]
    ds_read_b128 v[216:219], v3 offset:55296
    s_lshl_b32 s51, s2, 2
    s_add_u32 s51, s51, s3
    s_cmp_lg_u32 s51, 1023
    s_cbranch_scc1 L_fin_39
    v_lshrrev_b32 v254, 3, v0
    v_lshl_add_u32 v254, v254, 14, v13
L_chk_40:
    v_xor_b32 v26, v248, v19
    v_xor_b32 v27, v249, v19
    v_xor_b32 v28, v250, v19
    v_xor_b32 v29, v251, v19
    v_or3_b32 v26, v26, v27, v28
    v_or_b32 v26, v26, v29
    v_cmp_ne_u32 vcc, 0, v26
    s_cbranch_vccz L_ok_41
    s_cmp_eq_u32 s50, 0
    s_cbranch_scc1 L_ok_41
    s_sub_u32 s50, s50, 1
    s_sleep 1
    s_mov_b64 exec, vcc
    s_mov_b32 s55, 0x1690000
    buffer_load_dword v248, v254, s[12:15], s55 offen sc1
    s_mov_b32 s55, 0x1691000
    buffer_load_dword v249, v254, s[12:15], s55 offen sc1
    s_mov_b32 s55, 0x1692000
    buffer_load_dword v250, v254, s[12:15], s55 offen sc1
    s_mov_b32 s55, 0x1693000
    buffer_load_dword v251, v254, s[12:15], s55 offen sc1
    s_mov_b64 exec, -1
    s_waitcnt vmcnt(0)
    s_branch L_chk_40
L_ok_41:
    s_mov_b32 s63, 0x17c3000
    s_mov_b64 exec, 1
    buffer_store_dword v19, v20, s[12:15], s63 offen sc1
    s_mov_b64 exec, -1
L_fin_39:
    v_mfma_f32_16x16x32_bf16 v[136:139], v[192:195], v[104:107], v[136:139]
    s_waitcnt lgkmcnt(5)
    buffer_load_dwordx4 v[40:43], v244, s[12:15], s77 offen offset:1024 sc1
    v_mfma_f32_16x16x32_bf16 v[140:143], v[192:195], v[108:111], v[140:143]
    ds_read_b128 v[192:195], v3 offset:56320
    s_add_u32 s52, s68, 0x17d0000
    v_mfma_f32_16x16x32_bf16 v[148:151], v[196:199], v[108:111], v[148:151]
    s_waitcnt lgkmcnt(5)
    buffer_load_dwordx4 v[88:91], v6, s[12:15], s52 offen sc1
    v_mfma_f32_16x16x32_bf16 v[144:147], v[196:199], v[104:107], v[144:147]
    ds_read_b128 v[196:199], v3 offset:57344
    v_mfma_f32_16x16x32_bf16 v[152:155], v[200:203], v[104:107], v[152:155]
    s_waitcnt lgkmcnt(5)
    v_mfma_f32_16x16x32_bf16 v[156:159], v[200:203], v[108:111], v[156:159]
    ds_read_b128 v[200:203], v3 offset:58368
    v_mfma_f32_16x16x32_bf16 v[164:167], v[204:207], v[108:111], v[164:167]
    s_waitcnt lgkmcnt(5)
    buffer_load_dwordx4 v[92:95], v6, s[12:15], s52 offen offset:2048 sc1
    v_mfma_f32_16x16x32_bf16 v[160:163], v[204:207], v[104:107], v[160:163]
    ds_read_b128 v[204:207], v3 offset:59392
    v_mfma_f32_16x16x32_bf16 v[168:171], v[208:211], v[104:107], v[168:171]
    s_waitcnt lgkmcnt(5)
    v_mfma_f32_16x16x32_bf16 v[172:175], v[208:211], v[108:111], v[172:175]
    ds_read_b128 v[208:211], v3 offset:60416
    s_add_u32 s52, s69, 0x17d0000
    v_mfma_f32_16x16x32_bf16 v[180:183], v[212:215], v[108:111], v[180:183]
    s_waitcnt lgkmcnt(5)
    buffer_load_dwordx4 v[96:99], v6, s[12:15], s52 offen sc1
    v_mfma_f32_16x16x32_bf16 v[176:179], v[212:215], v[104:107], v[176:179]
    ds_read_b128 v[212:215], v3 offset:61440
    v_mfma_f32_16x16x32_bf16 v[184:187], v[216:219], v[104:107], v[184:187]
    s_waitcnt lgkmcnt(5)
    buffer_load_dwordx4 v[100:103], v6, s[12:15], s52 offen offset:2048 sc1
    v_mfma_f32_16x16x32_bf16 v[188:191], v[216:219], v[108:111], v[188:191]
    ds_read_b128 v[216:219], v3 offset:62464
    v_mfma_f32_16x16x32_bf16 v[136:139], v[192:195], v[112:115], v[136:139]
    s_waitcnt lgkmcnt(5)
    buffer_load_dwordx4 v[44:47], v245, s[12:15], s77 offen offset:0 sc1
    v_mfma_f32_16x16x32_bf16 v[140:143], v[192:195], v[116:119], v[140:143]
    ds_read_b128 v[192:195], v3 offset:63488
    s_add_u32 s52, s70, 0x17d0000
    v_mfma_f32_16x16x32_bf16 v[148:151], v[196:199], v[116:119], v[148:151]
    s_waitcnt lgkmcnt(5)
    buffer_load_dwordx4 v[104:107], v6, s[12:15], s52 offen sc1
    v_mfma_f32_16x16x32_bf16 v[144:147], v[196:199], v[112:115], v[144:147]
    ds_read_b128 v[196:199], v3 offset:64512
    v_mfma_f32_16x16x32_bf16 v[152:155], v[200:203], v[112:115], v[152:155]
    s_waitcnt lgkmcnt(5)
    v_mfma_f32_16x16x32_bf16 v[156:159], v[200:203], v[116:119], v[156:159]
    ds_read_b128 v[200:203], v4 offset:0
    v_mfma_f32_16x16x32_bf16 v[164:167], v[204:207], v[116:119], v[164:167]
    s_waitcnt lgkmcnt(5)
    buffer_load_dwordx4 v[108:111], v6, s[12:15], s52 offen offset:2048 sc1
    v_mfma_f32_16x16x32_bf16 v[160:163], v[204:207], v[112:115], v[160:163]
    ds_read_b128 v[204:207], v4 offset:1024
    v_mfma_f32_16x16x32_bf16 v[168:171], v[208:211], v[112:115], v[168:171]
    s_waitcnt lgkmcnt(5)
    v_mfma_f32_16x16x32_bf16 v[172:175], v[208:211], v[116:119], v[172:175]
    ds_read_b128 v[208:211], v4 offset:2048
    v_mfma_f32_16x16x32_bf16 v[180:183], v[212:215], v[116:119], v[180:183]
    s_waitcnt lgkmcnt(5)
    v_mfma_f32_16x16x32_bf16 v[176:179], v[212:215], v[112:115], v[176:179]
    ds_read_b128 v[212:215], v4 offset:3072
    v_mfma_f32_16x16x32_bf16 v[184:187], v[216:219], v[112:115], v[184:187]
    s_waitcnt lgkmcnt(5)
    v_mfma_f32_16x16x32_bf16 v[188:191], v[216:219], v[116:119], v[188:191]
    ds_read_b128 v[216:219], v4 offset:4096
    v_mfma_f32_16x16x32_bf16 v[136:139], v[192:195], v[120:123], v[136:139]
    s_waitcnt lgkmcnt(5)
    buffer_load_dwordx4 v[48:51], v245, s[12:15], s77 offen offset:1024 sc1
    v_mfma_f32_16x16x32_bf16 v[140:143], v[192:195], v[124:127], v[140:143]
    ds_read_b128 v[192:195], v4 offset:5120
    s_add_u32 s52, s64, 0x17d0000
    v_mfma_f32_16x16x32_bf16 v[148:151], v[196:199], v[124:127], v[148:151]
    s_waitcnt lgkmcnt(5)
    buffer_load_dwordx4 v[112:115], v5, s[12:15], s52 offen sc1
    v_mfma_f32_16x16x32_bf16 v[144:147], v[196:199], v[120:123], v[144:147]
    ds_read_b128 v[196:199], v4 offset:6144
    v_mfma_f32_16x16x32_bf16 v[152:155], v[200:203], v[120:123], v[152:155]
    s_waitcnt lgkmcnt(5)
    v_mfma_f32_16x16x32_bf16 v[156:159], v[200:203], v[124:127], v[156:159]
    ds_read_b128 v[200:203], v4 offset:7168
    v_mfma_f32_16x16x32_bf16 v[164:167], v[204:207], v[124:127], v[164:167]
    s_waitcnt lgkmcnt(5)
    buffer_load_dwordx4 v[116:119], v5, s[12:15], s52 offen offset:2048 sc1
    v_mfma_f32_16x16x32_bf16 v[160:163], v[204:207], v[120:123], v[160:163]
    ds_read_b128 v[204:207], v4 offset:8192
    v_mfma_f32_16x16x32_bf16 v[168:171], v[208:211], v[120:123], v[168:171]
    s_waitcnt lgkmcnt(5)
    v_mfma_f32_16x16x32_bf16 v[172:175], v[208:211], v[124:127], v[172:175]
    ds_read_b128 v[208:211], v4 offset:9216
    v_mfma_f32_16x16x32_bf16 v[180:183], v[212:215], v[124:127], v[180:183]
    s_waitcnt lgkmcnt(5)
    v_mfma_f32_16x16x32_bf16 v[176:179], v[212:215], v[120:123], v[176:179]
    ds_read_b128 v[212:215], v4 offset:10240
    v_mfma_f32_16x16x32_bf16 v[184:187], v[216:219], v[120:123], v[184:187]
    s_waitcnt lgkmcnt(5)
    v_mfma_f32_16x16x32_bf16 v[188:191], v[216:219], v[124:127], v[188:191]
    ds_read_b128 v[216:219], v4 offset:11264
    s_waitcnt vmcnt(25)
    v_mfma_f32_16x16x32_bf16 v[136:139], v[192:195], v[128:131], v[136:139]
    s_waitcnt lgkmcnt(5)
    buffer_load_dwordx4 v[52:55], v246, s[12:15], s77 offen offset:0 sc1
    v_mfma_f32_16x16x32_bf16 v[140:143], v[192:195], v[132:135], v[140:143]
    s_add_u32 s52, s65, 0x17d0000
    v_mfma_f32_16x16x32_bf16 v[148:151], v[196:199], v[132:135], v[148:151]
    s_waitcnt lgkmcnt(4)
    buffer_load_dwordx4 v[120:123], v5, s[12:15], s52 offen sc1
    v_mfma_f32_16x16x32_bf16 v[144:147], v[196:199], v[128:131], v[144:147]
    v_mfma_f32_16x16x32_bf16 v[152:155], v[200:203], v[128:131], v[152:155]
    s_waitcnt lgkmcnt(3)
    v_mfma_f32_16x16x32_bf16 v[156:159], v[200:203], v[132:135], v[156:159]
    s_add_u32 s54, s34, 0x1b50000
    v_pk_mul_f32 v[136:137], v[136:137], v[138:139]
    v_pk_mul_f32 v[140:141], v[140:141], v[142:143]
    v_cvt_pk_bf16_f32 v136, v136, v137
    v_cvt_pk_bf16_f32 v140, v140, v141
    v_mfma_f32_16x16x32_bf16 v[164:167], v[204:207], v[132:135], v[164:167]
    s_waitcnt lgkmcnt(2)
    buffer_load_dwordx4 v[124:127], v5, s[12:15], s52 offen offset:2048 sc1
    v_mfma_f32_16x16x32_bf16 v[160:163], v[204:207], v[128:131], v[160:163]
    v_pk_mul_f32 v[144:145], v[144:145], v[146:147]
    v_pk_mul_f32 v[148:149], v[148:149], v[150:151]
    v_cvt_pk_bf16_f32 v137, v144, v145
    v_cvt_pk_bf16_f32 v141, v148, v149
    v_mfma_f32_16x16x32_bf16 v[168:171], v[208:211], v[128:131], v[168:171]
    s_waitcnt lgkmcnt(1)
    v_mfma_f32_16x16x32_bf16 v[172:175], v[208:211], v[132:135], v[172:175]
    v_pk_mul_f32 v[152:153], v[152:153], v[154:155]
    v_pk_mul_f32 v[156:157], v[156:157], v[158:159]
    v_cvt_pk_bf16_f32 v138, v152, v153
    v_cvt_pk_bf16_f32 v142, v156, v157
    v_mfma_f32_16x16x32_bf16 v[180:183], v[212:215], v[132:135], v[180:183]
    s_waitcnt lgkmcnt(0)
    v_mfma_f32_16x16x32_bf16 v[176:179], v[212:215], v[128:131], v[176:179]
    v_pk_mul_f32 v[160:161], v[160:161], v[162:163]
    v_pk_mul_f32 v[164:165], v[164:165], v[166:167]
    v_cvt_pk_bf16_f32 v139, v160, v161
    v_cvt_pk_bf16_f32 v143, v164, v165
    buffer_store_dwordx4 v[136:139], v7, s[12:15], s54 offen offset:0 sc1
    buffer_store_dwordx4 v[140:143], v7, s[12:15], s54 offen offset:1024 sc1
    v_mfma_f32_16x16x32_bf16 v[184:187], v[216:219], v[128:131], v[184:187]
    v_mfma_f32_16x16x32_bf16 v[188:191], v[216:219], v[132:135], v[188:191]
    v_pk_mul_f32 v[168:169], v[168:169], v[170:171]
    v_pk_mul_f32 v[172:173], v[172:173], v[174:175]
    v_cvt_pk_bf16_f32 v168, v168, v169
    v_cvt_pk_bf16_f32 v172, v172, v173
    v_pk_mul_f32 v[176:177], v[176:177], v[178:179]
    v_pk_mul_f32 v[180:181], v[180:181], v[182:183]
    v_cvt_pk_bf16_f32 v169, v176, v177
    v_cvt_pk_bf16_f32 v173, v180, v181
    s_nop 3
    v_pk_mul_f32 v[184:185], v[184:185], v[186:187]
    v_pk_mul_f32 v[188:189], v[188:189], v[190:191]
    v_cvt_pk_bf16_f32 v170, v184, v185
    v_cvt_pk_bf16_f32 v174, v188, v189
    v_mov_b32 v24, v170
    v_mov_b32 v25, v168
    v_mov_b32 v28, v174
    s_add_u32 s52, s66, 0x17d0000
    buffer_load_dwordx4 v[128:131], v5, s[12:15], s52 offen sc1
    v_mov_b32 v29, v172
    s_nop 0
    v_permlane16_swap_b32 v24, v171
    v_permlane16_swap_b32 v25, v26
    v_permlane16_swap_b32 v28, v175
    v_permlane16_swap_b32 v29, v30
    s_nop 0
    v_mov_b32_dpp v26, v169 quad_perm:[0,1,2,3] row_mask:0x8 bank_mask:0xf
    v_mov_b32_dpp v30, v173 quad_perm:[0,1,2,3] row_mask:0x8 bank_mask:0xf
    s_nop 1
    v_permlane32_swap_b32 v26, v171
    v_permlane32_swap_b32 v30, v175
    buffer_load_dwordx4 v[132:135], v5, s[12:15], s52 offen offset:2048 sc1
    s_mov_b32 exec_hi, 0xffff
    buffer_store_dwordx4 v[168:171], v7, s[12:15], s54 offen offset:2048 sc1
    s_mov_b32 exec_hi, -1
    s_mov_b32 exec_hi, 0xffff
    buffer_store_dwordx4 v[172:175], v7, s[12:15], s54 offen offset:3072 sc1
    s_mov_b32 exec_hi, -1
    s_waitcnt vmcnt(27)
    s_waitcnt vmcnt(8)
    v_mfma_f32_16x16x32_bf16 v[196:199], a[0:3], v[56:59], 0
    v_mfma_f32_16x16x32_bf16 v[200:203], a[4:7], v[56:59], 0
    v_mfma_f32_16x16x32_bf16 v[204:207], a[8:11], v[56:59], 0
    v_mfma_f32_16x16x32_bf16 v[208:211], a[12:15], v[56:59], 0
    v_mfma_f32_16x16x32_bf16 v[212:215], a[16:19], v[56:59], 0
    v_mfma_f32_16x16x32_bf16 v[196:199], a[20:23], v[60:63], v[196:199]
    v_mfma_f32_16x16x32_bf16 v[200:203], a[24:27], v[60:63], v[200:203]
    v_mfma_f32_16x16x32_bf16 v[204:207], a[28:31], v[60:63], v[204:207]
    v_mfma_f32_16x16x32_bf16 v[208:211], a[32:35], v[60:63], v[208:211]
    v_mfma_f32_16x16x32_bf16 v[212:215], a[36:39], v[60:63], v[212:215]
    v_mfma_f32_16x16x32_bf16 v[196:199], a[40:43], v[64:67], v[196:199]
    s_add_u32 s52, s67, 0x17d0000
    v_mfma_f32_16x16x32_bf16 v[200:203], a[44:47], v[64:67], v[200:203]
    buffer_load_dwordx4 v[56:59], v5, s[12:15], s52 offen sc1
    v_mfma_f32_16x16x32_bf16 v[204:207], a[48:51], v[64:67], v[204:207]
    v_lshlrev_b32 v176, 16, v220
    v_and_b32 v177, 0xffff0000, v220
    v_mfma_f32_16x16x32_bf16 v[208:211], a[52:55], v[64:67], v[208:211]
    buffer_load_dwordx4 v[60:63], v5, s[12:15], s52 offen offset:2048 sc1
    v_mfma_f32_16x16x32_bf16 v[212:215], a[56:59], v[64:67], v[212:215]
    v_lshlrev_b32 v178, 16, v221
    v_and_b32 v179, 0xffff0000, v221
    v_mfma_f32_16x16x32_bf16 v[196:199], a[60:63], v[68:71], v[196:199]
    v_lshlrev_b32 v180, 16, v222
    v_and_b32 v181, 0xffff0000, v222
    v_mfma_f32_16x16x32_bf16 v[200:203], a[64:67], v[68:71], v[200:203]
    v_lshlrev_b32 v182, 16, v223
    v_and_b32 v183, 0xffff0000, v223
    v_mfma_f32_16x16x32_bf16 v[204:207], a[68:71], v[68:71], v[204:207]
    v_lshlrev_b32 v192, 16, v224
    v_and_b32 v193, 0xffff0000, v224
    v_mfma_f32_16x16x32_bf16 v[208:211], a[72:75], v[68:71], v[208:211]
    v_lshlrev_b32 v194, 16, v225
    v_and_b32 v195, 0xffff0000, v225
    v_mfma_f32_16x16x32_bf16 v[212:215], a[76:79], v[68:71], v[212:215]
    v_lshlrev_b32 v22, 16, v232
    v_and_b32 v23, 0xffff0000, v232
    v_mfma_f32_16x16x32_bf16 v[196:199], a[80:83], v[72:75], v[196:199]
    s_add_u32 s52, s68, 0x17d0000
    v_fma_f32 v250, v176, v253, v252
    v_mfma_f32_16x16x32_bf16 v[200:203], a[84:87], v[72:75], v[200:203]
    buffer_load_dwordx4 v[64:67], v5, s[12:15], s52 offen sc1
    v_mfma_f32_16x16x32_bf16 v[204:207], a[88:91], v[72:75], v[204:207]
    v_fma_f32 v251, v177, v253, v252
    v_fma_f32 v176, v250, v22, v176
    v_mfma_f32_16x16x32_bf16 v[208:211], a[92:95], v[72:75], v[208:211]
    buffer_load_dwordx4 v[68:71], v5, s[12:15], s52 offen offset:2048 sc1
    v_mfma_f32_16x16x32_bf16 v[212:215], a[96:99], v[72:75], v[212:215]
    v_fma_f32 v177, v251, v23, v177
    v_lshlrev_b32 v24, 16, v233
    v_mfma_f32_16x16x32_bf16 v[196:199], a[100:103], v[76:79], v[196:199]
    v_and_b32 v25, 0xffff0000, v233
    v_fma_f32 v250, v178, v253, v252
    v_mfma_f32_16x16x32_bf16 v[200:203], a[104:107], v[76:79], v[200:203]
    v_fma_f32 v251, v179, v253, v252
    v_fma_f32 v178, v250, v24, v178
    v_mfma_f32_16x16x32_bf16 v[204:207], a[108:111], v[76:79], v[204:207]
    v_fma_f32 v179, v251, v25, v179
    v_lshlrev_b32 v26, 16, v234
    v_mfma_f32_16x16x32_bf16 v[208:211], a[112:115], v[76:79], v[208:211]
    v_and_b32 v27, 0xffff0000, v234
    v_fma_f32 v250, v180, v253, v252
    v_mfma_f32_16x16x32_bf16 v[212:215], a[116:119], v[76:79], v[212:215]
    v_fma_f32 v251, v181, v253, v252
    v_fma_f32 v180, v250, v26, v180
    v_mfma_f32_16x16x32_bf16 v[196:199], a[120:123], v[80:83], v[196:199]
    s_add_u32 s52, s69, 0x17d0000
    v_fma_f32 v181, v251, v27, v181
    v_mfma_f32_16x16x32_bf16 v[200:203], a[124:127], v[80:83], v[200:203]
    buffer_load_dwordx4 v[72:75], v5, s[12:15], s52 offen sc1
    v_mfma_f32_16x16x32_bf16 v[204:207], a[128:131], v[80:83], v[204:207]
    v_lshlrev_b32 v28, 16, v235
    v_and_b32 v29, 0xffff0000, v235
    v_mfma_f32_16x16x32_bf16 v[208:211], a[132:135], v[80:83], v[208:211]
    buffer_load_dwordx4 v[76:79], v5, s[12:15], s52 offen offset:2048 sc1
    v_mfma_f32_16x16x32_bf16 v[212:215], a[136:139], v[80:83], v[212:215]
    v_fma_f32 v250, v182, v253, v252
    v_fma_f32 v251, v183, v253, v252
    v_mfma_f32_16x16x32_bf16 v[196:199], a[140:143], v[84:87], v[196:199]
    v_fma_f32 v182, v250, v28, v182
    v_fma_f32 v183, v251, v29, v183
    v_mfma_f32_16x16x32_bf16 v[200:203], a[144:147], v[84:87], v[200:203]
    v_lshlrev_b32 v30, 16, v236
    v_and_b32 v31, 0xffff0000, v236
    v_mfma_f32_16x16x32_bf16 v[204:207], a[148:151], v[84:87], v[204:207]
    v_fma_f32 v250, v192, v253, v252
    v_fma_f32 v251, v193, v253, v252
    v_mfma_f32_16x16x32_bf16 v[208:211], a[152:155], v[84:87], v[208:211]
    v_fma_f32 v192, v250, v30, v192
    v_fma_f32 v193, v251, v31, v193
    v_mfma_f32_16x16x32_bf16 v[212:215], a[156:159], v[84:87], v[212:215]
    v_lshlrev_b32 v248, 16, v237
    v_and_b32 v249, 0xffff0000, v237
    v_mfma_f32_16x16x32_bf16 v[196:199], a[160:163], v[88:91], v[196:199]
    s_add_u32 s52, s70, 0x17d0000
    v_fma_f32 v250, v194, v253, v252
    v_mfma_f32_16x16x32_bf16 v[200:203], a[164:167], v[88:91], v[200:203]
    buffer_load_dwordx4 v[80:83], v5, s[12:15], s52 offen sc1
    v_mfma_f32_16x16x32_bf16 v[204:207], a[168:171], v[88:91], v[204:207]
    v_fma_f32 v251, v195, v253, v252
    v_fma_f32 v194, v250, v248, v194
    v_mfma_f32_16x16x32_bf16 v[208:211], a[172:175], v[88:91], v[208:211]
    buffer_load_dwordx4 v[84:87], v5, s[12:15], s52 offen offset:2048 sc1
    v_mfma_f32_16x16x32_bf16 v[212:215], a[176:179], v[88:91], v[212:215]
    v_fma_f32 v195, v251, v249, v195
    v_mul_f32 v252, v22, v22
    v_mfma_f32_16x16x32_bf16 v[196:199], a[180:183], v[92:95], v[196:199]
    v_mul_f32 v253, v23, v23
    v_add_f32 v250, v22, v24
    v_mfma_f32_16x16x32_bf16 v[200:203], a[184:187], v[92:95], v[200:203]
    v_add_f32 v251, v23, v25
    v_fma_f32 v252, v24, v24, v252
    v_mfma_f32_16x16x32_bf16 v[204:207], a[188:191], v[92:95], v[204:207]
    v_fma_f32 v253, v25, v25, v253
    v_add_f32 v250, v250, v26
    v_mfma_f32_16x16x32_bf16 v[208:211], a[192:195], v[92:95], v[208:211]
    v_add_f32 v251, v251, v27
    v_fma_f32 v252, v26, v26, v252
    v_mfma_f32_16x16x32_bf16 v[212:215], a[196:199], v[92:95], v[212:215]
    v_fma_f32 v253, v27, v27, v253
    v_add_f32 v250, v250, v28
    v_mfma_f32_16x16x32_bf16 v[196:199], a[200:203], v[96:99], v[196:199]
    v_add_f32 v251, v251, v29
    v_fma_f32 v252, v28, v28, v252
    v_mfma_f32_16x16x32_bf16 v[200:203], a[204:207], v[96:99], v[200:203]
    v_fma_f32 v253, v29, v29, v253
    v_add_f32 v250, v250, v30
    v_mfma_f32_16x16x32_bf16 v[204:207], a[208:211], v[96:99], v[204:207]
    v_add_f32 v251, v251, v31
    v_fma_f32 v252, v30, v30, v252
    v_mfma_f32_16x16x32_bf16 v[208:211], a[212:215], v[96:99], v[208:211]
    v_fma_f32 v253, v31, v31, v253
    v_add_f32 v250, v250, v248
    v_mfma_f32_16x16x32_bf16 v[212:215], a[216:219], v[96:99], v[212:215]
    v_add_f32 v251, v251, v249
    v_fma_f32 v252, v248, v248, v252
    v_mfma_f32_16x16x32_bf16 v[196:199], a[220:223], v[100:103], v[196:199]
    v_fma_f32 v253, v249, v249, v253
    v_add_f32 v250, v250, v251
    v_mfma_f32_16x16x32_bf16 v[200:203], a[224:227], v[100:103], v[200:203]
    v_add_f32 v252, v252, v253
    v_mfma_f32_16x16x32_bf16 v[204:207], a[228:231], v[100:103], v[204:207]
    v_mfma_f32_16x16x32_bf16 v[208:211], a[232:235], v[100:103], v[208:211]
    v_mfma_f32_16x16x32_bf16 v[212:215], a[236:239], v[100:103], v[212:215]
    s_waitcnt vmcnt(8)
    s_add_u32 s55, s46, 0x1730000
    s_mov_b64 exec, 1
    buffer_store_dword v19, v20, s[12:15], s55 offen sc1
    s_mov_b64 exec, -1
    v_mfma_f32_16x16x32_bf16 v[196:199], a[240:243], v[104:107], v[196:199]
    v_mfma_f32_16x16x32_bf16 v[200:203], a[244:247], v[104:107], v[200:203]
    v_mfma_f32_16x16x32_bf16 v[204:207], a[248:251], v[104:107], v[204:207]
    v_mfma_f32_16x16x32_bf16 v[208:211], a[252:255], v[104:107], v[208:211]
    v_mfma_f32_16x16x32_bf16 v[212:215], v[32:35], v[104:107], v[212:215]
    v_mfma_f32_16x16x32_bf16 v[196:199], v[36:39], v[108:111], v[196:199]
    v_mfma_f32_16x16x32_bf16 v[200:203], v[40:43], v[108:111], v[200:203]
    v_mfma_f32_16x16x32_bf16 v[204:207], v[44:47], v[108:111], v[204:207]
    v_mfma_f32_16x16x32_bf16 v[208:211], v[48:51], v[108:111], v[208:211]
    v_mfma_f32_16x16x32_bf16 v[212:215], v[52:55], v[108:111], v[212:215]
    s_nop 1
    v_mfma_f32_16x16x32_bf16 v[176:179], a[0:3], v[112:115], v[176:179]
    v_mfma_f32_16x16x32_bf16 v[180:183], a[4:7], v[112:115], v[180:183]
    v_mfma_f32_16x16x32_bf16 v[184:187], a[8:11], v[112:115], 0
    v_mfma_f32_16x16x32_bf16 v[188:191], a[12:15], v[112:115], 0
    v_mfma_f32_16x16x32_bf16 v[192:195], a[16:19], v[112:115], v[192:195]
    v_mfma_f32_16x16x32_bf16 v[176:179], a[20:23], v[116:119], v[176:179]
    v_mfma_f32_16x16x32_bf16 v[180:183], a[24:27], v[116:119], v[180:183]
    v_mfma_f32_16x16x32_bf16 v[184:187], a[28:31], v[116:119], v[184:187]
    v_mfma_f32_16x16x32_bf16 v[188:191], a[32:35], v[116:119], v[188:191]
    v_mfma_f32_16x16x32_bf16 v[192:195], a[36:39], v[116:119], v[192:195]
    v_mfma_f32_16x16x32_bf16 v[176:179], a[40:43], v[120:123], v[176:179]
    s_barrier
    ds_write_b128 v15, v[196:199] offset:0
    v_mfma_f32_16x16x32_bf16 v[180:183], a[44:47], v[120:123], v[180:183]
    ds_write_b128 v15, v[200:203] offset:1024
    ds_write_b128 v15, v[204:207] offset:2048
    v_mfma_f32_16x16x32_bf16 v[184:187], a[48:51], v[120:123], v[184:187]
    ds_write_b128 v15, v[208:211] offset:3072
    ds_write_b128 v15, v[212:215] offset:4096
    v_mfma_f32_16x16x32_bf16 v[188:191], a[52:55], v[120:123], v[188:191]
    v_mfma_f32_16x16x32_bf16 v[192:195], a[56:59], v[120:123], v[192:195]
    v_mfma_f32_16x16x32_bf16 v[176:179], a[60:63], v[124:127], v[176:179]
    v_mfma_f32_16x16x32_bf16 v[180:183], a[64:67], v[124:127], v[180:183]
    v_mfma_f32_16x16x32_bf16 v[184:187], a[68:71], v[124:127], v[184:187]
    v_mfma_f32_16x16x32_bf16 v[188:191], a[72:75], v[124:127], v[188:191]
    v_mfma_f32_16x16x32_bf16 v[192:195], a[76:79], v[124:127], v[192:195]
    v_mfma_f32_16x16x32_bf16 v[176:179], a[80:83], v[128:131], v[176:179]
    s_waitcnt lgkmcnt(0)
    s_barrier
    v_mfma_f32_16x16x32_bf16 v[180:183], a[84:87], v[128:131], v[180:183]
    ds_read_b128 v[196:199], v16 offset:0
    ds_read_b128 v[200:203], v16 offset:1024
    v_mfma_f32_16x16x32_bf16 v[184:187], a[88:91], v[128:131], v[184:187]
    ds_read_b128 v[204:207], v16 offset:4096
    ds_read_b128 v[208:211], v1 offset:2048
    v_mfma_f32_16x16x32_bf16 v[188:191], a[92:95], v[128:131], v[188:191]
    ds_read_b128 v[212:215], v1 offset:3072
    v_mfma_f32_16x16x32_bf16 v[192:195], a[96:99], v[128:131], v[192:195]
    v_mfma_f32_16x16x32_bf16 v[176:179], a[100:103], v[132:135], v[176:179]
    v_mfma_f32_16x16x32_bf16 v[180:183], a[104:107], v[132:135], v[180:183]
    v_mfma_f32_16x16x32_bf16 v[184:187], a[108:111], v[132:135], v[184:187]
    v_mfma_f32_16x16x32_bf16 v[188:191], a[112:115], v[132:135], v[188:191]
    v_mfma_f32_16x16x32_bf16 v[192:195], a[116:119], v[132:135], v[192:195]
    s_add_u32 s55, s44, 0x1730000
    buffer_load_dword v18, v13, s[12:15], s55 offen sc1
    s_waitcnt vmcnt(8)
    v_mfma_f32_16x16x32_bf16 v[176:179], a[120:123], v[56:59], v[176:179]
    s_waitcnt lgkmcnt(0)
    v_add_f32 v196, v196, v208
    v_mfma_f32_16x16x32_bf16 v[180:183], a[124:127], v[56:59], v[180:183]
    v_add_f32 v197, v197, v209
    v_add_f32 v198, v198, v210
    v_mfma_f32_16x16x32_bf16 v[184:187], a[128:131], v[56:59], v[184:187]
    v_add_f32 v199, v199, v211
    ds_read_b128 v[208:211], v1 offset:4096
    v_mfma_f32_16x16x32_bf16 v[188:191], a[132:135], v[56:59], v[188:191]
    v_add_f32 v200, v200, v212
    v_add_f32 v201, v201, v213
    v_mfma_f32_16x16x32_bf16 v[192:195], a[136:139], v[56:59], v[192:195]
    v_add_f32 v202, v202, v214
    v_add_f32 v203, v203, v215
    v_mfma_f32_16x16x32_bf16 v[176:179], a[140:143], v[60:63], v[176:179]
    v_mfma_f32_16x16x32_bf16 v[180:183], a[144:147], v[60:63], v[180:183]
    v_mfma_f32_16x16x32_bf16 v[184:187], a[148:151], v[60:63], v[184:187]
    v_mfma_f32_16x16x32_bf16 v[188:191], a[152:155], v[60:63], v[188:191]
    v_mfma_f32_16x16x32_bf16 v[192:195], a[156:159], v[60:63], v[192:195]
    s_waitcnt vmcnt(6)
    v_mfma_f32_16x16x32_bf16 v[176:179], a[160:163], v[64:67], v[176:179]
    s_waitcnt lgkmcnt(0)
    s_barrier
    v_mfma_f32_16x16x32_bf16 v[180:183], a[164:167], v[64:67], v[180:183]
    v_add_f32 v204, v204, v208
    v_add_f32 v205, v205, v209
    v_mfma_f32_16x16x32_bf16 v[184:187], a[168:171], v[64:67], v[184:187]
    v_add_f32 v206, v206, v210
    v_add_f32 v207, v207, v211
    v_mfma_f32_16x16x32_bf16 v[188:191], a[172:175], v[64:67], v[188:191]
    v_mfma_f32_16x16x32_bf16 v[192:195], a[176:179], v[64:67], v[192:195]
    v_mfma_f32_16x16x32_bf16 v[176:179], a[180:183], v[68:71], v[176:179]
    v_mfma_f32_16x16x32_bf16 v[180:183], a[184:187], v[68:71], v[180:183]
    v_mfma_f32_16x16x32_bf16 v[184:187], a[188:191], v[68:71], v[184:187]
    v_mfma_f32_16x16x32_bf16 v[188:191], a[192:195], v[68:71], v[188:191]
    v_mfma_f32_16x16x32_bf16 v[192:195], a[196:199], v[68:71], v[192:195]
    s_waitcnt vmcnt(4)
    v_mfma_f32_16x16x32_bf16 v[176:179], a[200:203], v[72:75], v[176:179]
    v_mfma_f32_16x16x32_bf16 v[180:183], a[204:207], v[72:75], v[180:183]
    v_mfma_f32_16x16x32_bf16 v[184:187], a[208:211], v[72:75], v[184:187]
    v_mfma_f32_16x16x32_bf16 v[188:191], a[212:215], v[72:75], v[188:191]
    v_mfma_f32_16x16x32_bf16 v[192:195], a[216:219], v[72:75], v[192:195]
    v_mfma_f32_16x16x32_bf16 v[176:179], a[220:223], v[76:79], v[176:179]
    v_mfma_f32_16x16x32_bf16 v[180:183], a[224:227], v[76:79], v[180:183]
    v_mfma_f32_16x16x32_bf16 v[184:187], a[228:231], v[76:79], v[184:187]
    v_mfma_f32_16x16x32_bf16 v[188:191], a[232:235], v[76:79], v[188:191]
    v_mfma_f32_16x16x32_bf16 v[192:195], a[236:239], v[76:79], v[192:195]
    s_waitcnt vmcnt(2)
    v_mfma_f32_16x16x32_bf16 v[184:187], a[248:251], v[80:83], v[184:187]
    v_mfma_f32_16x16x32_bf16 v[188:191], a[252:255], v[80:83], v[188:191]
    v_mfma_f32_16x16x32_bf16 v[192:195], v[32:35], v[80:83], v[192:195]
    v_mfma_f32_16x16x32_bf16 v[184:187], v[44:47], v[84:87], v[184:187]
    v_mfma_f32_16x16x32_bf16 v[188:191], v[48:51], v[84:87], v[188:191]
    v_mfma_f32_16x16x32_bf16 v[192:195], v[52:55], v[84:87], v[192:195]
    v_mfma_f32_16x16x32_bf16 v[176:179], a[240:243], v[80:83], v[176:179]
    v_mfma_f32_16x16x32_bf16 v[180:183], a[244:247], v[80:83], v[180:183]
    v_mfma_f32_16x16x32_bf16 v[176:179], v[36:39], v[84:87], v[176:179]
    v_mfma_f32_16x16x32_bf16 v[180:183], v[40:43], v[84:87], v[180:183]
    s_nop 2
    ds_write_b128 v15, v[184:187] offset:2048
    ds_write_b128 v15, v[188:191] offset:3072
    ds_write_b128 v15, v[192:195] offset:4096
    s_nop 3
    v_pk_add_f32 v[176:177], v[176:177], v[196:197]
    v_pk_add_f32 v[178:179], v[178:179], v[198:199]
    v_pk_add_f32 v[180:181], v[180:181], v[200:201]
    v_pk_add_f32 v[182:183], v[182:183], v[202:203]
    s_waitcnt lgkmcnt(0)
    s_barrier
    ds_read_b128 v[208:211], v17 offset:2048
    ds_read_b128 v[212:215], v17 offset:3072
    ds_read_b128 v[184:187], v17 offset:4096
    v_pk_add_f32 v[192:193], v[192:193], v[204:205]
    v_pk_add_f32 v[194:195], v[194:195], v[206:207]
    s_waitcnt vmcnt(0)
L_chk_42:
    v_cmp_ne_u32 vcc, v19, v18
    s_cbranch_vccz L_ok_43
    s_cmp_eq_u32 s50, 0
    s_cbranch_scc1 L_ok_43
    s_sub_u32 s50, s50, 1
    s_sleep 1
    s_mov_b64 exec, vcc
    s_add_u32 s55, s44, 0x1730000
    buffer_load_dword v18, v13, s[12:15], s55 offen sc1
    s_mov_b64 exec, -1
    s_waitcnt vmcnt(0)
    s_branch L_chk_42
L_ok_43:
    s_add_u32 s52, s64, 0x1b50000
    buffer_load_dwordx4 v[88:91], v6, s[12:15], s52 offen sc1
    buffer_load_dwordx4 v[92:95], v6, s[12:15], s52 offen offset:2048 sc1
    s_add_u32 s52, s65, 0x1b50000
    buffer_load_dwordx4 v[96:99], v6, s[12:15], s52 offen sc1
    buffer_load_dwordx4 v[100:103], v6, s[12:15], s52 offen offset:2048 sc1
    s_add_u32 s52, s66, 0x1b50000
    buffer_load_dwordx4 v[104:107], v6, s[12:15], s52 offen sc1
    buffer_load_dwordx4 v[108:111], v6, s[12:15], s52 offen offset:2048 sc1
    s_add_u32 s52, s67, 0x1b50000
    buffer_load_dwordx4 v[112:115], v6, s[12:15], s52 offen sc1
    buffer_load_dwordx4 v[116:119], v6, s[12:15], s52 offen offset:2048 sc1
    s_waitcnt lgkmcnt(2)
    v_pk_add_f32 v[176:177], v[176:177], v[208:209]
    v_pk_add_f32 v[178:179], v[178:179], v[210:211]
    s_waitcnt lgkmcnt(1)
    v_pk_add_f32 v[180:181], v[180:181], v[212:213]
    v_pk_add_f32 v[182:183], v[182:183], v[214:215]
    s_waitcnt lgkmcnt(0)
    v_pk_add_f32 v[192:193], v[192:193], v[184:185]
    v_pk_add_f32 v[194:195], v[194:195], v[186:187]
    v_cndmask_b32 v192, 0, v192, s[56:57]
    v_cndmask_b32 v193, 0, v193, s[56:57]
    v_cndmask_b32 v194, 0, v194, s[56:57]
    v_cndmask_b32 v195, 0, v195, s[56:57]
    v_pk_mul_f32 v[200:201], v[176:177], v[22:23]
    v_pk_mul_f32 v[198:199], v[176:177], v[176:177]
    v_pk_mul_f32 v[202:203], v[200:201], v[176:177]
    v_pk_mul_f32 v[204:205], v[200:201], v[200:201]
    v_pk_mul_f32 v[206:207], v[200:201], v[22:23]
    v_pk_mul_f32 v[186:187], v[178:179], v[24:25]
    v_pk_add_f32 v[196:197], v[176:177], v[178:179]
    v_pk_fma_f32 v[198:199], v[178:179], v[178:179], v[198:199]
    v_pk_add_f32 v[200:201], v[200:201], v[186:187]
    v_pk_fma_f32 v[202:203], v[186:187], v[178:179], v[202:203]
    v_pk_fma_f32 v[204:205], v[186:187], v[186:187], v[204:205]
    v_pk_fma_f32 v[206:207], v[186:187], v[24:25], v[206:207]
    v_pk_mul_f32 v[184:185], v[180:181], v[26:27]
    v_pk_add_f32 v[196:197], v[196:197], v[180:181]
    v_pk_fma_f32 v[198:199], v[180:181], v[180:181], v[198:199]
    v_pk_add_f32 v[200:201], v[200:201], v[184:185]
    v_pk_fma_f32 v[202:203], v[184:185], v[180:181], v[202:203]
    v_pk_fma_f32 v[204:205], v[184:185], v[184:185], v[204:205]
    v_pk_fma_f32 v[206:207], v[184:185], v[26:27], v[206:207]
    v_pk_mul_f32 v[186:187], v[182:183], v[28:29]
    v_pk_add_f32 v[196:197], v[196:197], v[182:183]
    v_pk_fma_f32 v[198:199], v[182:183], v[182:183], v[198:199]
    v_pk_add_f32 v[200:201], v[200:201], v[186:187]
    v_pk_fma_f32 v[202:203], v[186:187], v[182:183], v[202:203]
    v_pk_fma_f32 v[204:205], v[186:187], v[186:187], v[204:205]
    v_pk_fma_f32 v[206:207], v[186:187], v[28:29], v[206:207]
    v_pk_mul_f32 v[184:185], v[192:193], v[30:31]
    v_pk_add_f32 v[196:197], v[196:197], v[192:193]
    v_pk_fma_f32 v[198:199], v[192:193], v[192:193], v[198:199]
    v_pk_add_f32 v[200:201], v[200:201], v[184:185]
    v_pk_fma_f32 v[202:203], v[184:185], v[192:193], v[202:203]
    v_pk_fma_f32 v[204:205], v[184:185], v[184:185], v[204:205]
    v_pk_fma_f32 v[206:207], v[184:185], v[30:31], v[206:207]
    v_pk_mul_f32 v[186:187], v[194:195], v[248:249]
    v_pk_add_f32 v[196:197], v[196:197], v[194:195]
    v_pk_fma_f32 v[198:199], v[194:195], v[194:195], v[198:199]
    v_pk_add_f32 v[200:201], v[200:201], v[186:187]
    v_pk_fma_f32 v[202:203], v[186:187], v[194:195], v[202:203]
    v_pk_fma_f32 v[204:205], v[186:187], v[186:187], v[204:205]
    v_pk_fma_f32 v[206:207], v[186:187], v[248:249], v[206:207]
    v_add_f32 v196, v196, v197
    v_add_f32 v198, v198, v199
    v_add_f32 v200, v200, v201
    v_add_f32 v202, v202, v203
    v_add_f32 v204, v204, v205
    v_add_f32 v206, v206, v207
    v_permlane32_swap_b32 v250, v252
    v_permlane32_swap_b32 v196, v198
    v_permlane32_swap_b32 v200, v202
    v_permlane32_swap_b32 v204, v206
    v_add_f32 v250, v250, v252
    v_add_f32 v196, v196, v198
    v_add_f32 v200, v200, v202
    v_add_f32 v204, v204, v206
    s_nop 0
    v_permlane16_swap_b32 v196, v200
    v_permlane16_swap_b32 v204, v250
    v_add_f32 v188, v196, v200
    v_add_f32 v189, v204, v250
    v_mov_b32 v190, 0x7f800000
    v_cmp_lt_f32 vcc, |v188|, v190
    v_cmp_lt_f32 s[6:7], |v189|, v190
    s_nop 0
    v_cndmask_b32 v188, v190, v188, vcc
    v_cndmask_b32 v189, v190, v189, s[6:7]
    s_add_u32 s55, s49, 0x280000
    buffer_store_dwordx2 v[188:189], v14, s[12:15], s55 offen
    s_add_u32 s55, s49, 0x1590000
    buffer_store_dwordx2 v[188:189], v14, s[12:15], s55 offen sc1
    s_lshr_b32 s55, s48, 4
    s_add_u32 s55, s55, 0x788000
    buffer_load_dwordx2 v[252:253], v12, s[12:15], s55 offen sc1
    s_add_u32 s52, s68, 0x1b50000
    buffer_load_dwordx4 v[120:123], v6, s[12:15], s52 offen sc1
    buffer_load_dwordx4 v[124:127], v6, s[12:15], s52 offen offset:2048 sc1
    s_add_u32 s52, s69, 0x1b50000
    buffer_load_dwordx4 v[128:131], v6, s[12:15], s52 offen sc1
    buffer_load_dwordx4 v[132:135], v6, s[12:15], s52 offen offset:2048 sc1
    s_add_u32 s52, s70, 0x1b50000
    buffer_load_dwordx4 v[56:59], v6, s[12:15], s52 offen sc1
    buffer_load_dwordx4 v[60:63], v6, s[12:15], s52 offen offset:2048 sc1
    s_add_u32 s52, s64, 0x1b50000
    buffer_load_dwordx4 v[64:67], v5, s[12:15], s52 offen sc1
    buffer_load_dwordx4 v[68:71], v5, s[12:15], s52 offen offset:2048 sc1
    s_add_u32 s52, s65, 0x1b50000
    buffer_load_dwordx4 v[72:75], v5, s[12:15], s52 offen sc1
    buffer_load_dwordx4 v[76:79], v5, s[12:15], s52 offen offset:2048 sc1
    s_add_u32 s52, s66, 0x1b50000
    buffer_load_dwordx4 v[80:83], v5, s[12:15], s52 offen sc1
    buffer_load_dwordx4 v[84:87], v5, s[12:15], s52 offen offset:2048 sc1
    s_waitcnt vmcnt(21)
    v_mfma_f32_16x16x32_bf16 v[156:159], a[0:3], v[88:91], 0
    v_mfma_f32_16x16x32_bf16 v[160:163], a[4:7], v[88:91], 0
    v_mfma_f32_16x16x32_bf16 v[164:167], a[8:11], v[88:91], 0
    v_mfma_f32_16x16x32_bf16 v[168:171], a[12:15], v[88:91], 0
    v_mfma_f32_16x16x32_bf16 v[172:175], a[16:19], v[88:91], 0
    v_mfma_f32_16x16x32_bf16 v[156:159], a[20:23], v[92:95], v[156:159]
    v_mfma_f32_16x16x32_bf16 v[160:163], a[24:27], v[92:95], v[160:163]
    v_mfma_f32_16x16x32_bf16 v[164:167], a[28:31], v[92:95], v[164:167]
    v_mfma_f32_16x16x32_bf16 v[168:171], a[32:35], v[92:95], v[168:171]
    v_mfma_f32_16x16x32_bf16 v[172:175], a[36:39], v[92:95], v[172:175]
    s_waitcnt vmcnt(19)
    v_mfma_f32_16x16x32_bf16 v[156:159], a[40:43], v[96:99], v[156:159]
    s_add_u32 s52, s67, 0x1b50000
    s_waitcnt vmcnt(12)
    v_mfma_f32_16x16x32_bf16 v[160:163], a[44:47], v[96:99], v[160:163]
    buffer_load_dwordx4 v[88:91], v5, s[12:15], s52 offen sc1
    v_mfma_f32_16x16x32_bf16 v[164:167], a[48:51], v[96:99], v[164:167]
    v_lshlrev_b32 v136, 16, v226
    v_and_b32 v137, 0xffff0000, v226
    v_mfma_f32_16x16x32_bf16 v[168:171], a[52:55], v[96:99], v[168:171]
    buffer_load_dwordx4 v[92:95], v5, s[12:15], s52 offen offset:2048 sc1
    v_mfma_f32_16x16x32_bf16 v[172:175], a[56:59], v[96:99], v[172:175]
    v_lshlrev_b32 v138, 16, v227
    v_and_b32 v139, 0xffff0000, v227
    v_mfma_f32_16x16x32_bf16 v[156:159], a[60:63], v[100:103], v[156:159]
    v_lshlrev_b32 v140, 16, v228
    v_and_b32 v141, 0xffff0000, v228
    v_mfma_f32_16x16x32_bf16 v[160:163], a[64:67], v[100:103], v[160:163]
    v_lshlrev_b32 v142, 16, v229
    v_and_b32 v143, 0xffff0000, v229
    v_mfma_f32_16x16x32_bf16 v[164:167], a[68:71], v[100:103], v[164:167]
    v_lshlrev_b32 v152, 16, v230
    v_and_b32 v153, 0xffff0000, v230
    v_mfma_f32_16x16x32_bf16 v[168:171], a[72:75], v[100:103], v[168:171]
    v_lshlrev_b32 v154, 16, v231
    v_and_b32 v155, 0xffff0000, v231
    v_mfma_f32_16x16x32_bf16 v[172:175], a[76:79], v[100:103], v[172:175]
    v_lshlrev_b32 v22, 16, v238
    v_and_b32 v23, 0xffff0000, v238
    v_mfma_f32_16x16x32_bf16 v[156:159], a[80:83], v[104:107], v[156:159]
    s_add_u32 s52, s68, 0x1b50000
    s_mov_b32 s41, 0
    s_add_u32 s61, s48, 0x280000
    buffer_load_dwordx2 v[196:197], v14, s[12:15], s61 offen offset:0 sc1
    v_mfma_f32_16x16x32_bf16 v[160:163], a[84:87], v[104:107], v[160:163]
    buffer_load_dwordx4 v[96:99], v5, s[12:15], s52 offen sc1
    v_mfma_f32_16x16x32_bf16 v[164:167], a[88:91], v[104:107], v[164:167]
    buffer_load_dwordx2 v[198:199], v14, s[12:15], s61 offen offset:512 sc1
    v_mfma_f32_16x16x32_bf16 v[168:171], a[92:95], v[104:107], v[168:171]
    buffer_load_dwordx4 v[100:103], v5, s[12:15], s52 offen offset:2048 sc1
    v_mfma_f32_16x16x32_bf16 v[172:175], a[96:99], v[104:107], v[172:175]
    buffer_load_dwordx2 v[200:201], v14, s[12:15], s61 offen offset:1024 sc1
    v_mfma_f32_16x16x32_bf16 v[156:159], a[100:103], v[108:111], v[156:159]
    buffer_load_dwordx2 v[202:203], v14, s[12:15], s61 offen offset:1536 sc1
    v_mfma_f32_16x16x32_bf16 v[160:163], a[104:107], v[108:111], v[160:163]
    buffer_load_dwordx2 v[204:205], v14, s[12:15], s61 offen offset:2048 sc1
    v_mfma_f32_16x16x32_bf16 v[164:167], a[108:111], v[108:111], v[164:167]
    buffer_load_dwordx2 v[206:207], v14, s[12:15], s61 offen offset:2560 sc1
    v_mfma_f32_16x16x32_bf16 v[168:171], a[112:115], v[108:111], v[168:171]
    buffer_load_dwordx2 v[208:209], v14, s[12:15], s61 offen offset:3072 sc1
    v_mfma_f32_16x16x32_bf16 v[172:175], a[116:119], v[108:111], v[172:175]
    buffer_load_dwordx2 v[210:211], v14, s[12:15], s61 offen offset:3584 sc1
    v_mfma_f32_16x16x32_bf16 v[156:159], a[120:123], v[112:115], v[156:159]
    s_add_u32 s52, s69, 0x1b50000
    s_add_u32 s61, s61, 4096
    buffer_load_dwordx2 v[212:213], v14, s[12:15], s61 offen offset:0 sc1
    v_mfma_f32_16x16x32_bf16 v[160:163], a[124:127], v[112:115], v[160:163]
    buffer_load_dwordx4 v[104:107], v5, s[12:15], s52 offen sc1
    v_mfma_f32_16x16x32_bf16 v[164:167], a[128:131], v[112:115], v[164:167]
    buffer_load_dwordx2 v[214:215], v14, s[12:15], s61 offen offset:512 sc1
    v_mfma_f32_16x16x32_bf16 v[168:171], a[132:135], v[112:115], v[168:171]
    buffer_load_dwordx4 v[108:111], v5, s[12:15], s52 offen offset:2048 sc1
    v_mfma_f32_16x16x32_bf16 v[172:175], a[136:139], v[112:115], v[172:175]
    buffer_load_dwordx2 v[184:185], v14, s[12:15], s61 offen offset:1024 sc1
    v_mfma_f32_16x16x32_bf16 v[156:159], a[140:143], v[116:119], v[156:159]
    buffer_load_dwordx2 v[186:187], v14, s[12:15], s61 offen offset:1536 sc1
    v_mfma_f32_16x16x32_bf16 v[160:163], a[144:147], v[116:119], v[160:163]
    buffer_load_dwordx2 v[188:189], v14, s[12:15], s61 offen offset:2048 sc1
    v_mfma_f32_16x16x32_bf16 v[164:167], a[148:151], v[116:119], v[164:167]
    buffer_load_dwordx2 v[190:191], v14, s[12:15], s61 offen offset:2560 sc1
    v_mfma_f32_16x16x32_bf16 v[168:171], a[152:155], v[116:119], v[168:171]
    buffer_load_dwordx2 v[244:245], v14, s[12:15], s61 offen offset:3072 sc1
    v_mfma_f32_16x16x32_bf16 v[172:175], a[156:159], v[116:119], v[172:175]
    buffer_load_dwordx2 v[246:247], v14, s[12:15], s61 offen offset:3584 sc1
    s_waitcnt vmcnt(32)
    v_mfma_f32_16x16x32_bf16 v[156:159], a[160:163], v[120:123], v[156:159]
    s_add_u32 s52, s70, 0x1b50000
    v_fma_f32 v250, v136, v253, v252
    v_mfma_f32_16x16x32_bf16 v[160:163], a[164:167], v[120:123], v[160:163]
    buffer_load_dwordx4 v[112:115], v5, s[12:15], s52 offen sc1
    v_mfma_f32_16x16x32_bf16 v[164:167], a[168:171], v[120:123], v[164:167]
    v_fma_f32 v251, v137, v253, v252
    v_fma_f32 v136, v250, v22, v136
    v_mfma_f32_16x16x32_bf16 v[168:171], a[172:175], v[120:123], v[168:171]
    buffer_load_dwordx4 v[116:119], v5, s[12:15], s52 offen offset:2048 sc1
    v_mfma_f32_16x16x32_bf16 v[172:175], a[176:179], v[120:123], v[172:175]
    v_fma_f32 v137, v251, v23, v137
    v_lshlrev_b32 v24, 16, v239
    v_mfma_f32_16x16x32_bf16 v[156:159], a[180:183], v[124:127], v[156:159]
    v_and_b32 v25, 0xffff0000, v239
    v_fma_f32 v250, v138, v253, v252
    v_mfma_f32_16x16x32_bf16 v[160:163], a[184:187], v[124:127], v[160:163]
    v_fma_f32 v251, v139, v253, v252
    v_fma_f32 v138, v250, v24, v138
    v_mfma_f32_16x16x32_bf16 v[164:167], a[188:191], v[124:127], v[164:167]
    v_fma_f32 v139, v251, v25, v139
    v_lshlrev_b32 v26, 16, v240
    v_mfma_f32_16x16x32_bf16 v[168:171], a[192:195], v[124:127], v[168:171]
    v_and_b32 v27, 0xffff0000, v240
    v_fma_f32 v250, v140, v253, v252
    v_mfma_f32_16x16x32_bf16 v[172:175], a[196:199], v[124:127], v[172:175]
    v_fma_f32 v251, v141, v253, v252
    v_fma_f32 v140, v250, v26, v140
    s_waitcnt vmcnt(32)
    v_mfma_f32_16x16x32_bf16 v[156:159], a[200:203], v[128:131], v[156:159]
    v_fma_f32 v141, v251, v27, v141
    v_lshlrev_b32 v28, 16, v241
    v_mfma_f32_16x16x32_bf16 v[160:163], a[204:207], v[128:131], v[160:163]
    v_and_b32 v29, 0xffff0000, v241
    v_fma_f32 v250, v142, v253, v252
    v_mfma_f32_16x16x32_bf16 v[164:167], a[208:211], v[128:131], v[164:167]
    v_fma_f32 v251, v143, v253, v252
    v_fma_f32 v142, v250, v28, v142
    v_mfma_f32_16x16x32_bf16 v[168:171], a[212:215], v[128:131], v[168:171]
    v_fma_f32 v143, v251, v29, v143
    v_lshlrev_b32 v30, 16, v242
    v_mfma_f32_16x16x32_bf16 v[172:175], a[216:219], v[128:131], v[172:175]
    v_and_b32 v31, 0xffff0000, v242
    v_fma_f32 v250, v152, v253, v252
    v_mfma_f32_16x16x32_bf16 v[156:159], a[220:223], v[132:135], v[156:159]
    v_fma_f32 v251, v153, v253, v252
    v_fma_f32 v152, v250, v30, v152
    v_mfma_f32_16x16x32_bf16 v[160:163], a[224:227], v[132:135], v[160:163]
    v_fma_f32 v153, v251, v31, v153
    v_lshlrev_b32 v248, 16, v243
    v_mfma_f32_16x16x32_bf16 v[164:167], a[228:231], v[132:135], v[164:167]
    v_and_b32 v249, 0xffff0000, v243
    v_fma_f32 v250, v154, v253, v252
    v_mfma_f32_16x16x32_bf16 v[168:171], a[232:235], v[132:135], v[168:171]
    v_fma_f32 v251, v155, v253, v252
    v_fma_f32 v154, v250, v248, v154
    v_mfma_f32_16x16x32_bf16 v[172:175], a[236:239], v[132:135], v[172:175]
    v_fma_f32 v155, v251, v249, v155
    v_mul_f32 v252, v22, v22
    s_waitcnt vmcnt(30)
    v_mfma_f32_16x16x32_bf16 v[156:159], a[240:243], v[56:59], v[156:159]
    v_mul_f32 v253, v23, v23
    v_add_f32 v250, v22, v24
    v_mfma_f32_16x16x32_bf16 v[160:163], a[244:247], v[56:59], v[160:163]
    v_add_f32 v251, v23, v25
    v_fma_f32 v252, v24, v24, v252
    v_mfma_f32_16x16x32_bf16 v[164:167], a[248:251], v[56:59], v[164:167]
    v_fma_f32 v253, v25, v25, v253
    v_add_f32 v250, v250, v26
    v_mfma_f32_16x16x32_bf16 v[168:171], a[252:255], v[56:59], v[168:171]
    v_add_f32 v251, v251, v27
    v_fma_f32 v252, v26, v26, v252
    v_mfma_f32_16x16x32_bf16 v[172:175], v[32:35], v[56:59], v[172:175]
    v_fma_f32 v253, v27, v27, v253
    v_add_f32 v250, v250, v28
    v_mfma_f32_16x16x32_bf16 v[156:159], v[36:39], v[60:63], v[156:159]
    v_add_f32 v251, v251, v29
    v_fma_f32 v252, v28, v28, v252
    v_mfma_f32_16x16x32_bf16 v[160:163], v[40:43], v[60:63], v[160:163]
    v_fma_f32 v253, v29, v29, v253
    v_add_f32 v250, v250, v30
    v_mfma_f32_16x16x32_bf16 v[164:167], v[44:47], v[60:63], v[164:167]
    v_add_f32 v251, v251, v31
    v_fma_f32 v252, v30, v30, v252
    v_mfma_f32_16x16x32_bf16 v[168:171], v[48:51], v[60:63], v[168:171]
    v_fma_f32 v253, v31, v31, v253
    v_add_f32 v250, v250, v248
    v_mfma_f32_16x16x32_bf16 v[172:175], v[52:55], v[60:63], v[172:175]
    v_add_f32 v251, v251, v249
    v_fma_f32 v252, v248, v248, v252
    s_waitcnt vmcnt(2)
L_chk_44:
    v_pk_add_f32 v[216:217], v[196:197], v[198:199]
    v_pk_add_f32 v[218:219], v[200:201], v[202:203]
    v_pk_add_f32 v[216:217], v[216:217], v[204:205]
    v_pk_add_f32 v[218:219], v[218:219], v[206:207]
    v_pk_add_f32 v[216:217], v[216:217], v[208:209]
    v_pk_add_f32 v[218:219], v[218:219], v[210:211]
    v_pk_add_f32 v[216:217], v[216:217], v[212:213]
    v_pk_add_f32 v[218:219], v[218:219], v[214:215]
    v_pk_add_f32 v[216:217], v[216:217], v[184:185]
    v_pk_add_f32 v[218:219], v[218:219], v[186:187]
    v_pk_add_f32 v[216:217], v[216:217], v[188:189]
    v_pk_add_f32 v[218:219], v[218:219], v[190:191]
    v_pk_add_f32 v[216:217], v[216:217], v[244:245]
    v_pk_add_f32 v[218:219], v[218:219], v[246:247]
    v_pk_add_f32 v[216:217], v[216:217], v[218:219]
    v_cmp_u_f32 vcc, v216, v217
    s_cbranch_vccz L_ok_45
    s_cmp_eq_u32 s50, 0
    s_cbranch_scc1 L_ok_45
    s_sub_u32 s50, s50, 1
    s_sleep 1
    s_mov_b64 exec, vcc
    s_add_u32 s41, s41, 1
    s_and_b32 s61, s41, 3
    s_cmp_eq_u32 s61, 0
    s_cselect_b32 s61, 0x1310000, 0
    s_add_u32 s61, s61, s48
    s_add_u32 s61, s61, 0x280000
    buffer_load_dwordx2 v[196:197], v14, s[12:15], s61 offen offset:0 sc1
    buffer_load_dwordx2 v[198:199], v14, s[12:15], s61 offen offset:512 sc1
    buffer_load_dwordx2 v[200:201], v14, s[12:15], s61 offen offset:1024 sc1
    buffer_load_dwordx2 v[202:203], v14, s[12:15], s61 offen offset:1536 sc1
    buffer_load_dwordx2 v[204:205], v14, s[12:15], s61 offen offset:2048 sc1
    buffer_load_dwordx2 v[206:207], v14, s[12:15], s61 offen offset:2560 sc1
    buffer_load_dwordx2 v[208:209], v14, s[12:15], s61 offen offset:3072 sc1
    buffer_load_dwordx2 v[210:211], v14, s[12:15], s61 offen offset:3584 sc1
    s_add_u32 s61, s61, 4096
    buffer_load_dwordx2 v[212:213], v14, s[12:15], s61 offen offset:0 sc1
    buffer_load_dwordx2 v[214:215], v14, s[12:15], s61 offen offset:512 sc1
    buffer_load_dwordx2 v[184:185], v14, s[12:15], s61 offen offset:1024 sc1
    buffer_load_dwordx2 v[186:187], v14, s[12:15], s61 offen offset:1536 sc1
    buffer_load_dwordx2 v[188:189], v14, s[12:15], s61 offen offset:2048 sc1
    buffer_load_dwordx2 v[190:191], v14, s[12:15], s61 offen offset:2560 sc1
    buffer_load_dwordx2 v[244:245], v14, s[12:15], s61 offen offset:3072 sc1
    buffer_load_dwordx2 v[246:247], v14, s[12:15], s61 offen offset:3584 sc1
    s_mov_b64 exec, -1
    s_waitcnt vmcnt(0)
    s_branch L_chk_44
L_ok_45:
    v_mov_b32 v196, v216
    v_mov_b32 v198, v216
    v_mov_b32 v200, v217
    v_mov_b32 v202, v217
    s_nop 1
    v_permlane16_swap_b32 v196, v198
    v_permlane16_swap_b32 v200, v202
    v_mov_b32 v197, v196
    v_mov_b32 v199, v198
    v_mov_b32 v201, v200
    v_mov_b32 v203, v202
    s_nop 1
    v_permlane32_swap_b32 v196, v197
    v_permlane32_swap_b32 v198, v199
    v_permlane32_swap_b32 v200, v201
    v_permlane32_swap_b32 v202, v203
    v_mov_b32 v212, v196
    v_mov_b32 v213, v197
    v_mul_f32 v212, 0x3acccccd, v212
    v_mul_f32 v213, 0x3acccccd, v213
    v_fma_f32 v213, -v212, v212, v213
    v_max_f32 v213, 0, v213
    v_cvt_pk_bf16_f32 v204, v212, v212
    v_lshlrev_b32 v204, 16, v204
    v_cvt_pk_bf16_f32 v214, v213, v213
    v_lshlrev_b32 v214, 16, v214
    v_add_f32 v214, 0x3727c5ac, v214
    v_cvt_pk_bf16_f32 v214, v214, v214
    v_lshlrev_b32 v214, 16, v214
    v_sqrt_f32 v214, v214
    s_nop 0
    v_cvt_pk_bf16_f32 v214, v214, v214
    v_lshlrev_b32 v214, 16, v214
    v_rcp_f32 v206, v214
    s_nop 0
    v_fma_f32 v212, -v204, v202, v198
    v_mul_f32 v213, v204, v203
    v_fma_f32 v196, v206, v212, v196
    v_fma_f32 v212, -v204, v198, v199
    v_fma_f32 v213, -2.0, v201, v213
    v_add_f32 v212, v212, v212
    v_fma_f32 v213, v204, v213, v200
    v_mul_f32 v204, -v204, v206
    v_fma_f32 v212, v206, v213, v212
    v_mov_b32 v207, v206
    v_fma_f32 v197, v206, v212, v197
    v_mov_b32 v205, v204
    v_mul_f32 v196, 0x3acccccd, v196
    v_mul_f32 v197, 0x3acccccd, v197
    v_fma_f32 v197, -v196, v196, v197
    v_max_f32 v197, 0, v197
    v_cvt_pk_bf16_f32 v208, v196, v196
    v_lshlrev_b32 v208, 16, v208
    v_cvt_pk_bf16_f32 v214, v197, v197
    v_lshlrev_b32 v214, 16, v214
    v_add_f32 v214, 0x3727c5ac, v214
    v_cvt_pk_bf16_f32 v214, v214, v214
    v_lshlrev_b32 v214, 16, v214
    v_sqrt_f32 v214, v214
    s_nop 0
    v_cvt_pk_bf16_f32 v214, v214, v214
    v_lshlrev_b32 v214, 16, v214
    v_rcp_f32 v210, v214
    s_nop 0
    v_mul_f32 v208, -v208, v210
    v_mov_b32 v211, v210
    v_mov_b32 v209, v208
    v_lshlrev_b32 v216, 16, v232
    v_and_b32 v217, 0xffff0000, v232
    v_pk_fma_f32 v[198:199], v[176:177], v[206:207], v[204:205]
    v_pk_fma_f32 v[176:177], v[198:199], v[216:217], v[176:177]
    v_pk_fma_f32 v[198:199], v[176:177], v[210:211], v[208:209]
    v_cvt_pk_bf16_f32 v184, v198, v199
    v_lshlrev_b32 v218, 16, v233
    v_and_b32 v219, 0xffff0000, v233
    v_pk_fma_f32 v[200:201], v[178:179], v[206:207], v[204:205]
    v_pk_fma_f32 v[178:179], v[200:201], v[218:219], v[178:179]
    v_pk_fma_f32 v[200:201], v[178:179], v[210:211], v[208:209]
    v_cvt_pk_bf16_f32 v185, v200, v201
    v_lshlrev_b32 v216, 16, v234
    v_and_b32 v217, 0xffff0000, v234
    v_pk_fma_f32 v[198:199], v[180:181], v[206:207], v[204:205]
    v_pk_fma_f32 v[180:181], v[198:199], v[216:217], v[180:181]
    v_pk_fma_f32 v[198:199], v[180:181], v[210:211], v[208:209]
    v_cvt_pk_bf16_f32 v186, v198, v199
    v_lshlrev_b32 v218, 16, v235
    v_and_b32 v219, 0xffff0000, v235
    v_pk_fma_f32 v[200:201], v[182:183], v[206:207], v[204:205]
    v_pk_fma_f32 v[182:183], v[200:201], v[218:219], v[182:183]
    v_pk_fma_f32 v[200:201], v[182:183], v[210:211], v[208:209]
    v_cvt_pk_bf16_f32 v187, v200, v201
    s_add_u32 s55, s36, 0xc80000
    buffer_store_dwordx4 v[184:187], v8, s[12:15], s55 offen sc1
    v_lshlrev_b32 v216, 16, v236
    v_and_b32 v217, 0xffff0000, v236
    v_pk_fma_f32 v[198:199], v[192:193], v[206:207], v[204:205]
    v_pk_fma_f32 v[192:193], v[198:199], v[216:217], v[192:193]
    v_pk_fma_f32 v[198:199], v[192:193], v[210:211], v[208:209]
    v_cvt_pk_bf16_f32 v188, v198, v199
    v_lshlrev_b32 v218, 16, v237
    v_and_b32 v219, 0xffff0000, v237
    v_pk_fma_f32 v[200:201], v[194:195], v[206:207], v[204:205]
    v_pk_fma_f32 v[194:195], v[200:201], v[218:219], v[194:195]
    v_pk_fma_f32 v[200:201], v[194:195], v[210:211], v[208:209]
    v_cvt_pk_bf16_f32 v189, v200, v201
    s_add_u32 s55, s36, 0xc80000
    s_mov_b64 exec, s[56:57]
    buffer_store_dwordx2 v[188:189], v9, s[12:15], s55 offen sc1
    s_mov_b64 exec, -1
    v_cvt_pk_bf16_f32 v220, v176, v177
    v_cvt_pk_bf16_f32 v221, v178, v179
    v_cvt_pk_bf16_f32 v222, v180, v181
    v_cvt_pk_bf16_f32 v223, v182, v183
    v_cvt_pk_bf16_f32 v224, v192, v193
    v_cvt_pk_bf16_f32 v225, v194, v195
    v_fma_f32 v253, v249, v249, v253
    v_add_f32 v250, v250, v251
    v_add_f32 v252, v252, v253
    s_nop 1
    v_mfma_f32_16x16x32_bf16 v[136:139], a[0:3], v[64:67], v[136:139]
    v_mfma_f32_16x16x32_bf16 v[140:143], a[4:7], v[64:67], v[140:143]
    v_mfma_f32_16x16x32_bf16 v[144:147], a[8:11], v[64:67], 0
    v_mfma_f32_16x16x32_bf16 v[148:151], a[12:15], v[64:67], 0
    v_mfma_f32_16x16x32_bf16 v[152:155], a[16:19], v[64:67], v[152:155]
    v_mfma_f32_16x16x32_bf16 v[136:139], a[20:23], v[68:71], v[136:139]
    v_mfma_f32_16x16x32_bf16 v[140:143], a[24:27], v[68:71], v[140:143]
    v_mfma_f32_16x16x32_bf16 v[144:147], a[28:31], v[68:71], v[144:147]
    v_mfma_f32_16x16x32_bf16 v[148:151], a[32:35], v[68:71], v[148:151]
    v_mfma_f32_16x16x32_bf16 v[152:155], a[36:39], v[68:71], v[152:155]
    v_mfma_f32_16x16x32_bf16 v[136:139], a[40:43], v[72:75], v[136:139]
    s_barrier
    ds_write_b128 v15, v[156:159] offset:0
    v_mfma_f32_16x16x32_bf16 v[140:143], a[44:47], v[72:75], v[140:143]
    ds_write_b128 v15, v[160:163] offset:1024
    ds_write_b128 v15, v[164:167] offset:2048
    v_mfma_f32_16x16x32_bf16 v[144:147], a[48:51], v[72:75], v[144:147]
    ds_write_b128 v15, v[168:171] offset:3072
    ds_write_b128 v15, v[172:175] offset:4096
    v_mfma_f32_16x16x32_bf16 v[148:151], a[52:55], v[72:75], v[148:151]
    v_mfma_f32_16x16x32_bf16 v[152:155], a[56:59], v[72:75], v[152:155]
    v_mfma_f32_16x16x32_bf16 v[136:139], a[60:63], v[76:79], v[136:139]
    v_mfma_f32_16x16x32_bf16 v[140:143], a[64:67], v[76:79], v[140:143]
    v_mfma_f32_16x16x32_bf16 v[144:147], a[68:71], v[76:79], v[144:147]
    v_mfma_f32_16x16x32_bf16 v[148:151], a[72:75], v[76:79], v[148:151]
    v_mfma_f32_16x16x32_bf16 v[152:155], a[76:79], v[76:79], v[152:155]
    v_mfma_f32_16x16x32_bf16 v[136:139], a[80:83], v[80:83], v[136:139]
    s_waitcnt lgkmcnt(0)
    s_barrier
    v_mfma_f32_16x16x32_bf16 v[140:143], a[84:87], v[80:83], v[140:143]
    ds_read_b128 v[156:159], v16 offset:0
    ds_read_b128 v[160:163], v16 offset:1024
    v_mfma_f32_16x16x32_bf16 v[144:147], a[88:91], v[80:83], v[144:147]
    ds_read_b128 v[164:167], v16 offset:4096
    ds_read_b128 v[168:171], v1 offset:2048
    v_mfma_f32_16x16x32_bf16 v[148:151], a[92:95], v[80:83], v[148:151]
    ds_read_b128 v[172:175], v1 offset:3072
    v_mfma_f32_16x16x32_bf16 v[152:155], a[96:99], v[80:83], v[152:155]
    v_mfma_f32_16x16x32_bf16 v[136:139], a[100:103], v[84:87], v[136:139]
    v_mfma_f32_16x16x32_bf16 v[140:143], a[104:107], v[84:87], v[140:143]
    v_mfma_f32_16x16x32_bf16 v[144:147], a[108:111], v[84:87], v[144:147]
    v_mfma_f32_16x16x32_bf16 v[148:151], a[112:115], v[84:87], v[148:151]
    v_mfma_f32_16x16x32_bf16 v[152:155], a[116:119], v[84:87], v[152:155]
    v_mfma_f32_16x16x32_bf16 v[136:139], a[120:123], v[88:91], v[136:139]
    s_waitcnt lgkmcnt(0)
    v_add_f32 v156, v156, v168
    v_mfma_f32_16x16x32_bf16 v[140:143], a[124:127], v[88:91], v[140:143]
    v_add_f32 v157, v157, v169
    v_add_f32 v158, v158, v170
    v_mfma_f32_16x16x32_bf16 v[144:147], a[128:131], v[88:91], v[144:147]
    v_add_f32 v159, v159, v171
    ds_read_b128 v[168:171], v1 offset:4096
    v_mfma_f32_16x16x32_bf16 v[148:151], a[132:135], v[88:91], v[148:151]
    v_add_f32 v160, v160, v172
    v_add_f32 v161, v161, v173
    v_mfma_f32_16x16x32_bf16 v[152:155], a[136:139], v[88:91], v[152:155]
    v_add_f32 v162, v162, v174
    v_add_f32 v163, v163, v175
    v_mfma_f32_16x16x32_bf16 v[136:139], a[140:143], v[92:95], v[136:139]
    v_mfma_f32_16x16x32_bf16 v[140:143], a[144:147], v[92:95], v[140:143]
    v_mfma_f32_16x16x32_bf16 v[144:147], a[148:151], v[92:95], v[144:147]
    v_mfma_f32_16x16x32_bf16 v[148:151], a[152:155], v[92:95], v[148:151]
    v_mfma_f32_16x16x32_bf16 v[152:155], a[156:159], v[92:95], v[152:155]
    s_waitcnt vmcnt(0)
    s_barrier
    s_cmp_lg_u32 s3, 0
    s_cbranch_scc1 L_nopub_46
    s_add_u32 s55, s42, 0x16d0000
    s_mov_b64 exec, 1
    buffer_store_dword v19, v20, s[12:15], s55 offen sc1
    s_mov_b64 exec, -1
L_nopub_46:
    v_mfma_f32_16x16x32_bf16 v[136:139], a[160:163], v[96:99], v[136:139]
    s_waitcnt lgkmcnt(0)
    s_barrier
    v_mfma_f32_16x16x32_bf16 v[140:143], a[164:167], v[96:99], v[140:143]
    v_add_f32 v164, v164, v168
    v_add_f32 v165, v165, v169
    v_mfma_f32_16x16x32_bf16 v[144:147], a[168:171], v[96:99], v[144:147]
    v_add_f32 v166, v166, v170
    v_add_f32 v167, v167, v171
    v_mfma_f32_16x16x32_bf16 v[148:151], a[172:175], v[96:99], v[148:151]
    v_mfma_f32_16x16x32_bf16 v[152:155], a[176:179], v[96:99], v[152:155]
    v_mfma_f32_16x16x32_bf16 v[136:139], a[180:183], v[100:103], v[136:139]
    v_mfma_f32_16x16x32_bf16 v[140:143], a[184:187], v[100:103], v[140:143]
    v_mfma_f32_16x16x32_bf16 v[144:147], a[188:191], v[100:103], v[144:147]
    v_mfma_f32_16x16x32_bf16 v[148:151], a[192:195], v[100:103], v[148:151]
    v_mfma_f32_16x16x32_bf16 v[152:155], a[196:199], v[100:103], v[152:155]
    v_mfma_f32_16x16x32_bf16 v[136:139], a[200:203], v[104:107], v[136:139]
    v_mfma_f32_16x16x32_bf16 v[140:143], a[204:207], v[104:107], v[140:143]
    v_mfma_f32_16x16x32_bf16 v[144:147], a[208:211], v[104:107], v[144:147]
    v_mfma_f32_16x16x32_bf16 v[148:151], a[212:215], v[104:107], v[148:151]
    v_mfma_f32_16x16x32_bf16 v[152:155], a[216:219], v[104:107], v[152:155]
    v_mfma_f32_16x16x32_bf16 v[136:139], a[220:223], v[108:111], v[136:139]
    v_mfma_f32_16x16x32_bf16 v[140:143], a[224:227], v[108:111], v[140:143]
    v_mfma_f32_16x16x32_bf16 v[144:147], a[228:231], v[108:111], v[144:147]
    v_mfma_f32_16x16x32_bf16 v[148:151], a[232:235], v[108:111], v[148:151]
    v_mfma_f32_16x16x32_bf16 v[152:155], a[236:239], v[108:111], v[152:155]
    v_mfma_f32_16x16x32_bf16 v[144:147], a[248:251], v[112:115], v[144:147]
    v_mfma_f32_16x16x32_bf16 v[148:151], a[252:255], v[112:115], v[148:151]
    v_mfma_f32_16x16x32_bf16 v[152:155], v[32:35], v[112:115], v[152:155]
    v_mfma_f32_16x16x32_bf16 v[144:147], v[44:47], v[116:119], v[144:147]
    v_mfma_f32_16x16x32_bf16 v[148:151], v[48:51], v[116:119], v[148:151]
    v_mfma_f32_16x16x32_bf16 v[152:155], v[52:55], v[116:119], v[152:155]
    v_mfma_f32_16x16x32_bf16 v[136:139], a[240:243], v[112:115], v[136:139]
    v_mfma_f32_16x16x32_bf16 v[140:143], a[244:247], v[112:115], v[140:143]
    v_mfma_f32_16x16x32_bf16 v[136:139], v[36:39], v[116:119], v[136:139]
    v_mfma_f32_16x16x32_bf16 v[140:143], v[40:43], v[116:119], v[140:143]
    s_nop 2
    ds_write_b128 v15, v[144:147] offset:2048
    ds_write_b128 v15, v[148:151] offset:3072
    ds_write_b128 v15, v[152:155] offset:4096
    s_nop 3
    v_pk_add_f32 v[136:137], v[136:137], v[156:157]
    v_pk_add_f32 v[138:139], v[138:139], v[158:159]
    v_pk_add_f32 v[140:141], v[140:141], v[160:161]
    v_pk_add_f32 v[142:143], v[142:143], v[162:163]
    s_waitcnt lgkmcnt(0)
    s_barrier
    ds_read_b128 v[168:171], v17 offset:2048
    ds_read_b128 v[172:175], v17 offset:3072
    ds_read_b128 v[144:147], v17 offset:4096
    v_pk_add_f32 v[152:153], v[152:153], v[164:165]
    v_pk_add_f32 v[154:155], v[154:155], v[166:167]
    s_add_u32 s55, s40, 0x16d0000
    buffer_load_dword v18, v13, s[12:15], s55 offen sc1
    s_waitcnt lgkmcnt(2)
    v_pk_add_f32 v[136:137], v[136:137], v[168:169]
    v_pk_add_f32 v[138:139], v[138:139], v[170:171]
    s_waitcnt lgkmcnt(1)
    v_pk_add_f32 v[140:141], v[140:141], v[172:173]
    v_pk_add_f32 v[142:143], v[142:143], v[174:175]
    s_waitcnt lgkmcnt(0)
    v_pk_add_f32 v[152:153], v[152:153], v[144:145]
    v_pk_add_f32 v[154:155], v[154:155], v[146:147]
    v_cndmask_b32 v152, 0, v152, s[56:57]
    v_cndmask_b32 v153, 0, v153, s[56:57]
    v_cndmask_b32 v154, 0, v154, s[56:57]
    v_cndmask_b32 v155, 0, v155, s[56:57]
    v_pk_mul_f32 v[160:161], v[136:137], v[22:23]
    v_pk_mul_f32 v[158:159], v[136:137], v[136:137]
    v_pk_mul_f32 v[162:163], v[160:161], v[136:137]
    v_pk_mul_f32 v[164:165], v[160:161], v[160:161]
    v_pk_mul_f32 v[166:167], v[160:161], v[22:23]
    v_pk_mul_f32 v[146:147], v[138:139], v[24:25]
    v_pk_add_f32 v[156:157], v[136:137], v[138:139]
    v_pk_fma_f32 v[158:159], v[138:139], v[138:139], v[158:159]
    v_pk_add_f32 v[160:161], v[160:161], v[146:147]
    v_pk_fma_f32 v[162:163], v[146:147], v[138:139], v[162:163]
    v_pk_fma_f32 v[164:165], v[146:147], v[146:147], v[164:165]
    v_pk_fma_f32 v[166:167], v[146:147], v[24:25], v[166:167]
    v_pk_mul_f32 v[144:145], v[140:141], v[26:27]
    v_pk_add_f32 v[156:157], v[156:157], v[140:141]
    v_pk_fma_f32 v[158:159], v[140:141], v[140:141], v[158:159]
    v_pk_add_f32 v[160:161], v[160:161], v[144:145]
    v_pk_fma_f32 v[162:163], v[144:145], v[140:141], v[162:163]
    v_pk_fma_f32 v[164:165], v[144:145], v[144:145], v[164:165]
    v_pk_fma_f32 v[166:167], v[144:145], v[26:27], v[166:167]
    v_pk_mul_f32 v[146:147], v[142:143], v[28:29]
    v_pk_add_f32 v[156:157], v[156:157], v[142:143]
    v_pk_fma_f32 v[158:159], v[142:143], v[142:143], v[158:159]
    v_pk_add_f32 v[160:161], v[160:161], v[146:147]
    v_pk_fma_f32 v[162:163], v[146:147], v[142:143], v[162:163]
    v_pk_fma_f32 v[164:165], v[146:147], v[146:147], v[164:165]
    v_pk_fma_f32 v[166:167], v[146:147], v[28:29], v[166:167]
    v_pk_mul_f32 v[144:145], v[152:153], v[30:31]
    v_pk_add_f32 v[156:157], v[156:157], v[152:153]
    v_pk_fma_f32 v[158:159], v[152:153], v[152:153], v[158:159]
    v_pk_add_f32 v[160:161], v[160:161], v[144:145]
    v_pk_fma_f32 v[162:163], v[144:145], v[152:153], v[162:163]
    v_pk_fma_f32 v[164:165], v[144:145], v[144:145], v[164:165]
    v_pk_fma_f32 v[166:167], v[144:145], v[30:31], v[166:167]
    v_pk_mul_f32 v[146:147], v[154:155], v[248:249]
    v_pk_add_f32 v[156:157], v[156:157], v[154:155]
    v_pk_fma_f32 v[158:159], v[154:155], v[154:155], v[158:159]
    v_pk_add_f32 v[160:161], v[160:161], v[146:147]
    v_pk_fma_f32 v[162:163], v[146:147], v[154:155], v[162:163]
    v_pk_fma_f32 v[164:165], v[146:147], v[146:147], v[164:165]
    v_pk_fma_f32 v[166:167], v[146:147], v[248:249], v[166:167]
    v_add_f32 v156, v156, v157
    v_add_f32 v158, v158, v159
    v_add_f32 v160, v160, v161
    v_add_f32 v162, v162, v163
    v_add_f32 v164, v164, v165
    v_add_f32 v166, v166, v167
    v_permlane32_swap_b32 v250, v252
    v_permlane32_swap_b32 v156, v158
    v_permlane32_swap_b32 v160, v162
    v_permlane32_swap_b32 v164, v166
    v_add_f32 v250, v250, v252
    v_add_f32 v156, v156, v158
    v_add_f32 v160, v160, v162
    v_add_f32 v164, v164, v166
    s_nop 0
    v_permlane16_swap_b32 v156, v160
    v_permlane16_swap_b32 v164, v250
    v_add_f32 v148, v156, v160
    v_add_f32 v149, v164, v250
    v_mov_b32 v150, 0x7f800000
    v_cmp_lt_f32 vcc, |v148|, v150
    v_cmp_lt_f32 s[6:7], |v149|, v150
    s_nop 0
    v_cndmask_b32 v148, v150, v148, vcc
    v_cndmask_b32 v149, v150, v149, s[6:7]
    s_add_u32 s55, s49, 0x300000
    buffer_store_dwordx2 v[148:149], v14, s[12:15], s55 offen
    s_add_u32 s55, s49, 0x1610000
    buffer_store_dwordx2 v[148:149], v14, s[12:15], s55 offen sc1
    ds_read_b128 v[192:195], v21 offset:0
    ds_read_b128 v[196:199], v21 offset:1024
    ds_read_b128 v[200:203], v21 offset:2048
    ds_read_b128 v[204:207], v21 offset:3072
    ds_read_b128 v[208:211], v21 offset:4096
    ds_read_b128 v[212:215], v21 offset:5120
    ds_read_b128 v[216:219], v21 offset:6144
    s_waitcnt vmcnt(2)
L_chk_47:
    v_cmp_ne_u32 vcc, v19, v18
    s_cbranch_vccz L_ok_48
    s_cmp_eq_u32 s50, 0
    s_cbranch_scc1 L_ok_48
    s_sub_u32 s50, s50, 1
    s_sleep 1
    s_mov_b64 exec, vcc
    s_add_u32 s55, s40, 0x16d0000
    buffer_load_dword v18, v13, s[12:15], s55 offen sc1
    s_mov_b64 exec, -1
    s_waitcnt vmcnt(0)
    s_branch L_chk_47
L_ok_48:
    s_add_u32 s52, s30, 0xc80000
    buffer_load_dwordx4 v[56:59], v2, s[12:15], s52 offen offset:0 sc1
    buffer_load_dwordx4 v[60:63], v2, s[12:15], s52 offen offset:1024 sc1
    buffer_load_dwordx4 v[64:67], v2, s[12:15], s52 offen offset:2048 sc1
    buffer_load_dwordx4 v[68:71], v2, s[12:15], s52 offen offset:3072 sc1
    s_add_u32 s52, s30, 0xc81000
    buffer_load_dwordx4 v[72:75], v2, s[12:15], s52 offen offset:0 sc1
    buffer_load_dwordx4 v[76:79], v2, s[12:15], s52 offen offset:1024 sc1
    buffer_load_dwordx4 v[80:83], v2, s[12:15], s52 offen offset:2048 sc1
    buffer_load_dwordx4 v[84:87], v2, s[12:15], s52 offen offset:3072 sc1
    v_cvt_pk_bf16_f32 v226, v136, v137
    v_cvt_pk_bf16_f32 v227, v138, v139
    v_cvt_pk_bf16_f32 v228, v140, v141
    v_cvt_pk_bf16_f32 v229, v142, v143
    v_cvt_pk_bf16_f32 v230, v152, v153
    v_cvt_pk_bf16_f32 v231, v154, v155
    s_add_u32 s52, s30, 0xc82000
    buffer_load_dwordx4 v[88:91], v2, s[12:15], s52 offen offset:0 sc1
    buffer_load_dwordx4 v[92:95], v2, s[12:15], s52 offen offset:1024 sc1
    buffer_load_dwordx4 v[96:99], v2, s[12:15], s52 offen offset:2048 sc1
    buffer_load_dwordx4 v[100:103], v2, s[12:15], s52 offen offset:3072 sc1
    s_add_u32 s52, s30, 0xc83000
    buffer_load_dwordx4 v[104:107], v2, s[12:15], s52 offen offset:0 sc1
    buffer_load_dwordx4 v[108:111], v2, s[12:15], s52 offen offset:1024 sc1
    buffer_load_dwordx4 v[112:115], v2, s[12:15], s52 offen offset:2048 sc1
    buffer_load_dwordx4 v[116:119], v2, s[12:15], s52 offen offset:3072 sc1
    s_waitcnt vmcnt(14)
    s_waitcnt lgkmcnt(6)
    v_mfma_f32_16x16x32_bf16 v[136:139], v[192:195], v[56:59], 0
    s_waitcnt lgkmcnt(5)
    v_mfma_f32_16x16x32_bf16 v[140:143], v[192:195], v[60:63], 0
    ds_read_b128 v[192:195], v21 offset:7168
    v_mfma_f32_16x16x32_bf16 v[148:151], v[196:199], v[60:63], 0
    s_waitcnt lgkmcnt(5)
    s_mov_b32 s41, 0
    s_add_u32 s61, s48, 0x300000
    buffer_load_dwordx2 v[120:121], v14, s[12:15], s61 offen offset:0 sc1
    v_mfma_f32_16x16x32_bf16 v[144:147], v[196:199], v[56:59], 0
    ds_read_b128 v[196:199], v21 offset:8192
    v_mfma_f32_16x16x32_bf16 v[152:155], v[200:203], v[56:59], 0
    s_waitcnt lgkmcnt(5)
    v_mfma_f32_16x16x32_bf16 v[156:159], v[200:203], v[60:63], 0
    ds_read_b128 v[200:203], v21 offset:9216
    v_mfma_f32_16x16x32_bf16 v[164:167], v[204:207], v[60:63], 0
    s_waitcnt lgkmcnt(5)
    buffer_load_dwordx2 v[122:123], v14, s[12:15], s61 offen offset:512 sc1
    v_mfma_f32_16x16x32_bf16 v[160:163], v[204:207], v[56:59], 0
    ds_read_b128 v[204:207], v21 offset:10240
    v_mfma_f32_16x16x32_bf16 v[168:171], v[208:211], v[56:59], 0
    s_waitcnt lgkmcnt(5)
    v_mfma_f32_16x16x32_bf16 v[172:175], v[208:211], v[60:63], 0
    ds_read_b128 v[208:211], v21 offset:11264
    v_mfma_f32_16x16x32_bf16 v[180:183], v[212:215], v[60:63], 0
    s_waitcnt lgkmcnt(5)
    buffer_load_dwordx2 v[124:125], v14, s[12:15], s61 offen offset:1024 sc1
    v_mfma_f32_16x16x32_bf16 v[176:179], v[212:215], v[56:59], 0
    ds_read_b128 v[212:215], v21 offset:12288
    v_mfma_f32_16x16x32_bf16 v[184:187], v[216:219], v[56:59], 0
    s_waitcnt lgkmcnt(5)
    buffer_load_dwordx2 v[126:127], v14, s[12:15], s61 offen offset:1536 sc1
    v_mfma_f32_16x16x32_bf16 v[188:191], v[216:219], v[60:63], 0
    ds_read_b128 v[216:219], v21 offset:13312
    s_waitcnt vmcnt(16)
    v_mfma_f32_16x16x32_bf16 v[136:139], v[192:195], v[64:67], v[136:139]
    s_waitcnt lgkmcnt(5)
    v_mfma_f32_16x16x32_bf16 v[140:143], v[192:195], v[68:71], v[140:143]
    ds_read_b128 v[192:195], v21 offset:14336
    v_mfma_f32_16x16x32_bf16 v[148:151], v[196:199], v[68:71], v[148:151]
    s_waitcnt lgkmcnt(5)
    buffer_load_dwordx2 v[128:129], v14, s[12:15], s61 offen offset:2048 sc1
    v_mfma_f32_16x16x32_bf16 v[144:147], v[196:199], v[64:67], v[144:147]
    ds_read_b128 v[196:199], v21 offset:15360
    v_mfma_f32_16x16x32_bf16 v[152:155], v[200:203], v[64:67], v[152:155]
    s_waitcnt lgkmcnt(5)
    v_mfma_f32_16x16x32_bf16 v[156:159], v[200:203], v[68:71], v[156:159]
    ds_read_b128 v[200:203], v21 offset:16384
    v_mfma_f32_16x16x32_bf16 v[164:167], v[204:207], v[68:71], v[164:167]
    s_waitcnt lgkmcnt(5)
    buffer_load_dwordx2 v[130:131], v14, s[12:15], s61 offen offset:2560 sc1
    v_mfma_f32_16x16x32_bf16 v[160:163], v[204:207], v[64:67], v[160:163]
    ds_read_b128 v[204:207], v21 offset:17408
    v_mfma_f32_16x16x32_bf16 v[168:171], v[208:211], v[64:67], v[168:171]
    s_waitcnt lgkmcnt(5)
    v_mfma_f32_16x16x32_bf16 v[172:175], v[208:211], v[68:71], v[172:175]
    ds_read_b128 v[208:211], v21 offset:18432
    v_mfma_f32_16x16x32_bf16 v[180:183], v[212:215], v[68:71], v[180:183]
    s_waitcnt lgkmcnt(5)
    buffer_load_dwordx2 v[132:133], v14, s[12:15], s61 offen offset:3072 sc1
    v_mfma_f32_16x16x32_bf16 v[176:179], v[212:215], v[64:67], v[176:179]
    ds_read_b128 v[212:215], v21 offset:19456
    v_mfma_f32_16x16x32_bf16 v[184:187], v[216:219], v[64:67], v[184:187]
    s_waitcnt lgkmcnt(5)
    buffer_load_dwordx2 v[134:135], v14, s[12:15], s61 offen offset:3584 sc1
    v_mfma_f32_16x16x32_bf16 v[188:191], v[216:219], v[68:71], v[188:191]
    ds_read_b128 v[216:219], v21 offset:20480
    s_waitcnt vmcnt(18)
    v_mfma_f32_16x16x32_bf16 v[136:139], v[192:195], v[72:75], v[136:139]
    s_waitcnt lgkmcnt(5)
    v_mfma_f32_16x16x32_bf16 v[140:143], v[192:195], v[76:79], v[140:143]
    ds_read_b128 v[192:195], v21 offset:21504
    v_mfma_f32_16x16x32_bf16 v[148:151], v[196:199], v[76:79], v[148:151]
    s_waitcnt lgkmcnt(5)
    s_add_u32 s61, s61, 4096
    buffer_load_dwordx2 v[22:23], v14, s[12:15], s61 offen offset:0 sc1
    v_mfma_f32_16x16x32_bf16 v[144:147], v[196:199], v[72:75], v[144:147]
    ds_read_b128 v[196:199], v21 offset:22528
    v_mfma_f32_16x16x32_bf16 v[152:155], v[200:203], v[72:75], v[152:155]
    s_waitcnt lgkmcnt(5)
    v_mfma_f32_16x16x32_bf16 v[156:159], v[200:203], v[76:79], v[156:159]
    ds_read_b128 v[200:203], v21 offset:23552
    v_mfma_f32_16x16x32_bf16 v[164:167], v[204:207], v[76:79], v[164:167]
    s_waitcnt lgkmcnt(5)
    buffer_load_dwordx2 v[24:25], v14, s[12:15], s61 offen offset:512 sc1
    v_mfma_f32_16x16x32_bf16 v[160:163], v[204:207], v[72:75], v[160:163]
    ds_read_b128 v[204:207], v21 offset:24576
    v_mfma_f32_16x16x32_bf16 v[168:171], v[208:211], v[72:75], v[168:171]
    s_waitcnt lgkmcnt(5)
    v_mfma_f32_16x16x32_bf16 v[172:175], v[208:211], v[76:79], v[172:175]
    ds_read_b128 v[208:211], v21 offset:25600
    v_mfma_f32_16x16x32_bf16 v[180:183], v[212:215], v[76:79], v[180:183]
    s_waitcnt lgkmcnt(5)
    buffer_load_dwordx2 v[26:27], v14, s[12:15], s61 offen offset:1024 sc1
    v_mfma_f32_16x16x32_bf16 v[176:179], v[212:215], v[72:75], v[176:179]
    ds_read_b128 v[212:215], v21 offset:26624
    v_mfma_f32_16x16x32_bf16 v[184:187], v[216:219], v[72:75], v[184:187]
    s_waitcnt lgkmcnt(5)
    buffer_load_dwordx2 v[28:29], v14, s[12:15], s61 offen offset:1536 sc1
    v_mfma_f32_16x16x32_bf16 v[188:191], v[216:219], v[76:79], v[188:191]
    ds_read_b128 v[216:219], v21 offset:27648
    s_waitcnt vmcnt(20)
    v_mfma_f32_16x16x32_bf16 v[136:139], v[192:195], v[80:83], v[136:139]
    s_waitcnt lgkmcnt(5)
    v_mfma_f32_16x16x32_bf16 v[140:143], v[192:195], v[84:87], v[140:143]
    ds_read_b128 v[192:195], v21 offset:28672
    v_mfma_f32_16x16x32_bf16 v[148:151], v[196:199], v[84:87], v[148:151]
    s_waitcnt lgkmcnt(5)
    buffer_load_dwordx2 v[30:31], v14, s[12:15], s61 offen offset:2048 sc1
    v_mfma_f32_16x16x32_bf16 v[144:147], v[196:199], v[80:83], v[144:147]
    ds_read_b128 v[196:199], v21 offset:29696
    v_mfma_f32_16x16x32_bf16 v[152:155], v[200:203], v[80:83], v[152:155]
    s_waitcnt lgkmcnt(5)
    v_mfma_f32_16x16x32_bf16 v[156:159], v[200:203], v[84:87], v[156:159]
    ds_read_b128 v[200:203], v21 offset:30720
    v_mfma_f32_16x16x32_bf16 v[164:167], v[204:207], v[84:87], v[164:167]
    s_waitcnt lgkmcnt(5)
    buffer_load_dwordx2 v[244:245], v14, s[12:15], s61 offen offset:2560 sc1
    v_mfma_f32_16x16x32_bf16 v[160:163], v[204:207], v[80:83], v[160:163]
    ds_read_b128 v[204:207], v21 offset:31744
    v_mfma_f32_16x16x32_bf16 v[168:171], v[208:211], v[80:83], v[168:171]
    s_waitcnt lgkmcnt(5)
    v_mfma_f32_16x16x32_bf16 v[172:175], v[208:211], v[84:87], v[172:175]
    ds_read_b128 v[208:211], v21 offset:32768
    v_mfma_f32_16x16x32_bf16 v[180:183], v[212:215], v[84:87], v[180:183]
    s_waitcnt lgkmcnt(5)
    buffer_load_dwordx2 v[246:247], v14, s[12:15], s61 offen offset:3072 sc1
    v_mfma_f32_16x16x32_bf16 v[176:179], v[212:215], v[80:83], v[176:179]
    ds_read_b128 v[212:215], v21 offset:33792
    v_mfma_f32_16x16x32_bf16 v[184:187], v[216:219], v[80:83], v[184:187]
    s_waitcnt lgkmcnt(5)
    buffer_load_dwordx2 v[248:249], v14, s[12:15], s61 offen offset:3584 sc1
    v_mfma_f32_16x16x32_bf16 v[188:191], v[216:219], v[84:87], v[188:191]
    ds_read_b128 v[216:219], v21 offset:34816
    s_waitcnt vmcnt(22)
    v_mfma_f32_16x16x32_bf16 v[136:139], v[192:195], v[88:91], v[136:139]
    s_waitcnt lgkmcnt(5)
    v_mfma_f32_16x16x32_bf16 v[140:143], v[192:195], v[92:95], v[140:143]
    ds_read_b128 v[192:195], v21 offset:35840
    s_add_u32 s52, s30, 0xc84000
    v_mfma_f32_16x16x32_bf16 v[148:151], v[196:199], v[92:95], v[148:151]
    s_waitcnt lgkmcnt(5)
    buffer_load_dwordx4 v[56:59], v2, s[12:15], s52 offen offset:0 sc1
    v_mfma_f32_16x16x32_bf16 v[144:147], v[196:199], v[88:91], v[144:147]
    ds_read_b128 v[196:199], v21 offset:36864
    v_mfma_f32_16x16x32_bf16 v[152:155], v[200:203], v[88:91], v[152:155]
    s_waitcnt lgkmcnt(5)
    v_mfma_f32_16x16x32_bf16 v[156:159], v[200:203], v[92:95], v[156:159]
    ds_read_b128 v[200:203], v21 offset:37888
    v_mfma_f32_16x16x32_bf16 v[164:167], v[204:207], v[92:95], v[164:167]
    s_waitcnt lgkmcnt(5)
    buffer_load_dwordx4 v[60:63], v2, s[12:15], s52 offen offset:1024 sc1
    v_mfma_f32_16x16x32_bf16 v[160:163], v[204:207], v[88:91], v[160:163]
    ds_read_b128 v[204:207], v21 offset:38912
    v_mfma_f32_16x16x32_bf16 v[168:171], v[208:211], v[88:91], v[168:171]
    s_waitcnt lgkmcnt(5)
    v_mfma_f32_16x16x32_bf16 v[172:175], v[208:211], v[92:95], v[172:175]
    ds_read_b128 v[208:211], v21 offset:39936
    v_mfma_f32_16x16x32_bf16 v[180:183], v[212:215], v[92:95], v[180:183]
    s_waitcnt lgkmcnt(5)
    buffer_load_dwordx4 v[64:67], v2, s[12:15], s52 offen offset:2048 sc1
    v_mfma_f32_16x16x32_bf16 v[176:179], v[212:215], v[88:91], v[176:179]
    ds_read_b128 v[212:215], v21 offset:40960
    v_mfma_f32_16x16x32_bf16 v[184:187], v[216:219], v[88:91], v[184:187]
    s_waitcnt lgkmcnt(5)
    buffer_load_dwordx4 v[68:71], v2, s[12:15], s52 offen offset:3072 sc1
    v_mfma_f32_16x16x32_bf16 v[188:191], v[216:219], v[92:95], v[188:191]
    ds_read_b128 v[216:219], v21 offset:41984
    s_waitcnt vmcnt(24)
    v_mfma_f32_16x16x32_bf16 v[136:139], v[192:195], v[96:99], v[136:139]
    s_waitcnt lgkmcnt(5)
    v_mfma_f32_16x16x32_bf16 v[140:143], v[192:195], v[100:103], v[140:143]
    ds_read_b128 v[192:195], v21 offset:43008
    s_add_u32 s52, s30, 0xc85000
    v_mfma_f32_16x16x32_bf16 v[148:151], v[196:199], v[100:103], v[148:151]
    s_waitcnt lgkmcnt(5)
    buffer_load_dwordx4 v[72:75], v2, s[12:15], s52 offen offset:0 sc1
    v_mfma_f32_16x16x32_bf16 v[144:147], v[196:199], v[96:99], v[144:147]
    ds_read_b128 v[196:199], v21 offset:44032
    v_mfma_f32_16x16x32_bf16 v[152:155], v[200:203], v[96:99], v[152:155]
    s_waitcnt lgkmcnt(5)
    v_mfma_f32_16x16x32_bf16 v[156:159], v[200:203], v[100:103], v[156:159]
    ds_read_b128 v[200:203], v21 offset:45056
    v_mfma_f32_16x16x32_bf16 v[164:167], v[204:207], v[100:103], v[164:167]
    s_waitcnt lgkmcnt(5)
    buffer_load_dwordx4 v[76:79], v2, s[12:15], s52 offen offset:1024 sc1
    v_mfma_f32_16x16x32_bf16 v[160:163], v[204:207], v[96:99], v[160:163]
    ds_read_b128 v[204:207], v21 offset:46080
    v_mfma_f32_16x16x32_bf16 v[168:171], v[208:211], v[96:99], v[168:171]
    s_waitcnt lgkmcnt(5)
    v_mfma_f32_16x16x32_bf16 v[172:175], v[208:211], v[100:103], v[172:175]
    ds_read_b128 v[208:211], v21 offset:47104
    v_mfma_f32_16x16x32_bf16 v[180:183], v[212:215], v[100:103], v[180:183]
    s_waitcnt lgkmcnt(5)
    buffer_load_dwordx4 v[80:83], v2, s[12:15], s52 offen offset:2048 sc1
    v_mfma_f32_16x16x32_bf16 v[176:179], v[212:215], v[96:99], v[176:179]
    ds_read_b128 v[212:215], v21 offset:48128
    v_mfma_f32_16x16x32_bf16 v[184:187], v[216:219], v[96:99], v[184:187]
    s_waitcnt lgkmcnt(5)
    buffer_load_dwordx4 v[84:87], v2, s[12:15], s52 offen offset:3072 sc1
    v_mfma_f32_16x16x32_bf16 v[188:191], v[216:219], v[100:103], v[188:191]
    ds_read_b128 v[216:219], v21 offset:49152
    s_waitcnt vmcnt(8)
L_chk_49:
    v_pk_add_f32 v[250:251], v[120:121], v[122:123]
    v_pk_add_f32 v[252:253], v[124:125], v[126:127]
    v_pk_add_f32 v[250:251], v[250:251], v[128:129]
    v_pk_add_f32 v[252:253], v[252:253], v[130:131]
    v_pk_add_f32 v[250:251], v[250:251], v[132:133]
    v_pk_add_f32 v[252:253], v[252:253], v[134:135]
    v_pk_add_f32 v[250:251], v[250:251], v[22:23]
    v_pk_add_f32 v[252:253], v[252:253], v[24:25]
    v_pk_add_f32 v[250:251], v[250:251], v[26:27]
    v_pk_add_f32 v[252:253], v[252:253], v[28:29]
    v_pk_add_f32 v[250:251], v[250:251], v[30:31]
    v_pk_add_f32 v[252:253], v[252:253], v[244:245]
    v_pk_add_f32 v[250:251], v[250:251], v[246:247]
    v_pk_add_f32 v[252:253], v[252:253], v[248:249]
    v_pk_add_f32 v[250:251], v[250:251], v[252:253]
    v_cmp_u_f32 vcc, v250, v251
    s_cbranch_vccz L_ok_50
    s_cmp_eq_u32 s50, 0
    s_cbranch_scc1 L_ok_50
    s_sub_u32 s50, s50, 1
    s_sleep 1
    s_mov_b64 exec, vcc
    s_add_u32 s41, s41, 1
    s_and_b32 s61, s41, 3
    s_cmp_eq_u32 s61, 0
    s_cselect_b32 s61, 0x1310000, 0
    s_add_u32 s61, s61, s48
    s_add_u32 s61, s61, 0x300000
    buffer_load_dwordx2 v[120:121], v14, s[12:15], s61 offen offset:0 sc1
    buffer_load_dwordx2 v[122:123], v14, s[12:15], s61 offen offset:512 sc1
    buffer_load_dwordx2 v[124:125], v14, s[12:15], s61 offen offset:1024 sc1
    buffer_load_dwordx2 v[126:127], v14, s[12:15], s61 offen offset:1536 sc1
    buffer_load_dwordx2 v[128:129], v14, s[12:15], s61 offen offset:2048 sc1
    buffer_load_dwordx2 v[130:131], v14, s[12:15], s61 offen offset:2560 sc1
    buffer_load_dwordx2 v[132:133], v14, s[12:15], s61 offen offset:3072 sc1
    buffer_load_dwordx2 v[134:135], v14, s[12:15], s61 offen offset:3584 sc1
    s_add_u32 s61, s61, 4096
    buffer_load_dwordx2 v[22:23], v14, s[12:15], s61 offen offset:0 sc1
    buffer_load_dwordx2 v[24:25], v14, s[12:15], s61 offen offset:512 sc1
    buffer_load_dwordx2 v[26:27], v14, s[12:15], s61 offen offset:1024 sc1
    buffer_load_dwordx2 v[28:29], v14, s[12:15], s61 offen offset:1536 sc1
    buffer_load_dwordx2 v[30:31], v14, s[12:15], s61 offen offset:2048 sc1
    buffer_load_dwordx2 v[244:245], v14, s[12:15], s61 offen offset:2560 sc1
    buffer_load_dwordx2 v[246:247], v14, s[12:15], s61 offen offset:3072 sc1
    buffer_load_dwordx2 v[248:249], v14, s[12:15], s61 offen offset:3584 sc1
    s_mov_b64 exec, -1
    s_waitcnt vmcnt(0)
    s_branch L_chk_49
L_ok_50:
    v_mov_b32 v120, v250
    s_add_u32 s52, s30, 0xc86000
    buffer_load_dwordx4 v[88:91], v2, s[12:15], s52 offen offset:0 sc1
    v_mov_b32 v122, v250
    v_mov_b32 v124, v251
    v_mov_b32 v126, v251
    s_nop 1
    v_permlane16_swap_b32 v120, v122
    v_permlane16_swap_b32 v124, v126
    v_mov_b32 v121, v120
    v_mov_b32 v123, v122
    v_mov_b32 v125, v124
    v_mov_b32 v127, v126
    s_nop 1
    v_permlane32_swap_b32 v120, v121
    buffer_load_dwordx4 v[92:95], v2, s[12:15], s52 offen offset:1024 sc1
    v_permlane32_swap_b32 v122, v123
    v_permlane32_swap_b32 v124, v125
    v_permlane32_swap_b32 v126, v127
    v_mov_b32 v22, v120
    v_mov_b32 v23, v121
    v_mul_f32 v22, 0x3acccccd, v22
    v_mul_f32 v23, 0x3acccccd, v23
    v_fma_f32 v23, -v22, v22, v23
    v_max_f32 v23, 0, v23
    v_cvt_pk_bf16_f32 v128, v22, v22
    v_lshlrev_b32 v128, 16, v128
    v_cvt_pk_bf16_f32 v30, v23, v23
    buffer_load_dwordx4 v[96:99], v2, s[12:15], s52 offen offset:2048 sc1
    v_lshlrev_b32 v30, 16, v30
    v_add_f32 v30, 0x3727c5ac, v30
    v_cvt_pk_bf16_f32 v30, v30, v30
    v_lshlrev_b32 v30, 16, v30
    v_sqrt_f32 v30, v30
    s_nop 0
    v_cvt_pk_bf16_f32 v30, v30, v30
    v_lshlrev_b32 v30, 16, v30
    v_rcp_f32 v130, v30
    s_nop 0
    v_fma_f32 v22, -v128, v126, v122
    v_mul_f32 v23, v128, v127
    buffer_load_dwordx4 v[100:103], v2, s[12:15], s52 offen offset:3072 sc1
    v_fma_f32 v120, v130, v22, v120
    v_fma_f32 v22, -v128, v122, v123
    v_fma_f32 v23, -2.0, v125, v23
    v_add_f32 v22, v22, v22
    v_fma_f32 v23, v128, v23, v124
    v_mul_f32 v128, -v128, v130
    v_fma_f32 v22, v130, v23, v22
    v_mov_b32 v131, v130
    v_fma_f32 v121, v130, v22, v121
    v_mov_b32 v129, v128
    v_mul_f32 v120, 0x3acccccd, v120
    v_mul_f32 v121, 0x3acccccd, v121
    v_fma_f32 v121, -v120, v120, v121
    v_max_f32 v121, 0, v121
    v_cvt_pk_bf16_f32 v132, v120, v120
    v_lshlrev_b32 v132, 16, v132
    v_cvt_pk_bf16_f32 v30, v121, v121
    v_lshlrev_b32 v30, 16, v30
    v_add_f32 v30, 0x3727c5ac, v30
    v_cvt_pk_bf16_f32 v30, v30, v30
    v_lshlrev_b32 v30, 16, v30
    v_sqrt_f32 v30, v30
    s_nop 0
    v_cvt_pk_bf16_f32 v30, v30, v30
    v_lshlrev_b32 v30, 16, v30
    v_rcp_f32 v134, v30
    s_nop 0
    v_mul_f32 v132, -v132, v134
    v_mov_b32 v135, v134
    v_mov_b32 v133, v132
    v_lshlrev_b32 v244, 16, v226
    v_and_b32 v245, 0xffff0000, v226
    v_lshlrev_b32 v250, 16, v238
    v_and_b32 v251, 0xffff0000, v238
    v_pk_fma_f32 v[122:123], v[244:245], v[130:131], v[128:129]
    v_pk_fma_f32 v[244:245], v[122:123], v[250:251], v[244:245]
    v_pk_fma_f32 v[122:123], v[244:245], v[134:135], v[132:133]
    v_cvt_pk_bf16_f32 v226, v244, v245
    v_cvt_pk_bf16_f32 v24, v122, v123
    v_lshlrev_b32 v246, 16, v227
    v_and_b32 v247, 0xffff0000, v227
    v_lshlrev_b32 v252, 16, v239
    v_and_b32 v253, 0xffff0000, v239
    v_pk_fma_f32 v[124:125], v[246:247], v[130:131], v[128:129]
    v_pk_fma_f32 v[246:247], v[124:125], v[252:253], v[246:247]
    v_pk_fma_f32 v[124:125], v[246:247], v[134:135], v[132:133]
    v_cvt_pk_bf16_f32 v227, v246, v247
    v_cvt_pk_bf16_f32 v25, v124, v125
    v_lshlrev_b32 v244, 16, v228
    v_and_b32 v245, 0xffff0000, v228
    v_lshlrev_b32 v250, 16, v240
    v_and_b32 v251, 0xffff0000, v240
    v_pk_fma_f32 v[122:123], v[244:245], v[130:131], v[128:129]
    v_pk_fma_f32 v[244:245], v[122:123], v[250:251], v[244:245]
    v_pk_fma_f32 v[122:123], v[244:245], v[134:135], v[132:133]
    v_cvt_pk_bf16_f32 v228, v244, v245
    v_cvt_pk_bf16_f32 v26, v122, v123
    v_lshlrev_b32 v246, 16, v229
    v_and_b32 v247, 0xffff0000, v229
    v_lshlrev_b32 v252, 16, v241
    v_and_b32 v253, 0xffff0000, v241
    v_pk_fma_f32 v[124:125], v[246:247], v[130:131], v[128:129]
    v_pk_fma_f32 v[246:247], v[124:125], v[252:253], v[246:247]
    v_pk_fma_f32 v[124:125], v[246:247], v[134:135], v[132:133]
    v_cvt_pk_bf16_f32 v229, v246, v247
    v_cvt_pk_bf16_f32 v27, v124, v125
    s_add_u32 s55, s36, 0xdc0000
    buffer_store_dwordx4 v[24:27], v8, s[12:15], s55 offen sc1
    v_lshlrev_b32 v244, 16, v230
    v_and_b32 v245, 0xffff0000, v230
    v_lshlrev_b32 v250, 16, v242
    v_and_b32 v251, 0xffff0000, v242
    v_pk_fma_f32 v[122:123], v[244:245], v[130:131], v[128:129]
    v_pk_fma_f32 v[244:245], v[122:123], v[250:251], v[244:245]
    v_pk_fma_f32 v[122:123], v[244:245], v[134:135], v[132:133]
    v_cvt_pk_bf16_f32 v230, v244, v245
    v_cvt_pk_bf16_f32 v28, v122, v123
    v_lshlrev_b32 v246, 16, v231
    v_and_b32 v247, 0xffff0000, v231
    v_lshlrev_b32 v252, 16, v243
    v_and_b32 v253, 0xffff0000, v243
    v_pk_fma_f32 v[124:125], v[246:247], v[130:131], v[128:129]
    v_pk_fma_f32 v[246:247], v[124:125], v[252:253], v[246:247]
    v_pk_fma_f32 v[124:125], v[246:247], v[134:135], v[132:133]
    v_cvt_pk_bf16_f32 v231, v246, v247
    v_cvt_pk_bf16_f32 v29, v124, v125
    s_add_u32 s55, s36, 0xdc0000
    s_mov_b64 exec, s[56:57]
    buffer_store_dwordx2 v[28:29], v9, s[12:15], s55 offen sc1
    s_mov_b64 exec, -1
    v_mfma_f32_16x16x32_bf16 v[136:139], v[192:195], v[104:107], v[136:139]
    s_waitcnt lgkmcnt(5)
    v_mfma_f32_16x16x32_bf16 v[140:143], v[192:195], v[108:111], v[140:143]
    ds_read_b128 v[192:195], v21 offset:50176
    v_mfma_f32_16x16x32_bf16 v[148:151], v[196:199], v[108:111], v[148:151]
    s_waitcnt lgkmcnt(5)
    v_mfma_f32_16x16x32_bf16 v[144:147], v[196:199], v[104:107], v[144:147]
    ds_read_b128 v[196:199], v21 offset:51200
    v_mfma_f32_16x16x32_bf16 v[152:155], v[200:203], v[104:107], v[152:155]
    s_waitcnt lgkmcnt(5)
    v_mfma_f32_16x16x32_bf16 v[156:159], v[200:203], v[108:111], v[156:159]
    ds_read_b128 v[200:203], v21 offset:52224
    v_mfma_f32_16x16x32_bf16 v[164:167], v[204:207], v[108:111], v[164:167]
    s_waitcnt lgkmcnt(5)
    v_mfma_f32_16x16x32_bf16 v[160:163], v[204:207], v[104:107], v[160:163]
    ds_read_b128 v[204:207], v21 offset:53248
    v_mfma_f32_16x16x32_bf16 v[168:171], v[208:211], v[104:107], v[168:171]
    s_waitcnt lgkmcnt(5)
    v_mfma_f32_16x16x32_bf16 v[172:175], v[208:211], v[108:111], v[172:175]
    ds_read_b128 v[208:211], v21 offset:54272
    v_mfma_f32_16x16x32_bf16 v[180:183], v[212:215], v[108:111], v[180:183]
    s_waitcnt lgkmcnt(5)
    v_mfma_f32_16x16x32_bf16 v[176:179], v[212:215], v[104:107], v[176:179]
    ds_read_b128 v[212:215], v21 offset:55296
    v_mfma_f32_16x16x32_bf16 v[184:187], v[216:219], v[104:107], v[184:187]
    s_waitcnt lgkmcnt(5)
    v_mfma_f32_16x16x32_bf16 v[188:191], v[216:219], v[108:111], v[188:191]
    ds_read_b128 v[216:219], v21 offset:56320
    v_mfma_f32_16x16x32_bf16 v[136:139], v[192:195], v[112:115], v[136:139]
    s_waitcnt lgkmcnt(5)
    v_mfma_f32_16x16x32_bf16 v[140:143], v[192:195], v[116:119], v[140:143]
    ds_read_b128 v[192:195], v21 offset:57344
    s_add_u32 s52, s30, 0xc87000
    v_mfma_f32_16x16x32_bf16 v[148:151], v[196:199], v[116:119], v[148:151]
    s_waitcnt lgkmcnt(5)
    buffer_load_dwordx4 v[104:107], v2, s[12:15], s52 offen offset:0 sc1
    v_mfma_f32_16x16x32_bf16 v[144:147], v[196:199], v[112:115], v[144:147]
    ds_read_b128 v[196:199], v21 offset:58368
    v_mfma_f32_16x16x32_bf16 v[152:155], v[200:203], v[112:115], v[152:155]
    s_waitcnt lgkmcnt(5)
    v_mfma_f32_16x16x32_bf16 v[156:159], v[200:203], v[116:119], v[156:159]
    ds_read_b128 v[200:203], v21 offset:59392
    v_mfma_f32_16x16x32_bf16 v[164:167], v[204:207], v[116:119], v[164:167]
    s_waitcnt lgkmcnt(5)
    buffer_load_dwordx4 v[108:111], v2, s[12:15], s52 offen offset:1024 sc1
    v_mfma_f32_16x16x32_bf16 v[160:163], v[204:207], v[112:115], v[160:163]
    ds_read_b128 v[204:207], v21 offset:60416
    v_mfma_f32_16x16x32_bf16 v[168:171], v[208:211], v[112:115], v[168:171]
    s_waitcnt lgkmcnt(5)
    v_mfma_f32_16x16x32_bf16 v[172:175], v[208:211], v[116:119], v[172:175]
    ds_read_b128 v[208:211], v21 offset:61440
    v_mfma_f32_16x16x32_bf16 v[180:183], v[212:215], v[116:119], v[180:183]
    s_waitcnt lgkmcnt(5)
    v_mfma_f32_16x16x32_bf16 v[176:179], v[212:215], v[112:115], v[176:179]
    ds_read_b128 v[212:215], v21 offset:62464
    v_mfma_f32_16x16x32_bf16 v[184:187], v[216:219], v[112:115], v[184:187]
    s_waitcnt lgkmcnt(5)
    v_mfma_f32_16x16x32_bf16 v[188:191], v[216:219], v[116:119], v[188:191]
    ds_read_b128 v[216:219], v21 offset:63488
    s_waitcnt vmcnt(14)
    v_mfma_f32_16x16x32_bf16 v[136:139], v[192:195], v[56:59], v[136:139]
    s_waitcnt lgkmcnt(5)
    v_mfma_f32_16x16x32_bf16 v[140:143], v[192:195], v[60:63], v[140:143]
    ds_read_b128 v[192:195], v21 offset:64512
    v_mfma_f32_16x16x32_bf16 v[148:151], v[196:199], v[60:63], v[148:151]
    s_waitcnt lgkmcnt(5)
    buffer_load_dwordx4 v[112:115], v2, s[12:15], s52 offen offset:2048 sc1
    v_mfma_f32_16x16x32_bf16 v[144:147], v[196:199], v[56:59], v[144:147]
    ds_read_b128 v[196:199], v3 offset:0
    v_mfma_f32_16x16x32_bf16 v[152:155], v[200:203], v[56:59], v[152:155]
    s_waitcnt lgkmcnt(5)
    v_mfma_f32_16x16x32_bf16 v[156:159], v[200:203], v[60:63], v[156:159]
    ds_read_b128 v[200:203], v3 offset:1024
    v_mfma_f32_16x16x32_bf16 v[164:167], v[204:207], v[60:63], v[164:167]
    s_waitcnt lgkmcnt(5)
    buffer_load_dwordx4 v[116:119], v2, s[12:15], s52 offen offset:3072 sc1
    v_mfma_f32_16x16x32_bf16 v[160:163], v[204:207], v[56:59], v[160:163]
    ds_read_b128 v[204:207], v3 offset:2048
    v_mfma_f32_16x16x32_bf16 v[168:171], v[208:211], v[56:59], v[168:171]
    s_waitcnt lgkmcnt(5)
    v_mfma_f32_16x16x32_bf16 v[172:175], v[208:211], v[60:63], v[172:175]
    ds_read_b128 v[208:211], v3 offset:3072
    v_mfma_f32_16x16x32_bf16 v[180:183], v[212:215], v[60:63], v[180:183]
    s_waitcnt lgkmcnt(5)
    v_mfma_f32_16x16x32_bf16 v[176:179], v[212:215], v[56:59], v[176:179]
    ds_read_b128 v[212:215], v3 offset:4096
    v_mfma_f32_16x16x32_bf16 v[184:187], v[216:219], v[56:59], v[184:187]
    s_waitcnt lgkmcnt(5)
    v_mfma_f32_16x16x32_bf16 v[188:191], v[216:219], v[60:63], v[188:191]
    ds_read_b128 v[216:219], v3 offset:5120
    s_waitcnt vmcnt(4)
    s_barrier
    s_cmp_lg_u32 s3, 0
    s_cbranch_scc1 L_nopub_51
    s_add_u32 s55, s42, 0x16f0000
    s_mov_b64 exec, 1
    buffer_store_dword v19, v20, s[12:15], s55 offen sc1
    s_mov_b64 exec, -1
L_nopub_51:
    v_mfma_f32_16x16x32_bf16 v[136:139], v[192:195], v[64:67], v[136:139]
    s_waitcnt lgkmcnt(5)
    v_mfma_f32_16x16x32_bf16 v[140:143], v[192:195], v[68:71], v[140:143]
    ds_read_b128 v[192:195], v3 offset:6144
    s_add_u32 s52, s30, 0xc88000
    v_mfma_f32_16x16x32_bf16 v[148:151], v[196:199], v[68:71], v[148:151]
    s_waitcnt lgkmcnt(5)
    buffer_load_dwordx4 v[56:59], v2, s[12:15], s52 offen offset:0 sc1
    v_mfma_f32_16x16x32_bf16 v[144:147], v[196:199], v[64:67], v[144:147]
    ds_read_b128 v[196:199], v3 offset:7168
    v_mfma_f32_16x16x32_bf16 v[152:155], v[200:203], v[64:67], v[152:155]
    s_waitcnt lgkmcnt(5)
    v_mfma_f32_16x16x32_bf16 v[156:159], v[200:203], v[68:71], v[156:159]
    ds_read_b128 v[200:203], v3 offset:8192
    v_mfma_f32_16x16x32_bf16 v[164:167], v[204:207], v[68:71], v[164:167]
    s_waitcnt lgkmcnt(5)
    buffer_load_dwordx4 v[60:63], v2, s[12:15], s52 offen offset:1024 sc1
    v_mfma_f32_16x16x32_bf16 v[160:163], v[204:207], v[64:67], v[160:163]
    ds_read_b128 v[204:207], v3 offset:9216
    v_mfma_f32_16x16x32_bf16 v[168:171], v[208:211], v[64:67], v[168:171]
    s_waitcnt lgkmcnt(5)
    v_mfma_f32_16x16x32_bf16 v[172:175], v[208:211], v[68:71], v[172:175]
    ds_read_b128 v[208:211], v3 offset:10240
    v_mfma_f32_16x16x32_bf16 v[180:183], v[212:215], v[68:71], v[180:183]
    s_waitcnt lgkmcnt(5)
    v_mfma_f32_16x16x32_bf16 v[176:179], v[212:215], v[64:67], v[176:179]
    ds_read_b128 v[212:215], v3 offset:11264
    v_mfma_f32_16x16x32_bf16 v[184:187], v[216:219], v[64:67], v[184:187]
    s_waitcnt lgkmcnt(5)
    v_mfma_f32_16x16x32_bf16 v[188:191], v[216:219], v[68:71], v[188:191]
    ds_read_b128 v[216:219], v3 offset:12288
    v_mfma_f32_16x16x32_bf16 v[136:139], v[192:195], v[72:75], v[136:139]
    s_waitcnt lgkmcnt(5)
    v_mfma_f32_16x16x32_bf16 v[140:143], v[192:195], v[76:79], v[140:143]
    ds_read_b128 v[192:195], v3 offset:13312
    v_mfma_f32_16x16x32_bf16 v[148:151], v[196:199], v[76:79], v[148:151]
    s_waitcnt lgkmcnt(5)
    buffer_load_dwordx4 v[64:67], v2, s[12:15], s52 offen offset:2048 sc1
    v_mfma_f32_16x16x32_bf16 v[144:147], v[196:199], v[72:75], v[144:147]
    ds_read_b128 v[196:199], v3 offset:14336
    v_mfma_f32_16x16x32_bf16 v[152:155], v[200:203], v[72:75], v[152:155]
    s_waitcnt lgkmcnt(5)
    v_mfma_f32_16x16x32_bf16 v[156:159], v[200:203], v[76:79], v[156:159]
    ds_read_b128 v[200:203], v3 offset:15360
    v_mfma_f32_16x16x32_bf16 v[164:167], v[204:207], v[76:79], v[164:167]
    s_waitcnt lgkmcnt(5)
    buffer_load_dwordx4 v[68:71], v2, s[12:15], s52 offen offset:3072 sc1
    v_mfma_f32_16x16x32_bf16 v[160:163], v[204:207], v[72:75], v[160:163]
    ds_read_b128 v[204:207], v3 offset:16384
    v_mfma_f32_16x16x32_bf16 v[168:171], v[208:211], v[72:75], v[168:171]
    s_waitcnt lgkmcnt(5)
    v_mfma_f32_16x16x32_bf16 v[172:175], v[208:211], v[76:79], v[172:175]
    ds_read_b128 v[208:211], v3 offset:17408
    v_mfma_f32_16x16x32_bf16 v[180:183], v[212:215], v[76:79], v[180:183]
    s_waitcnt lgkmcnt(5)
    v_mfma_f32_16x16x32_bf16 v[176:179], v[212:215], v[72:75], v[176:179]
    ds_read_b128 v[212:215], v3 offset:18432
    v_mfma_f32_16x16x32_bf16 v[184:187], v[216:219], v[72:75], v[184:187]
    s_waitcnt lgkmcnt(5)
    v_mfma_f32_16x16x32_bf16 v[188:191], v[216:219], v[76:79], v[188:191]
    ds_read_b128 v[216:219], v3 offset:19456
    v_mfma_f32_16x16x32_bf16 v[136:139], v[192:195], v[80:83], v[136:139]
    s_waitcnt lgkmcnt(5)
    v_mfma_f32_16x16x32_bf16 v[140:143], v[192:195], v[84:87], v[140:143]
    ds_read_b128 v[192:195], v3 offset:20480
    s_add_u32 s52, s30, 0xc89000
    v_mfma_f32_16x16x32_bf16 v[148:151], v[196:199], v[84:87], v[148:151]
    s_waitcnt lgkmcnt(5)
    buffer_load_dwordx4 v[72:75], v2, s[12:15], s52 offen offset:0 sc1
    v_mfma_f32_16x16x32_bf16 v[144:147], v[196:199], v[80:83], v[144:147]
    ds_read_b128 v[196:199], v3 offset:21504
    v_mfma_f32_16x16x32_bf16 v[152:155], v[200:203], v[80:83], v[152:155]
    s_waitcnt lgkmcnt(5)
    v_mfma_f32_16x16x32_bf16 v[156:159], v[200:203], v[84:87], v[156:159]
    ds_read_b128 v[200:203], v3 offset:22528
    v_mfma_f32_16x16x32_bf16 v[164:167], v[204:207], v[84:87], v[164:167]
    s_waitcnt lgkmcnt(5)
    buffer_load_dwordx4 v[76:79], v2, s[12:15], s52 offen offset:1024 sc1
    v_mfma_f32_16x16x32_bf16 v[160:163], v[204:207], v[80:83], v[160:163]
    ds_read_b128 v[204:207], v3 offset:23552
    v_mfma_f32_16x16x32_bf16 v[168:171], v[208:211], v[80:83], v[168:171]
    s_waitcnt lgkmcnt(5)
    v_mfma_f32_16x16x32_bf16 v[172:175], v[208:211], v[84:87], v[172:175]
    ds_read_b128 v[208:211], v3 offset:24576
    v_mfma_f32_16x16x32_bf16 v[180:183], v[212:215], v[84:87], v[180:183]
    s_waitcnt lgkmcnt(5)
    v_mfma_f32_16x16x32_bf16 v[176:179], v[212:215], v[80:83], v[176:179]
    ds_read_b128 v[212:215], v3 offset:25600
    v_mfma_f32_16x16x32_bf16 v[184:187], v[216:219], v[80:83], v[184:187]
    s_waitcnt lgkmcnt(5)
    v_mfma_f32_16x16x32_bf16 v[188:191], v[216:219], v[84:87], v[188:191]
    ds_read_b128 v[216:219], v3 offset:26624
    v_mfma_f32_16x16x32_bf16 v[136:139], v[192:195], v[88:91], v[136:139]
    s_waitcnt lgkmcnt(5)
    v_mfma_f32_16x16x32_bf16 v[140:143], v[192:195], v[92:95], v[140:143]
    ds_read_b128 v[192:195], v3 offset:27648
    v_mfma_f32_16x16x32_bf16 v[148:151], v[196:199], v[92:95], v[148:151]
    s_waitcnt lgkmcnt(5)
    buffer_load_dwordx4 v[120:123], v2, s[12:15], s52 offen offset:2048 sc1
    v_mfma_f32_16x16x32_bf16 v[144:147], v[196:199], v[88:91], v[144:147]
    ds_read_b128 v[196:199], v3 offset:28672
    v_mfma_f32_16x16x32_bf16 v[152:155], v[200:203], v[88:91], v[152:155]
    s_waitcnt lgkmcnt(5)
    v_mfma_f32_16x16x32_bf16 v[156:159], v[200:203], v[92:95], v[156:159]
    ds_read_b128 v[200:203], v3 offset:29696
    v_mfma_f32_16x16x32_bf16 v[164:167], v[204:207], v[92:95], v[164:167]
    s_waitcnt lgkmcnt(5)
    buffer_load_dwordx4 v[124:127], v2, s[12:15], s52 offen offset:3072 sc1
    v_mfma_f32_16x16x32_bf16 v[160:163], v[204:207], v[88:91], v[160:163]
    ds_read_b128 v[204:207], v3 offset:30720
    v_mfma_f32_16x16x32_bf16 v[168:171], v[208:211], v[88:91], v[168:171]
    s_waitcnt lgkmcnt(5)
    v_mfma_f32_16x16x32_bf16 v[172:175], v[208:211], v[92:95], v[172:175]
    ds_read_b128 v[208:211], v3 offset:31744
    v_mfma_f32_16x16x32_bf16 v[180:183], v[212:215], v[92:95], v[180:183]
    s_waitcnt lgkmcnt(5)
    v_mfma_f32_16x16x32_bf16 v[176:179], v[212:215], v[88:91], v[176:179]
    ds_read_b128 v[212:215], v3 offset:32768
    v_mfma_f32_16x16x32_bf16 v[184:187], v[216:219], v[88:91], v[184:187]
    s_waitcnt lgkmcnt(5)
    v_mfma_f32_16x16x32_bf16 v[188:191], v[216:219], v[92:95], v[188:191]
    ds_read_b128 v[216:219], v3 offset:33792
    s_add_u32 s55, s40, 0x16f0000
    buffer_load_dword v18, v13, s[12:15], s55 offen sc1
    v_mfma_f32_16x16x32_bf16 v[136:139], v[192:195], v[96:99], v[136:139]
    s_waitcnt lgkmcnt(5)
    v_mfma_f32_16x16x32_bf16 v[140:143], v[192:195], v[100:103], v[140:143]
    ds_read_b128 v[192:195], v3 offset:34816
    v_mfma_f32_16x16x32_bf16 v[148:151], v[196:199], v[100:103], v[148:151]
    s_waitcnt lgkmcnt(5)
    v_mfma_f32_16x16x32_bf16 v[144:147], v[196:199], v[96:99], v[144:147]
    ds_read_b128 v[196:199], v3 offset:35840
    v_mfma_f32_16x16x32_bf16 v[152:155], v[200:203], v[96:99], v[152:155]
    s_waitcnt lgkmcnt(5)
    v_mfma_f32_16x16x32_bf16 v[156:159], v[200:203], v[100:103], v[156:159]
    ds_read_b128 v[200:203], v3 offset:36864
    v_mfma_f32_16x16x32_bf16 v[164:167], v[204:207], v[100:103], v[164:167]
    s_waitcnt lgkmcnt(5)
    v_mfma_f32_16x16x32_bf16 v[160:163], v[204:207], v[96:99], v[160:163]
    ds_read_b128 v[204:207], v3 offset:37888
    v_mfma_f32_16x16x32_bf16 v[168:171], v[208:211], v[96:99], v[168:171]
    s_waitcnt lgkmcnt(5)
    v_mfma_f32_16x16x32_bf16 v[172:175], v[208:211], v[100:103], v[172:175]
    ds_read_b128 v[208:211], v3 offset:38912
    v_mfma_f32_16x16x32_bf16 v[180:183], v[212:215], v[100:103], v[180:183]
    s_waitcnt lgkmcnt(5)
    v_mfma_f32_16x16x32_bf16 v[176:179], v[212:215], v[96:99], v[176:179]
    ds_read_b128 v[212:215], v3 offset:39936
    v_mfma_f32_16x16x32_bf16 v[184:187], v[216:219], v[96:99], v[184:187]
    s_waitcnt lgkmcnt(5)
    v_mfma_f32_16x16x32_bf16 v[188:191], v[216:219], v[100:103], v[188:191]
    ds_read_b128 v[216:219], v3 offset:40960
    s_waitcnt vmcnt(11)
    v_mfma_f32_16x16x32_bf16 v[136:139], v[192:195], v[104:107], v[136:139]
    s_waitcnt lgkmcnt(5)
    v_mfma_f32_16x16x32_bf16 v[140:143], v[192:195], v[108:111], v[140:143]
    ds_read_b128 v[192:195], v3 offset:41984
    v_mfma_f32_16x16x32_bf16 v[148:151], v[196:199], v[108:111], v[148:151]
    s_waitcnt lgkmcnt(5)
    v_mfma_f32_16x16x32_bf16 v[144:147], v[196:199], v[104:107], v[144:147]
    ds_read_b128 v[196:199], v3 offset:43008
    v_mfma_f32_16x16x32_bf16 v[152:155], v[200:203], v[104:107], v[152:155]
    s_waitcnt lgkmcnt(5)
    v_mfma_f32_16x16x32_bf16 v[156:159], v[200:203], v[108:111], v[156:159]
    ds_read_b128 v[200:203], v3 offset:44032
    v_mfma_f32_16x16x32_bf16 v[164:167], v[204:207], v[108:111], v[164:167]
    s_waitcnt lgkmcnt(5)
    v_mfma_f32_16x16x32_bf16 v[160:163], v[204:207], v[104:107], v[160:163]
    ds_read_b128 v[204:207], v3 offset:45056
    v_mfma_f32_16x16x32_bf16 v[168:171], v[208:211], v[104:107], v[168:171]
    s_waitcnt lgkmcnt(5)
    v_mfma_f32_16x16x32_bf16 v[172:175], v[208:211], v[108:111], v[172:175]
    ds_read_b128 v[208:211], v3 offset:46080
    v_mfma_f32_16x16x32_bf16 v[180:183], v[212:215], v[108:111], v[180:183]
    s_waitcnt lgkmcnt(5)
    v_mfma_f32_16x16x32_bf16 v[176:179], v[212:215], v[104:107], v[176:179]
    ds_read_b128 v[212:215], v3 offset:47104
    v_mfma_f32_16x16x32_bf16 v[184:187], v[216:219], v[104:107], v[184:187]
    s_waitcnt lgkmcnt(5)
    v_mfma_f32_16x16x32_bf16 v[188:191], v[216:219], v[108:111], v[188:191]
    ds_read_b128 v[216:219], v3 offset:48128
    s_waitcnt vmcnt(9)
    v_mfma_f32_16x16x32_bf16 v[136:139], v[192:195], v[112:115], v[136:139]
    s_waitcnt lgkmcnt(5)
    v_mfma_f32_16x16x32_bf16 v[140:143], v[192:195], v[116:119], v[140:143]
    ds_read_b128 v[192:195], v3 offset:49152
    v_mfma_f32_16x16x32_bf16 v[148:151], v[196:199], v[116:119], v[148:151]
    s_waitcnt lgkmcnt(5)
    v_mfma_f32_16x16x32_bf16 v[144:147], v[196:199], v[112:115], v[144:147]
    ds_read_b128 v[196:199], v3 offset:50176
    v_mfma_f32_16x16x32_bf16 v[152:155], v[200:203], v[112:115], v[152:155]
    s_waitcnt lgkmcnt(5)
    v_mfma_f32_16x16x32_bf16 v[156:159], v[200:203], v[116:119], v[156:159]
    ds_read_b128 v[200:203], v3 offset:51200
    v_mfma_f32_16x16x32_bf16 v[164:167], v[204:207], v[116:119], v[164:167]
    s_waitcnt lgkmcnt(5)
    v_mfma_f32_16x16x32_bf16 v[160:163], v[204:207], v[112:115], v[160:163]
    ds_read_b128 v[204:207], v3 offset:52224
    v_mfma_f32_16x16x32_bf16 v[168:171], v[208:211], v[112:115], v[168:171]
    s_waitcnt lgkmcnt(5)
    v_mfma_f32_16x16x32_bf16 v[172:175], v[208:211], v[116:119], v[172:175]
    ds_read_b128 v[208:211], v3 offset:53248
    v_mfma_f32_16x16x32_bf16 v[180:183], v[212:215], v[116:119], v[180:183]
    s_waitcnt lgkmcnt(5)
    v_mfma_f32_16x16x32_bf16 v[176:179], v[212:215], v[112:115], v[176:179]
    ds_read_b128 v[212:215], v3 offset:54272
    v_mfma_f32_16x16x32_bf16 v[184:187], v[216:219], v[112:115], v[184:187]
    s_waitcnt lgkmcnt(5)
    v_mfma_f32_16x16x32_bf16 v[188:191], v[216:219], v[116:119], v[188:191]
    ds_read_b128 v[216:219], v3 offset:55296
    s_waitcnt vmcnt(7)
    v_mfma_f32_16x16x32_bf16 v[136:139], v[192:195], v[56:59], v[136:139]
    s_waitcnt lgkmcnt(5)
    v_mfma_f32_16x16x32_bf16 v[140:143], v[192:195], v[60:63], v[140:143]
    ds_read_b128 v[192:195], v3 offset:56320
    v_mfma_f32_16x16x32_bf16 v[148:151], v[196:199], v[60:63], v[148:151]
    s_waitcnt lgkmcnt(5)
    v_mfma_f32_16x16x32_bf16 v[144:147], v[196:199], v[56:59], v[144:147]
    ds_read_b128 v[196:199], v3 offset:57344
    v_mfma_f32_16x16x32_bf16 v[152:155], v[200:203], v[56:59], v[152:155]
    s_waitcnt lgkmcnt(5)
    v_mfma_f32_16x16x32_bf16 v[156:159], v[200:203], v[60:63], v[156:159]
    ds_read_b128 v[200:203], v3 offset:58368
    v_mfma_f32_16x16x32_bf16 v[164:167], v[204:207], v[60:63], v[164:167]
    s_waitcnt lgkmcnt(5)
    v_mfma_f32_16x16x32_bf16 v[160:163], v[204:207], v[56:59], v[160:163]
    ds_read_b128 v[204:207], v3 offset:59392
    v_mfma_f32_16x16x32_bf16 v[168:171], v[208:211], v[56:59], v[168:171]
    s_waitcnt lgkmcnt(5)
    v_mfma_f32_16x16x32_bf16 v[172:175], v[208:211], v[60:63], v[172:175]
    ds_read_b128 v[208:211], v3 offset:60416
    v_mfma_f32_16x16x32_bf16 v[180:183], v[212:215], v[60:63], v[180:183]
    s_waitcnt lgkmcnt(5)
    v_mfma_f32_16x16x32_bf16 v[176:179], v[212:215], v[56:59], v[176:179]
    ds_read_b128 v[212:215], v3 offset:61440
    v_mfma_f32_16x16x32_bf16 v[184:187], v[216:219], v[56:59], v[184:187]
    s_waitcnt lgkmcnt(5)
    v_mfma_f32_16x16x32_bf16 v[188:191], v[216:219], v[60:63], v[188:191]
    ds_read_b128 v[216:219], v3 offset:62464
    s_waitcnt vmcnt(0)
L_chk_52:
    v_cmp_ne_u32 vcc, v19, v18
    s_cbranch_vccz L_ok_53
    s_cmp_eq_u32 s50, 0
    s_cbranch_scc1 L_ok_53
    s_sub_u32 s50, s50, 1
    s_sleep 1
    s_mov_b64 exec, vcc
    s_add_u32 s55, s40, 0x16f0000
    buffer_load_dword v18, v13, s[12:15], s55 offen sc1
    s_mov_b64 exec, -1
    s_waitcnt vmcnt(0)
    s_branch L_chk_52
L_ok_53:
    v_mfma_f32_16x16x32_bf16 v[136:139], v[192:195], v[64:67], v[136:139]
    s_waitcnt lgkmcnt(5)
    v_mfma_f32_16x16x32_bf16 v[140:143], v[192:195], v[68:71], v[140:143]
    ds_read_b128 v[192:195], v3 offset:63488
    s_add_u32 s52, s30, 0xdc0000
    v_mfma_f32_16x16x32_bf16 v[148:151], v[196:199], v[68:71], v[148:151]
    s_waitcnt lgkmcnt(5)
    buffer_load_dwordx4 v[128:131], v2, s[12:15], s52 offen offset:0 sc1
    v_mfma_f32_16x16x32_bf16 v[144:147], v[196:199], v[64:67], v[144:147]
    ds_read_b128 v[196:199], v3 offset:64512
    v_mfma_f32_16x16x32_bf16 v[152:155], v[200:203], v[64:67], v[152:155]
    s_waitcnt lgkmcnt(5)
    v_mfma_f32_16x16x32_bf16 v[156:159], v[200:203], v[68:71], v[156:159]
    ds_read_b128 v[200:203], v4 offset:0
    v_mfma_f32_16x16x32_bf16 v[164:167], v[204:207], v[68:71], v[164:167]
    s_waitcnt lgkmcnt(5)
    buffer_load_dwordx4 v[132:135], v2, s[12:15], s52 offen offset:1024 sc1
    v_mfma_f32_16x16x32_bf16 v[160:163], v[204:207], v[64:67], v[160:163]
    ds_read_b128 v[204:207], v4 offset:1024
    v_mfma_f32_16x16x32_bf16 v[168:171], v[208:211], v[64:67], v[168:171]
    s_waitcnt lgkmcnt(5)
    v_mfma_f32_16x16x32_bf16 v[172:175], v[208:211], v[68:71], v[172:175]
    ds_read_b128 v[208:211], v4 offset:2048
    v_mfma_f32_16x16x32_bf16 v[180:183], v[212:215], v[68:71], v[180:183]
    s_waitcnt lgkmcnt(5)
    buffer_load_dwordx4 v[80:83], v2, s[12:15], s52 offen offset:2048 sc1
    v_mfma_f32_16x16x32_bf16 v[176:179], v[212:215], v[64:67], v[176:179]
    ds_read_b128 v[212:215], v4 offset:3072
    v_mfma_f32_16x16x32_bf16 v[184:187], v[216:219], v[64:67], v[184:187]
    s_waitcnt lgkmcnt(5)
    buffer_load_dwordx4 v[84:87], v2, s[12:15], s52 offen offset:3072 sc1
    v_mfma_f32_16x16x32_bf16 v[188:191], v[216:219], v[68:71], v[188:191]
    ds_read_b128 v[216:219], v4 offset:4096
    v_mfma_f32_16x16x32_bf16 v[136:139], v[192:195], v[72:75], v[136:139]
    s_waitcnt lgkmcnt(5)
    v_mfma_f32_16x16x32_bf16 v[140:143], v[192:195], v[76:79], v[140:143]
    ds_read_b128 v[192:195], v4 offset:5120
    s_add_u32 s52, s30, 0xdc1000
    v_mfma_f32_16x16x32_bf16 v[148:151], v[196:199], v[76:79], v[148:151]
    s_waitcnt lgkmcnt(5)
    buffer_load_dwordx4 v[88:91], v2, s[12:15], s52 offen offset:0 sc1
    v_mfma_f32_16x16x32_bf16 v[144:147], v[196:199], v[72:75], v[144:147]
    ds_read_b128 v[196:199], v4 offset:6144
    v_mfma_f32_16x16x32_bf16 v[152:155], v[200:203], v[72:75], v[152:155]
    s_waitcnt lgkmcnt(5)
    v_mfma_f32_16x16x32_bf16 v[156:159], v[200:203], v[76:79], v[156:159]
    ds_read_b128 v[200:203], v4 offset:7168
    v_mfma_f32_16x16x32_bf16 v[164:167], v[204:207], v[76:79], v[164:167]
    s_waitcnt lgkmcnt(5)
    buffer_load_dwordx4 v[92:95], v2, s[12:15], s52 offen offset:1024 sc1
    v_mfma_f32_16x16x32_bf16 v[160:163], v[204:207], v[72:75], v[160:163]
    ds_read_b128 v[204:207], v4 offset:8192
    v_mfma_f32_16x16x32_bf16 v[168:171], v[208:211], v[72:75], v[168:171]
    s_waitcnt lgkmcnt(5)
    v_mfma_f32_16x16x32_bf16 v[172:175], v[208:211], v[76:79], v[172:175]
    ds_read_b128 v[208:211], v4 offset:9216
    v_mfma_f32_16x16x32_bf16 v[180:183], v[212:215], v[76:79], v[180:183]
    s_waitcnt lgkmcnt(5)
    buffer_load_dwordx4 v[96:99], v2, s[12:15], s52 offen offset:2048 sc1
    v_mfma_f32_16x16x32_bf16 v[176:179], v[212:215], v[72:75], v[176:179]
    ds_read_b128 v[212:215], v4 offset:10240
    v_mfma_f32_16x16x32_bf16 v[184:187], v[216:219], v[72:75], v[184:187]
    s_waitcnt lgkmcnt(5)
    buffer_load_dwordx4 v[100:103], v2, s[12:15], s52 offen offset:3072 sc1
    v_mfma_f32_16x16x32_bf16 v[188:191], v[216:219], v[76:79], v[188:191]
    ds_read_b128 v[216:219], v4 offset:11264
    v_mfma_f32_16x16x32_bf16 v[136:139], v[192:195], v[120:123], v[136:139]
    s_waitcnt lgkmcnt(5)
    v_mfma_f32_16x16x32_bf16 v[140:143], v[192:195], v[124:127], v[140:143]
    ds_read_b128 v[192:195], v21 offset:0
    s_add_u32 s52, s30, 0xdc2000
    v_mfma_f32_16x16x32_bf16 v[148:151], v[196:199], v[124:127], v[148:151]
    s_waitcnt lgkmcnt(5)
    buffer_load_dwordx4 v[104:107], v2, s[12:15], s52 offen offset:0 sc1
    v_mfma_f32_16x16x32_bf16 v[144:147], v[196:199], v[120:123], v[144:147]
    ds_read_b128 v[196:199], v21 offset:1024
    v_mfma_f32_16x16x32_bf16 v[152:155], v[200:203], v[120:123], v[152:155]
    s_waitcnt lgkmcnt(5)
    v_mfma_f32_16x16x32_bf16 v[156:159], v[200:203], v[124:127], v[156:159]
    ds_read_b128 v[200:203], v21 offset:2048
    s_add_u32 s54, s34, 0x1ed0000
    v_pk_mul_f32 v[136:137], v[136:137], v[138:139]
    v_pk_mul_f32 v[140:141], v[140:141], v[142:143]
    v_cvt_pk_bf16_f32 v136, v136, v137
    v_cvt_pk_bf16_f32 v140, v140, v141
    v_mfma_f32_16x16x32_bf16 v[164:167], v[204:207], v[124:127], v[164:167]
    s_waitcnt lgkmcnt(5)
    buffer_load_dwordx4 v[108:111], v2, s[12:15], s52 offen offset:1024 sc1
    v_mfma_f32_16x16x32_bf16 v[160:163], v[204:207], v[120:123], v[160:163]
    ds_read_b128 v[204:207], v21 offset:3072
    v_pk_mul_f32 v[144:145], v[144:145], v[146:147]
    v_pk_mul_f32 v[148:149], v[148:149], v[150:151]
    v_cvt_pk_bf16_f32 v137, v144, v145
    v_cvt_pk_bf16_f32 v141, v148, v149
    v_mfma_f32_16x16x32_bf16 v[168:171], v[208:211], v[120:123], v[168:171]
    s_waitcnt lgkmcnt(5)
    v_mfma_f32_16x16x32_bf16 v[172:175], v[208:211], v[124:127], v[172:175]
    ds_read_b128 v[208:211], v21 offset:4096
    v_pk_mul_f32 v[152:153], v[152:153], v[154:155]
    v_pk_mul_f32 v[156:157], v[156:157], v[158:159]
    v_cvt_pk_bf16_f32 v138, v152, v153
    v_cvt_pk_bf16_f32 v142, v156, v157
    v_mfma_f32_16x16x32_bf16 v[180:183], v[212:215], v[124:127], v[180:183]
    s_waitcnt lgkmcnt(5)
    buffer_load_dwordx4 v[112:115], v2, s[12:15], s52 offen offset:2048 sc1
    v_mfma_f32_16x16x32_bf16 v[176:179], v[212:215], v[120:123], v[176:179]
    ds_read_b128 v[212:215], v21 offset:5120
    v_pk_mul_f32 v[160:161], v[160:161], v[162:163]
    v_pk_mul_f32 v[164:165], v[164:165], v[166:167]
    v_cvt_pk_bf16_f32 v139, v160, v161
    v_cvt_pk_bf16_f32 v143, v164, v165
    buffer_store_dwordx4 v[136:139], v7, s[12:15], s54 offen offset:0 sc1
    buffer_store_dwordx4 v[140:143], v7, s[12:15], s54 offen offset:1024 sc1
    v_mfma_f32_16x16x32_bf16 v[184:187], v[216:219], v[120:123], v[184:187]
    s_waitcnt lgkmcnt(5)
    buffer_load_dwordx4 v[116:119], v2, s[12:15], s52 offen offset:3072 sc1
    v_mfma_f32_16x16x32_bf16 v[188:191], v[216:219], v[124:127], v[188:191]
    ds_read_b128 v[216:219], v21 offset:6144
    v_pk_mul_f32 v[168:169], v[168:169], v[170:171]
    v_pk_mul_f32 v[172:173], v[172:173], v[174:175]
    v_cvt_pk_bf16_f32 v168, v168, v169
    v_cvt_pk_bf16_f32 v172, v172, v173
    v_pk_mul_f32 v[176:177], v[176:177], v[178:179]
    v_pk_mul_f32 v[180:181], v[180:181], v[182:183]
    v_cvt_pk_bf16_f32 v169, v176, v177
    v_cvt_pk_bf16_f32 v173, v180, v181
    s_nop 3
    v_pk_mul_f32 v[184:185], v[184:185], v[186:187]
    v_pk_mul_f32 v[188:189], v[188:189], v[190:191]
    v_cvt_pk_bf16_f32 v170, v184, v185
    v_cvt_pk_bf16_f32 v174, v188, v189
    v_mov_b32 v24, v170
    v_mov_b32 v25, v168
    v_mov_b32 v28, v174
    s_add_u32 s52, s30, 0xdc3000
    buffer_load_dwordx4 v[56:59], v2, s[12:15], s52 offen offset:0 sc1
    v_mov_b32 v29, v172
    s_nop 0
    v_permlane16_swap_b32 v24, v171
    v_permlane16_swap_b32 v25, v26
    v_permlane16_swap_b32 v28, v175
    v_permlane16_swap_b32 v29, v30
    s_nop 0
    v_mov_b32_dpp v26, v169 quad_perm:[0,1,2,3] row_mask:0x8 bank_mask:0xf
    v_mov_b32_dpp v30, v173 quad_perm:[0,1,2,3] row_mask:0x8 bank_mask:0xf
    s_nop 1
    v_permlane32_swap_b32 v26, v171
    v_permlane32_swap_b32 v30, v175
    buffer_load_dwordx4 v[60:63], v2, s[12:15], s52 offen offset:1024 sc1
    s_mov_b32 exec_hi, 0xffff
    buffer_store_dwordx4 v[168:171], v7, s[12:15], s54 offen offset:2048 sc1
    s_mov_b32 exec_hi, -1
    s_mov_b32 exec_hi, 0xffff
    buffer_store_dwordx4 v[172:175], v7, s[12:15], s54 offen offset:3072 sc1
    s_mov_b32 exec_hi, -1
    s_waitcnt vmcnt(16)
    v_mfma_f32_16x16x32_bf16 v[136:139], v[192:195], v[128:131], 0
    s_waitcnt lgkmcnt(5)
    v_mfma_f32_16x16x32_bf16 v[140:143], v[192:195], v[132:135], 0
    ds_read_b128 v[192:195], v21 offset:7168
    v_mfma_f32_16x16x32_bf16 v[148:151], v[196:199], v[132:135], 0
    s_waitcnt lgkmcnt(5)
    buffer_load_dwordx4 v[64:67], v2, s[12:15], s52 offen offset:2048 sc1
    v_mfma_f32_16x16x32_bf16 v[144:147], v[196:199], v[128:131], 0
    ds_read_b128 v[196:199], v21 offset:8192
    v_mfma_f32_16x16x32_bf16 v[152:155], v[200:203], v[128:131], 0
    s_waitcnt lgkmcnt(5)
    v_mfma_f32_16x16x32_bf16 v[156:159], v[200:203], v[132:135], 0
    ds_read_b128 v[200:203], v21 offset:9216
    v_mfma_f32_16x16x32_bf16 v[164:167], v[204:207], v[132:135], 0
    s_waitcnt lgkmcnt(5)
    buffer_load_dwordx4 v[68:71], v2, s[12:15], s52 offen offset:3072 sc1
    v_mfma_f32_16x16x32_bf16 v[160:163], v[204:207], v[128:131], 0
    ds_read_b128 v[204:207], v21 offset:10240
    v_mfma_f32_16x16x32_bf16 v[168:171], v[208:211], v[128:131], 0
    s_waitcnt lgkmcnt(5)
    v_mfma_f32_16x16x32_bf16 v[172:175], v[208:211], v[132:135], 0
    ds_read_b128 v[208:211], v21 offset:11264
    s_add_u32 s52, s30, 0xdc4000
    v_mfma_f32_16x16x32_bf16 v[180:183], v[212:215], v[132:135], 0
    s_waitcnt lgkmcnt(5)
    buffer_load_dwordx4 v[72:75], v2, s[12:15], s52 offen offset:0 sc1
    v_mfma_f32_16x16x32_bf16 v[176:179], v[212:215], v[128:131], 0
    ds_read_b128 v[212:215], v21 offset:12288
    v_mfma_f32_16x16x32_bf16 v[184:187], v[216:219], v[128:131], 0
    s_waitcnt lgkmcnt(5)
    buffer_load_dwordx4 v[76:79], v2, s[12:15], s52 offen offset:1024 sc1
    v_mfma_f32_16x16x32_bf16 v[188:191], v[216:219], v[132:135], 0
    ds_read_b128 v[216:219], v21 offset:13312
    s_waitcnt vmcnt(18)
    v_mfma_f32_16x16x32_bf16 v[136:139], v[192:195], v[80:83], v[136:139]
    s_waitcnt lgkmcnt(5)
    v_mfma_f32_16x16x32_bf16 v[140:143], v[192:195], v[84:87], v[140:143]
    ds_read_b128 v[192:195], v21 offset:14336
    v_mfma_f32_16x16x32_bf16 v[148:151], v[196:199], v[84:87], v[148:151]
    s_waitcnt lgkmcnt(5)
    buffer_load_dwordx4 v[120:123], v2, s[12:15], s52 offen offset:2048 sc1
    v_mfma_f32_16x16x32_bf16 v[144:147], v[196:199], v[80:83], v[144:147]
    ds_read_b128 v[196:199], v21 offset:15360
    v_mfma_f32_16x16x32_bf16 v[152:155], v[200:203], v[80:83], v[152:155]
    s_waitcnt lgkmcnt(5)
    v_mfma_f32_16x16x32_bf16 v[156:159], v[200:203], v[84:87], v[156:159]
    ds_read_b128 v[200:203], v21 offset:16384
    v_mfma_f32_16x16x32_bf16 v[164:167], v[204:207], v[84:87], v[164:167]
    s_waitcnt lgkmcnt(5)
    buffer_load_dwordx4 v[124:127], v2, s[12:15], s52 offen offset:3072 sc1
    v_mfma_f32_16x16x32_bf16 v[160:163], v[204:207], v[80:83], v[160:163]
    ds_read_b128 v[204:207], v21 offset:17408
    v_mfma_f32_16x16x32_bf16 v[168:171], v[208:211], v[80:83], v[168:171]
    s_waitcnt lgkmcnt(5)
    v_mfma_f32_16x16x32_bf16 v[172:175], v[208:211], v[84:87], v[172:175]
    ds_read_b128 v[208:211], v21 offset:18432
    s_add_u32 s52, s30, 0xdc5000
    v_mfma_f32_16x16x32_bf16 v[180:183], v[212:215], v[84:87], v[180:183]
    s_waitcnt lgkmcnt(5)
    buffer_load_dwordx4 v[128:131], v2, s[12:15], s52 offen offset:0 sc1
    v_mfma_f32_16x16x32_bf16 v[176:179], v[212:215], v[80:83], v[176:179]
    ds_read_b128 v[212:215], v21 offset:19456
    v_mfma_f32_16x16x32_bf16 v[184:187], v[216:219], v[80:83], v[184:187]
    s_waitcnt lgkmcnt(5)
    buffer_load_dwordx4 v[132:135], v2, s[12:15], s52 offen offset:1024 sc1
    v_mfma_f32_16x16x32_bf16 v[188:191], v[216:219], v[84:87], v[188:191]
    ds_read_b128 v[216:219], v21 offset:20480
    s_waitcnt vmcnt(20)
    v_mfma_f32_16x16x32_bf16 v[136:139], v[192:195], v[88:91], v[136:139]
    s_waitcnt lgkmcnt(5)
    v_mfma_f32_16x16x32_bf16 v[140:143], v[192:195], v[92:95], v[140:143]
    ds_read_b128 v[192:195], v21 offset:21504
    v_mfma_f32_16x16x32_bf16 v[148:151], v[196:199], v[92:95], v[148:151]
    s_waitcnt lgkmcnt(5)
    buffer_load_dwordx4 v[80:83], v2, s[12:15], s52 offen offset:2048 sc1
    v_mfma_f32_16x16x32_bf16 v[144:147], v[196:199], v[88:91], v[144:147]
    ds_read_b128 v[196:199], v21 offset:22528
    v_mfma_f32_16x16x32_bf16 v[152:155], v[200:203], v[88:91], v[152:155]
    s_waitcnt lgkmcnt(5)
    v_mfma_f32_16x16x32_bf16 v[156:159], v[200:203], v[92:95], v[156:159]
    ds_read_b128 v[200:203], v21 offset:23552
    v_mfma_f32_16x16x32_bf16 v[164:167], v[204:207], v[92:95], v[164:167]
    s_waitcnt lgkmcnt(5)
    buffer_load_dwordx4 v[84:87], v2, s[12:15], s52 offen offset:3072 sc1
    v_mfma_f32_16x16x32_bf16 v[160:163], v[204:207], v[88:91], v[160:163]
    ds_read_b128 v[204:207], v21 offset:24576
    v_mfma_f32_16x16x32_bf16 v[168:171], v[208:211], v[88:91], v[168:171]
    s_waitcnt lgkmcnt(5)
    v_mfma_f32_16x16x32_bf16 v[172:175], v[208:211], v[92:95], v[172:175]
    ds_read_b128 v[208:211], v21 offset:25600
    v_mfma_f32_16x16x32_bf16 v[180:183], v[212:215], v[92:95], v[180:183]
    s_waitcnt lgkmcnt(5)
    v_mfma_f32_16x16x32_bf16 v[176:179], v[212:215], v[88:91], v[176:179]
    ds_read_b128 v[212:215], v21 offset:26624
    v_mfma_f32_16x16x32_bf16 v[184:187], v[216:219], v[88:91], v[184:187]
    s_waitcnt lgkmcnt(5)
    v_mfma_f32_16x16x32_bf16 v[188:191], v[216:219], v[92:95], v[188:191]
    ds_read_b128 v[216:219], v21 offset:27648
    s_waitcnt vmcnt(20)
    v_mfma_f32_16x16x32_bf16 v[136:139], v[192:195], v[96:99], v[136:139]
    s_waitcnt lgkmcnt(5)
    v_mfma_f32_16x16x32_bf16 v[140:143], v[192:195], v[100:103], v[140:143]
    ds_read_b128 v[192:195], v21 offset:28672
    s_add_u32 s52, s30, 0xdc6000
    v_mfma_f32_16x16x32_bf16 v[148:151], v[196:199], v[100:103], v[148:151]
    s_waitcnt lgkmcnt(5)
    buffer_load_dwordx4 v[88:91], v2, s[12:15], s52 offen offset:0 sc1
    v_mfma_f32_16x16x32_bf16 v[144:147], v[196:199], v[96:99], v[144:147]
    ds_read_b128 v[196:199], v21 offset:29696
    v_mfma_f32_16x16x32_bf16 v[152:155], v[200:203], v[96:99], v[152:155]
    s_waitcnt lgkmcnt(5)
    v_mfma_f32_16x16x32_bf16 v[156:159], v[200:203], v[100:103], v[156:159]
    ds_read_b128 v[200:203], v21 offset:30720
    v_mfma_f32_16x16x32_bf16 v[164:167], v[204:207], v[100:103], v[164:167]
    s_waitcnt lgkmcnt(5)
    buffer_load_dwordx4 v[92:95], v2, s[12:15], s52 offen offset:1024 sc1
    v_mfma_f32_16x16x32_bf16 v[160:163], v[204:207], v[96:99], v[160:163]
    ds_read_b128 v[204:207], v21 offset:31744
    v_mfma_f32_16x16x32_bf16 v[168:171], v[208:211], v[96:99], v[168:171]
    s_waitcnt lgkmcnt(5)
    v_mfma_f32_16x16x32_bf16 v[172:175], v[208:211], v[100:103], v[172:175]
    ds_read_b128 v[208:211], v21 offset:32768
    v_mfma_f32_16x16x32_bf16 v[180:183], v[212:215], v[100:103], v[180:183]
    s_waitcnt lgkmcnt(5)
    v_mfma_f32_16x16x32_bf16 v[176:179], v[212:215], v[96:99], v[176:179]
    ds_read_b128 v[212:215], v21 offset:33792
    v_mfma_f32_16x16x32_bf16 v[184:187], v[216:219], v[96:99], v[184:187]
    s_waitcnt lgkmcnt(5)
    v_mfma_f32_16x16x32_bf16 v[188:191], v[216:219], v[100:103], v[188:191]
    ds_read_b128 v[216:219], v21 offset:34816
    s_waitcnt vmcnt(12)
    s_add_u32 s55, s46, 0x1750000
    s_mov_b64 exec, 1
    buffer_store_dword v19, v20, s[12:15], s55 offen sc1
    s_mov_b64 exec, -1
    v_mfma_f32_16x16x32_bf16 v[136:139], v[192:195], v[104:107], v[136:139]
    s_waitcnt lgkmcnt(5)
    v_mfma_f32_16x16x32_bf16 v[140:143], v[192:195], v[108:111], v[140:143]
    ds_read_b128 v[192:195], v21 offset:35840
    v_mfma_f32_16x16x32_bf16 v[148:151], v[196:199], v[108:111], v[148:151]
    s_waitcnt lgkmcnt(5)
    buffer_load_dwordx4 v[96:99], v2, s[12:15], s52 offen offset:2048 sc1
    v_mfma_f32_16x16x32_bf16 v[144:147], v[196:199], v[104:107], v[144:147]
    ds_read_b128 v[196:199], v21 offset:36864
    v_mfma_f32_16x16x32_bf16 v[152:155], v[200:203], v[104:107], v[152:155]
    s_waitcnt lgkmcnt(5)
    v_mfma_f32_16x16x32_bf16 v[156:159], v[200:203], v[108:111], v[156:159]
    ds_read_b128 v[200:203], v21 offset:37888
    v_mfma_f32_16x16x32_bf16 v[164:167], v[204:207], v[108:111], v[164:167]
    s_waitcnt lgkmcnt(5)
    buffer_load_dwordx4 v[100:103], v2, s[12:15], s52 offen offset:3072 sc1
    v_mfma_f32_16x16x32_bf16 v[160:163], v[204:207], v[104:107], v[160:163]
    ds_read_b128 v[204:207], v21 offset:38912
    v_mfma_f32_16x16x32_bf16 v[168:171], v[208:211], v[104:107], v[168:171]
    s_waitcnt lgkmcnt(5)
    v_mfma_f32_16x16x32_bf16 v[172:175], v[208:211], v[108:111], v[172:175]
    ds_read_b128 v[208:211], v21 offset:39936
    v_mfma_f32_16x16x32_bf16 v[180:183], v[212:215], v[108:111], v[180:183]
    s_waitcnt lgkmcnt(5)
    v_mfma_f32_16x16x32_bf16 v[176:179], v[212:215], v[104:107], v[176:179]
    ds_read_b128 v[212:215], v21 offset:40960
    v_mfma_f32_16x16x32_bf16 v[184:187], v[216:219], v[104:107], v[184:187]
    s_waitcnt lgkmcnt(5)
    v_mfma_f32_16x16x32_bf16 v[188:191], v[216:219], v[108:111], v[188:191]
    ds_read_b128 v[216:219], v21 offset:41984
    v_mfma_f32_16x16x32_bf16 v[136:139], v[192:195], v[112:115], v[136:139]
    s_waitcnt lgkmcnt(5)
    v_mfma_f32_16x16x32_bf16 v[140:143], v[192:195], v[116:119], v[140:143]
    ds_read_b128 v[192:195], v21 offset:43008
    s_add_u32 s52, s30, 0xdc7000
    v_mfma_f32_16x16x32_bf16 v[148:151], v[196:199], v[116:119], v[148:151]
    s_waitcnt lgkmcnt(5)
    buffer_load_dwordx4 v[104:107], v2, s[12:15], s52 offen offset:0 sc1
    v_mfma_f32_16x16x32_bf16 v[144:147], v[196:199], v[112:115], v[144:147]
    ds_read_b128 v[196:199], v21 offset:44032
    v_mfma_f32_16x16x32_bf16 v[152:155], v[200:203], v[112:115], v[152:155]
    s_waitcnt lgkmcnt(5)
    v_mfma_f32_16x16x32_bf16 v[156:159], v[200:203], v[116:119], v[156:159]
    ds_read_b128 v[200:203], v21 offset:45056
    v_mfma_f32_16x16x32_bf16 v[164:167], v[204:207], v[116:119], v[164:167]
    s_waitcnt lgkmcnt(5)
    buffer_load_dwordx4 v[108:111], v2, s[12:15], s52 offen offset:1024 sc1
    v_mfma_f32_16x16x32_bf16 v[160:163], v[204:207], v[112:115], v[160:163]
    ds_read_b128 v[204:207], v21 offset:46080
    v_mfma_f32_16x16x32_bf16 v[168:171], v[208:211], v[112:115], v[168:171]
    s_waitcnt lgkmcnt(5)
    v_mfma_f32_16x16x32_bf16 v[172:175], v[208:211], v[116:119], v[172:175]
    ds_read_b128 v[208:211], v21 offset:47104
    v_mfma_f32_16x16x32_bf16 v[180:183], v[212:215], v[116:119], v[180:183]
    s_waitcnt lgkmcnt(5)
    v_mfma_f32_16x16x32_bf16 v[176:179], v[212:215], v[112:115], v[176:179]
    ds_read_b128 v[212:215], v21 offset:48128
    v_mfma_f32_16x16x32_bf16 v[184:187], v[216:219], v[112:115], v[184:187]
    s_waitcnt lgkmcnt(5)
    v_mfma_f32_16x16x32_bf16 v[188:191], v[216:219], v[116:119], v[188:191]
    ds_read_b128 v[216:219], v21 offset:49152
    v_mfma_f32_16x16x32_bf16 v[136:139], v[192:195], v[56:59], v[136:139]
    s_waitcnt lgkmcnt(5)
    v_mfma_f32_16x16x32_bf16 v[140:143], v[192:195], v[60:63], v[140:143]
    ds_read_b128 v[192:195], v21 offset:50176
    v_mfma_f32_16x16x32_bf16 v[148:151], v[196:199], v[60:63], v[148:151]
    s_waitcnt lgkmcnt(5)
    buffer_load_dwordx4 v[112:115], v2, s[12:15], s52 offen offset:2048 sc1
    v_mfma_f32_16x16x32_bf16 v[144:147], v[196:199], v[56:59], v[144:147]
    ds_read_b128 v[196:199], v21 offset:51200
    v_mfma_f32_16x16x32_bf16 v[152:155], v[200:203], v[56:59], v[152:155]
    s_waitcnt lgkmcnt(5)
    v_mfma_f32_16x16x32_bf16 v[156:159], v[200:203], v[60:63], v[156:159]
    ds_read_b128 v[200:203], v21 offset:52224
    v_mfma_f32_16x16x32_bf16 v[164:167], v[204:207], v[60:63], v[164:167]
    s_waitcnt lgkmcnt(5)
    buffer_load_dwordx4 v[116:119], v2, s[12:15], s52 offen offset:3072 sc1
    v_mfma_f32_16x16x32_bf16 v[160:163], v[204:207], v[56:59], v[160:163]
    ds_read_b128 v[204:207], v21 offset:53248
    v_mfma_f32_16x16x32_bf16 v[168:171], v[208:211], v[56:59], v[168:171]
    s_waitcnt lgkmcnt(5)
    v_mfma_f32_16x16x32_bf16 v[172:175], v[208:211], v[60:63], v[172:175]
    ds_read_b128 v[208:211], v21 offset:54272
    v_mfma_f32_16x16x32_bf16 v[180:183], v[212:215], v[60:63], v[180:183]
    s_waitcnt lgkmcnt(5)
    v_mfma_f32_16x16x32_bf16 v[176:179], v[212:215], v[56:59], v[176:179]
    ds_read_b128 v[212:215], v21 offset:55296
    v_mfma_f32_16x16x32_bf16 v[184:187], v[216:219], v[56:59], v[184:187]
    s_waitcnt lgkmcnt(5)
    v_mfma_f32_16x16x32_bf16 v[188:191], v[216:219], v[60:63], v[188:191]
    ds_read_b128 v[216:219], v21 offset:56320
    s_waitcnt vmcnt(17)
    v_mfma_f32_16x16x32_bf16 v[136:139], v[192:195], v[64:67], v[136:139]
    s_waitcnt lgkmcnt(5)
    v_mfma_f32_16x16x32_bf16 v[140:143], v[192:195], v[68:71], v[140:143]
    ds_read_b128 v[192:195], v21 offset:57344
    s_add_u32 s52, s30, 0xdc8000
    v_mfma_f32_16x16x32_bf16 v[148:151], v[196:199], v[68:71], v[148:151]
    s_waitcnt lgkmcnt(5)
    buffer_load_dwordx4 v[56:59], v2, s[12:15], s52 offen offset:0 sc1
    v_mfma_f32_16x16x32_bf16 v[144:147], v[196:199], v[64:67], v[144:147]
    ds_read_b128 v[196:199], v21 offset:58368
    v_mfma_f32_16x16x32_bf16 v[152:155], v[200:203], v[64:67], v[152:155]
    s_waitcnt lgkmcnt(5)
    v_mfma_f32_16x16x32_bf16 v[156:159], v[200:203], v[68:71], v[156:159]
    ds_read_b128 v[200:203], v21 offset:59392
    v_mfma_f32_16x16x32_bf16 v[164:167], v[204:207], v[68:71], v[164:167]
    s_waitcnt lgkmcnt(5)
    buffer_load_dwordx4 v[60:63], v2, s[12:15], s52 offen offset:1024 sc1
    v_mfma_f32_16x16x32_bf16 v[160:163], v[204:207], v[64:67], v[160:163]
    ds_read_b128 v[204:207], v21 offset:60416
    v_mfma_f32_16x16x32_bf16 v[168:171], v[208:211], v[64:67], v[168:171]
    s_waitcnt lgkmcnt(5)
    v_mfma_f32_16x16x32_bf16 v[172:175], v[208:211], v[68:71], v[172:175]
    ds_read_b128 v[208:211], v21 offset:61440
    v_mfma_f32_16x16x32_bf16 v[180:183], v[212:215], v[68:71], v[180:183]
    s_waitcnt lgkmcnt(5)
    v_mfma_f32_16x16x32_bf16 v[176:179], v[212:215], v[64:67], v[176:179]
    ds_read_b128 v[212:215], v21 offset:62464
    v_mfma_f32_16x16x32_bf16 v[184:187], v[216:219], v[64:67], v[184:187]
    s_waitcnt lgkmcnt(5)
    v_mfma_f32_16x16x32_bf16 v[188:191], v[216:219], v[68:71], v[188:191]
    ds_read_b128 v[216:219], v21 offset:63488
    s_waitcnt vmcnt(17)
    v_mfma_f32_16x16x32_bf16 v[136:139], v[192:195], v[72:75], v[136:139]
    s_waitcnt lgkmcnt(5)
    v_mfma_f32_16x16x32_bf16 v[140:143], v[192:195], v[76:79], v[140:143]
    ds_read_b128 v[192:195], v21 offset:64512
    v_mfma_f32_16x16x32_bf16 v[148:151], v[196:199], v[76:79], v[148:151]
    s_waitcnt lgkmcnt(5)
    buffer_load_dwordx4 v[64:67], v2, s[12:15], s52 offen offset:2048 sc1
    v_mfma_f32_16x16x32_bf16 v[144:147], v[196:199], v[72:75], v[144:147]
    ds_read_b128 v[196:199], v3 offset:0
    v_mfma_f32_16x16x32_bf16 v[152:155], v[200:203], v[72:75], v[152:155]
    s_waitcnt lgkmcnt(5)
    v_mfma_f32_16x16x32_bf16 v[156:159], v[200:203], v[76:79], v[156:159]
    ds_read_b128 v[200:203], v3 offset:1024
    v_mfma_f32_16x16x32_bf16 v[164:167], v[204:207], v[76:79], v[164:167]
    s_waitcnt lgkmcnt(5)
    buffer_load_dwordx4 v[68:71], v2, s[12:15], s52 offen offset:3072 sc1
    v_mfma_f32_16x16x32_bf16 v[160:163], v[204:207], v[72:75], v[160:163]
    ds_read_b128 v[204:207], v3 offset:2048
    v_mfma_f32_16x16x32_bf16 v[168:171], v[208:211], v[72:75], v[168:171]
    s_waitcnt lgkmcnt(5)
    v_mfma_f32_16x16x32_bf16 v[172:175], v[208:211], v[76:79], v[172:175]
    ds_read_b128 v[208:211], v3 offset:3072
    v_mfma_f32_16x16x32_bf16 v[180:183], v[212:215], v[76:79], v[180:183]
    s_waitcnt lgkmcnt(5)
    v_mfma_f32_16x16x32_bf16 v[176:179], v[212:215], v[72:75], v[176:179]
    ds_read_b128 v[212:215], v3 offset:4096
    v_mfma_f32_16x16x32_bf16 v[184:187], v[216:219], v[72:75], v[184:187]
    s_waitcnt lgkmcnt(5)
    v_mfma_f32_16x16x32_bf16 v[188:191], v[216:219], v[76:79], v[188:191]
    ds_read_b128 v[216:219], v3 offset:5120
    s_waitcnt vmcnt(17)
    v_mfma_f32_16x16x32_bf16 v[136:139], v[192:195], v[120:123], v[136:139]
    s_waitcnt lgkmcnt(5)
    v_mfma_f32_16x16x32_bf16 v[140:143], v[192:195], v[124:127], v[140:143]
    ds_read_b128 v[192:195], v3 offset:6144
    s_add_u32 s52, s30, 0xdc9000
    v_mfma_f32_16x16x32_bf16 v[148:151], v[196:199], v[124:127], v[148:151]
    s_waitcnt lgkmcnt(5)
    buffer_load_dwordx4 v[72:75], v2, s[12:15], s52 offen offset:0 sc1
    v_mfma_f32_16x16x32_bf16 v[144:147], v[196:199], v[120:123], v[144:147]
    ds_read_b128 v[196:199], v3 offset:7168
    v_mfma_f32_16x16x32_bf16 v[152:155], v[200:203], v[120:123], v[152:155]
    s_waitcnt lgkmcnt(5)
    v_mfma_f32_16x16x32_bf16 v[156:159], v[200:203], v[124:127], v[156:159]
    ds_read_b128 v[200:203], v3 offset:8192
    v_mfma_f32_16x16x32_bf16 v[164:167], v[204:207], v[124:127], v[164:167]
    s_waitcnt lgkmcnt(5)
    buffer_load_dwordx4 v[76:79], v2, s[12:15], s52 offen offset:1024 sc1
    v_mfma_f32_16x16x32_bf16 v[160:163], v[204:207], v[120:123], v[160:163]
    ds_read_b128 v[204:207], v3 offset:9216
    v_mfma_f32_16x16x32_bf16 v[168:171], v[208:211], v[120:123], v[168:171]
    s_waitcnt lgkmcnt(5)
    v_mfma_f32_16x16x32_bf16 v[172:175], v[208:211], v[124:127], v[172:175]
    ds_read_b128 v[208:211], v3 offset:10240
    v_mfma_f32_16x16x32_bf16 v[180:183], v[212:215], v[124:127], v[180:183]
    s_waitcnt lgkmcnt(5)
    v_mfma_f32_16x16x32_bf16 v[176:179], v[212:215], v[120:123], v[176:179]
    ds_read_b128 v[212:215], v3 offset:11264
    v_mfma_f32_16x16x32_bf16 v[184:187], v[216:219], v[120:123], v[184:187]
    s_waitcnt lgkmcnt(5)
    v_mfma_f32_16x16x32_bf16 v[188:191], v[216:219], v[124:127], v[188:191]
    ds_read_b128 v[216:219], v3 offset:12288
    s_add_u32 s55, s44, 0x1750000
    buffer_load_dword v18, v13, s[12:15], s55 offen sc1
    s_waitcnt vmcnt(18)
    v_mfma_f32_16x16x32_bf16 v[136:139], v[192:195], v[128:131], v[136:139]
    s_waitcnt lgkmcnt(5)
    v_mfma_f32_16x16x32_bf16 v[140:143], v[192:195], v[132:135], v[140:143]
    ds_read_b128 v[192:195], v3 offset:13312
    v_mfma_f32_16x16x32_bf16 v[148:151], v[196:199], v[132:135], v[148:151]
    s_waitcnt lgkmcnt(5)
    buffer_load_dwordx4 v[120:123], v2, s[12:15], s52 offen offset:2048 sc1
    v_mfma_f32_16x16x32_bf16 v[144:147], v[196:199], v[128:131], v[144:147]
    ds_read_b128 v[196:199], v3 offset:14336
    v_mfma_f32_16x16x32_bf16 v[152:155], v[200:203], v[128:131], v[152:155]
    s_waitcnt lgkmcnt(5)
    v_mfma_f32_16x16x32_bf16 v[156:159], v[200:203], v[132:135], v[156:159]
    ds_read_b128 v[200:203], v3 offset:15360
    v_mfma_f32_16x16x32_bf16 v[164:167], v[204:207], v[132:135], v[164:167]
    s_waitcnt lgkmcnt(5)
    buffer_load_dwordx4 v[124:127], v2, s[12:15], s52 offen offset:3072 sc1
    v_mfma_f32_16x16x32_bf16 v[160:163], v[204:207], v[128:131], v[160:163]
    ds_read_b128 v[204:207], v3 offset:16384
    v_mfma_f32_16x16x32_bf16 v[168:171], v[208:211], v[128:131], v[168:171]
    s_waitcnt lgkmcnt(5)
    v_mfma_f32_16x16x32_bf16 v[172:175], v[208:211], v[132:135], v[172:175]
    ds_read_b128 v[208:211], v3 offset:17408
    v_mfma_f32_16x16x32_bf16 v[180:183], v[212:215], v[132:135], v[180:183]
    s_waitcnt lgkmcnt(5)
    v_mfma_f32_16x16x32_bf16 v[176:179], v[212:215], v[128:131], v[176:179]
    ds_read_b128 v[212:215], v3 offset:18432
    v_mfma_f32_16x16x32_bf16 v[184:187], v[216:219], v[128:131], v[184:187]
    s_waitcnt lgkmcnt(5)
    v_mfma_f32_16x16x32_bf16 v[188:191], v[216:219], v[132:135], v[188:191]
    ds_read_b128 v[216:219], v3 offset:19456
    s_waitcnt vmcnt(18)
    v_mfma_f32_16x16x32_bf16 v[136:139], v[192:195], v[80:83], v[136:139]
    s_waitcnt lgkmcnt(5)
    v_mfma_f32_16x16x32_bf16 v[140:143], v[192:195], v[84:87], v[140:143]
    ds_read_b128 v[192:195], v3 offset:20480
    v_mfma_f32_16x16x32_bf16 v[148:151], v[196:199], v[84:87], v[148:151]
    s_waitcnt lgkmcnt(5)
    v_mfma_f32_16x16x32_bf16 v[144:147], v[196:199], v[80:83], v[144:147]
    ds_read_b128 v[196:199], v3 offset:21504
    v_mfma_f32_16x16x32_bf16 v[152:155], v[200:203], v[80:83], v[152:155]
    s_waitcnt lgkmcnt(5)
    v_mfma_f32_16x16x32_bf16 v[156:159], v[200:203], v[84:87], v[156:159]
    ds_read_b128 v[200:203], v3 offset:22528
    v_mfma_f32_16x16x32_bf16 v[164:167], v[204:207], v[84:87], v[164:167]
    s_waitcnt lgkmcnt(5)
    v_mfma_f32_16x16x32_bf16 v[160:163], v[204:207], v[80:83], v[160:163]
    ds_read_b128 v[204:207], v3 offset:23552
    v_mfma_f32_16x16x32_bf16 v[168:171], v[208:211], v[80:83], v[168:171]
    s_waitcnt lgkmcnt(5)
    v_mfma_f32_16x16x32_bf16 v[172:175], v[208:211], v[84:87], v[172:175]
    ds_read_b128 v[208:211], v3 offset:24576
    v_mfma_f32_16x16x32_bf16 v[180:183], v[212:215], v[84:87], v[180:183]
    s_waitcnt lgkmcnt(5)
    v_mfma_f32_16x16x32_bf16 v[176:179], v[212:215], v[80:83], v[176:179]
    ds_read_b128 v[212:215], v3 offset:25600
    v_mfma_f32_16x16x32_bf16 v[184:187], v[216:219], v[80:83], v[184:187]
    s_waitcnt lgkmcnt(5)
    v_mfma_f32_16x16x32_bf16 v[188:191], v[216:219], v[84:87], v[188:191]
    ds_read_b128 v[216:219], v3 offset:26624
    s_waitcnt vmcnt(16)
    v_mfma_f32_16x16x32_bf16 v[136:139], v[192:195], v[88:91], v[136:139]
    s_waitcnt lgkmcnt(5)
    v_mfma_f32_16x16x32_bf16 v[140:143], v[192:195], v[92:95], v[140:143]
    ds_read_b128 v[192:195], v3 offset:27648
    v_mfma_f32_16x16x32_bf16 v[148:151], v[196:199], v[92:95], v[148:151]
    s_waitcnt lgkmcnt(5)
    v_mfma_f32_16x16x32_bf16 v[144:147], v[196:199], v[88:91], v[144:147]
    ds_read_b128 v[196:199], v3 offset:28672
    v_mfma_f32_16x16x32_bf16 v[152:155], v[200:203], v[88:91], v[152:155]
    s_waitcnt lgkmcnt(5)
    v_mfma_f32_16x16x32_bf16 v[156:159], v[200:203], v[92:95], v[156:159]
    ds_read_b128 v[200:203], v3 offset:29696
    v_mfma_f32_16x16x32_bf16 v[164:167], v[204:207], v[92:95], v[164:167]
    s_waitcnt lgkmcnt(5)
    v_mfma_f32_16x16x32_bf16 v[160:163], v[204:207], v[88:91], v[160:163]
    ds_read_b128 v[204:207], v3 offset:30720
    v_mfma_f32_16x16x32_bf16 v[168:171], v[208:211], v[88:91], v[168:171]
    s_waitcnt lgkmcnt(5)
    v_mfma_f32_16x16x32_bf16 v[172:175], v[208:211], v[92:95], v[172:175]
    ds_read_b128 v[208:211], v3 offset:31744
    v_mfma_f32_16x16x32_bf16 v[180:183], v[212:215], v[92:95], v[180:183]
    s_waitcnt lgkmcnt(5)
    v_mfma_f32_16x16x32_bf16 v[176:179], v[212:215], v[88:91], v[176:179]
    ds_read_b128 v[212:215], v3 offset:32768
    v_mfma_f32_16x16x32_bf16 v[184:187], v[216:219], v[88:91], v[184:187]
    s_waitcnt lgkmcnt(5)
    v_mfma_f32_16x16x32_bf16 v[188:191], v[216:219], v[92:95], v[188:191]
    ds_read_b128 v[216:219], v3 offset:33792
    s_waitcnt vmcnt(13)
    v_mfma_f32_16x16x32_bf16 v[136:139], v[192:195], v[96:99], v[136:139]
    s_waitcnt lgkmcnt(5)
    v_mfma_f32_16x16x32_bf16 v[140:143], v[192:195], v[100:103], v[140:143]
    ds_read_b128 v[192:195], v3 offset:34816
    v_mfma_f32_16x16x32_bf16 v[148:151], v[196:199], v[100:103], v[148:151]
    s_waitcnt lgkmcnt(5)
    v_mfma_f32_16x16x32_bf16 v[144:147], v[196:199], v[96:99], v[144:147]
    ds_read_b128 v[196:199], v3 offset:35840
    v_mfma_f32_16x16x32_bf16 v[152:155], v[200:203], v[96:99], v[152:155]
    s_waitcnt lgkmcnt(5)
    v_mfma_f32_16x16x32_bf16 v[156:159], v[200:203], v[100:103], v[156:159]
    ds_read_b128 v[200:203], v3 offset:36864
    v_mfma_f32_16x16x32_bf16 v[164:167], v[204:207], v[100:103], v[164:167]
    s_waitcnt lgkmcnt(5)
    v_mfma_f32_16x16x32_bf16 v[160:163], v[204:207], v[96:99], v[160:163]
    ds_read_b128 v[204:207], v3 offset:37888
    v_mfma_f32_16x16x32_bf16 v[168:171], v[208:211], v[96:99], v[168:171]
    s_waitcnt lgkmcnt(5)
    v_mfma_f32_16x16x32_bf16 v[172:175], v[208:211], v[100:103], v[172:175]
    ds_read_b128 v[208:211], v3 offset:38912
    v_mfma_f32_16x16x32_bf16 v[180:183], v[212:215], v[100:103], v[180:183]
    s_waitcnt lgkmcnt(5)
    v_mfma_f32_16x16x32_bf16 v[176:179], v[212:215], v[96:99], v[176:179]
    ds_read_b128 v[212:215], v3 offset:39936
    v_mfma_f32_16x16x32_bf16 v[184:187], v[216:219], v[96:99], v[184:187]
    s_waitcnt lgkmcnt(5)
    v_mfma_f32_16x16x32_bf16 v[188:191], v[216:219], v[100:103], v[188:191]
    ds_read_b128 v[216:219], v3 offset:40960
    s_waitcnt vmcnt(2)
L_chk_54:
    v_cmp_ne_u32 vcc, v19, v18
    s_cbranch_vccz L_ok_55
    s_cmp_eq_u32 s50, 0
    s_cbranch_scc1 L_ok_55
    s_sub_u32 s50, s50, 1
    s_sleep 1
    s_mov_b64 exec, vcc
    s_add_u32 s55, s44, 0x1750000
    buffer_load_dword v18, v13, s[12:15], s55 offen sc1
    s_mov_b64 exec, -1
    s_waitcnt vmcnt(0)
    s_branch L_chk_54
L_ok_55:
    v_mfma_f32_16x16x32_bf16 v[136:139], v[192:195], v[104:107], v[136:139]
    s_waitcnt lgkmcnt(5)
    v_mfma_f32_16x16x32_bf16 v[140:143], v[192:195], v[108:111], v[140:143]
    ds_read_b128 v[192:195], v3 offset:41984
    s_add_u32 s52, s64, 0x1ed0000
    v_mfma_f32_16x16x32_bf16 v[148:151], v[196:199], v[108:111], v[148:151]
    s_waitcnt lgkmcnt(5)
    buffer_load_dwordx4 v[128:131], v6, s[12:15], s52 offen sc1
    v_mfma_f32_16x16x32_bf16 v[144:147], v[196:199], v[104:107], v[144:147]
    ds_read_b128 v[196:199], v3 offset:43008
    v_mfma_f32_16x16x32_bf16 v[152:155], v[200:203], v[104:107], v[152:155]
    s_waitcnt lgkmcnt(5)
    v_mfma_f32_16x16x32_bf16 v[156:159], v[200:203], v[108:111], v[156:159]
    ds_read_b128 v[200:203], v3 offset:44032
    v_mfma_f32_16x16x32_bf16 v[164:167], v[204:207], v[108:111], v[164:167]
    s_waitcnt lgkmcnt(5)
    buffer_load_dwordx4 v[132:135], v6, s[12:15], s52 offen offset:2048 sc1
    v_mfma_f32_16x16x32_bf16 v[160:163], v[204:207], v[104:107], v[160:163]
    ds_read_b128 v[204:207], v3 offset:45056
    v_mfma_f32_16x16x32_bf16 v[168:171], v[208:211], v[104:107], v[168:171]
    s_waitcnt lgkmcnt(5)
    v_mfma_f32_16x16x32_bf16 v[172:175], v[208:211], v[108:111], v[172:175]
    ds_read_b128 v[208:211], v3 offset:46080
    s_add_u32 s52, s65, 0x1ed0000
    v_mfma_f32_16x16x32_bf16 v[180:183], v[212:215], v[108:111], v[180:183]
    s_waitcnt lgkmcnt(5)
    buffer_load_dwordx4 v[80:83], v6, s[12:15], s52 offen sc1
    v_mfma_f32_16x16x32_bf16 v[176:179], v[212:215], v[104:107], v[176:179]
    ds_read_b128 v[212:215], v3 offset:47104
    v_mfma_f32_16x16x32_bf16 v[184:187], v[216:219], v[104:107], v[184:187]
    s_waitcnt lgkmcnt(5)
    buffer_load_dwordx4 v[84:87], v6, s[12:15], s52 offen offset:2048 sc1
    v_mfma_f32_16x16x32_bf16 v[188:191], v[216:219], v[108:111], v[188:191]
    ds_read_b128 v[216:219], v3 offset:48128
    v_mfma_f32_16x16x32_bf16 v[136:139], v[192:195], v[112:115], v[136:139]
    s_waitcnt lgkmcnt(5)
    v_mfma_f32_16x16x32_bf16 v[140:143], v[192:195], v[116:119], v[140:143]
    ds_read_b128 v[192:195], v3 offset:49152
    s_add_u32 s52, s66, 0x1ed0000
    v_mfma_f32_16x16x32_bf16 v[148:151], v[196:199], v[116:119], v[148:151]
    s_waitcnt lgkmcnt(5)
    buffer_load_dwordx4 v[88:91], v6, s[12:15], s52 offen sc1
    v_mfma_f32_16x16x32_bf16 v[144:147], v[196:199], v[112:115], v[144:147]
    ds_read_b128 v[196:199], v3 offset:50176
    v_mfma_f32_16x16x32_bf16 v[152:155], v[200:203], v[112:115], v[152:155]
    s_waitcnt lgkmcnt(5)
    v_mfma_f32_16x16x32_bf16 v[156:159], v[200:203], v[116:119], v[156:159]
    ds_read_b128 v[200:203], v3 offset:51200
    v_mfma_f32_16x16x32_bf16 v[164:167], v[204:207], v[116:119], v[164:167]
    s_waitcnt lgkmcnt(5)
    buffer_load_dwordx4 v[92:95], v6, s[12:15], s52 offen offset:2048 sc1
    v_mfma_f32_16x16x32_bf16 v[160:163], v[204:207], v[112:115], v[160:163]
    ds_read_b128 v[204:207], v3 offset:52224
    v_mfma_f32_16x16x32_bf16 v[168:171], v[208:211], v[112:115], v[168:171]
    s_waitcnt lgkmcnt(5)
    v_mfma_f32_16x16x32_bf16 v[172:175], v[208:211], v[116:119], v[172:175]
    ds_read_b128 v[208:211], v3 offset:53248
    s_add_u32 s52, s67, 0x1ed0000
    v_mfma_f32_16x16x32_bf16 v[180:183], v[212:215], v[116:119], v[180:183]
    s_waitcnt lgkmcnt(5)
    buffer_load_dwordx4 v[96:99], v6, s[12:15], s52 offen sc1
    v_mfma_f32_16x16x32_bf16 v[176:179], v[212:215], v[112:115], v[176:179]
    ds_read_b128 v[212:215], v3 offset:54272
    v_mfma_f32_16x16x32_bf16 v[184:187], v[216:219], v[112:115], v[184:187]
    s_waitcnt lgkmcnt(5)
    buffer_load_dwordx4 v[100:103], v6, s[12:15], s52 offen offset:2048 sc1
    v_mfma_f32_16x16x32_bf16 v[188:191], v[216:219], v[116:119], v[188:191]
    ds_read_b128 v[216:219], v3 offset:55296
    v_mfma_f32_16x16x32_bf16 v[136:139], v[192:195], v[56:59], v[136:139]
    s_waitcnt lgkmcnt(5)
    v_mfma_f32_16x16x32_bf16 v[140:143], v[192:195], v[60:63], v[140:143]
    ds_read_b128 v[192:195], v3 offset:56320
    s_add_u32 s52, s68, 0x1ed0000
    v_mfma_f32_16x16x32_bf16 v[148:151], v[196:199], v[60:63], v[148:151]
    s_waitcnt lgkmcnt(5)
    buffer_load_dwordx4 v[104:107], v6, s[12:15], s52 offen sc1
    v_mfma_f32_16x16x32_bf16 v[144:147], v[196:199], v[56:59], v[144:147]
    ds_read_b128 v[196:199], v3 offset:57344
    v_mfma_f32_16x16x32_bf16 v[152:155], v[200:203], v[56:59], v[152:155]
    s_waitcnt lgkmcnt(5)
    v_mfma_f32_16x16x32_bf16 v[156:159], v[200:203], v[60:63], v[156:159]
    ds_read_b128 v[200:203], v3 offset:58368
    v_mfma_f32_16x16x32_bf16 v[164:167], v[204:207], v[60:63], v[164:167]
    s_waitcnt lgkmcnt(5)
    buffer_load_dwordx4 v[108:111], v6, s[12:15], s52 offen offset:2048 sc1
    v_mfma_f32_16x16x32_bf16 v[160:163], v[204:207], v[56:59], v[160:163]
    ds_read_b128 v[204:207], v3 offset:59392
    v_mfma_f32_16x16x32_bf16 v[168:171], v[208:211], v[56:59], v[168:171]
    s_waitcnt lgkmcnt(5)
    v_mfma_f32_16x16x32_bf16 v[172:175], v[208:211], v[60:63], v[172:175]
    ds_read_b128 v[208:211], v3 offset:60416
    s_add_u32 s52, s69, 0x1ed0000
    v_mfma_f32_16x16x32_bf16 v[180:183], v[212:215], v[60:63], v[180:183]
    s_waitcnt lgkmcnt(5)
    buffer_load_dwordx4 v[112:115], v6, s[12:15], s52 offen sc1
    v_mfma_f32_16x16x32_bf16 v[176:179], v[212:215], v[56:59], v[176:179]
    ds_read_b128 v[212:215], v3 offset:61440
    v_mfma_f32_16x16x32_bf16 v[184:187], v[216:219], v[56:59], v[184:187]
    s_waitcnt lgkmcnt(5)
    buffer_load_dwordx4 v[116:119], v6, s[12:15], s52 offen offset:2048 sc1
    v_mfma_f32_16x16x32_bf16 v[188:191], v[216:219], v[60:63], v[188:191]
    ds_read_b128 v[216:219], v3 offset:62464
    v_mfma_f32_16x16x32_bf16 v[136:139], v[192:195], v[64:67], v[136:139]
    s_waitcnt lgkmcnt(5)
    v_mfma_f32_16x16x32_bf16 v[140:143], v[192:195], v[68:71], v[140:143]
    ds_read_b128 v[192:195], v3 offset:63488
    s_add_u32 s52, s70, 0x1ed0000
    v_mfma_f32_16x16x32_bf16 v[148:151], v[196:199], v[68:71], v[148:151]
    s_waitcnt lgkmcnt(5)
    buffer_load_dwordx4 v[56:59], v6, s[12:15], s52 offen sc1
    v_mfma_f32_16x16x32_bf16 v[144:147], v[196:199], v[64:67], v[144:147]
    ds_read_b128 v[196:199], v3 offset:64512
    v_mfma_f32_16x16x32_bf16 v[152:155], v[200:203], v[64:67], v[152:155]
    s_waitcnt lgkmcnt(5)
    v_mfma_f32_16x16x32_bf16 v[156:159], v[200:203], v[68:71], v[156:159]
    ds_read_b128 v[200:203], v4 offset:0
    v_mfma_f32_16x16x32_bf16 v[164:167], v[204:207], v[68:71], v[164:167]
    s_waitcnt lgkmcnt(5)
    buffer_load_dwordx4 v[60:63], v6, s[12:15], s52 offen offset:2048 sc1
    v_mfma_f32_16x16x32_bf16 v[160:163], v[204:207], v[64:67], v[160:163]
    ds_read_b128 v[204:207], v4 offset:1024
    v_mfma_f32_16x16x32_bf16 v[168:171], v[208:211], v[64:67], v[168:171]
    s_waitcnt lgkmcnt(5)
    v_mfma_f32_16x16x32_bf16 v[172:175], v[208:211], v[68:71], v[172:175]
    ds_read_b128 v[208:211], v4 offset:2048
    v_mfma_f32_16x16x32_bf16 v[180:183], v[212:215], v[68:71], v[180:183]
    s_waitcnt lgkmcnt(5)
    v_mfma_f32_16x16x32_bf16 v[176:179], v[212:215], v[64:67], v[176:179]
    ds_read_b128 v[212:215], v4 offset:3072
    v_mfma_f32_16x16x32_bf16 v[184:187], v[216:219], v[64:67], v[184:187]
    s_waitcnt lgkmcnt(5)
    v_mfma_f32_16x16x32_bf16 v[188:191], v[216:219], v[68:71], v[188:191]
    ds_read_b128 v[216:219], v4 offset:4096
    v_mfma_f32_16x16x32_bf16 v[136:139], v[192:195], v[72:75], v[136:139]
    s_waitcnt lgkmcnt(5)
    v_mfma_f32_16x16x32_bf16 v[140:143], v[192:195], v[76:79], v[140:143]
    ds_read_b128 v[192:195], v4 offset:5120
    s_add_u32 s52, s64, 0x1ed0000
    v_mfma_f32_16x16x32_bf16 v[148:151], v[196:199], v[76:79], v[148:151]
    s_waitcnt lgkmcnt(5)
    buffer_load_dwordx4 v[64:67], v5, s[12:15], s52 offen sc1
    v_mfma_f32_16x16x32_bf16 v[144:147], v[196:199], v[72:75], v[144:147]
    ds_read_b128 v[196:199], v4 offset:6144
    v_mfma_f32_16x16x32_bf16 v[152:155], v[200:203], v[72:75], v[152:155]
    s_waitcnt lgkmcnt(5)
    v_mfma_f32_16x16x32_bf16 v[156:159], v[200:203], v[76:79], v[156:159]
    ds_read_b128 v[200:203], v4 offset:7168
    v_mfma_f32_16x16x32_bf16 v[164:167], v[204:207], v[76:79], v[164:167]
    s_waitcnt lgkmcnt(5)
    buffer_load_dwordx4 v[68:71], v5, s[12:15], s52 offen offset:2048 sc1
    v_mfma_f32_16x16x32_bf16 v[160:163], v[204:207], v[72:75], v[160:163]
    ds_read_b128 v[204:207], v4 offset:8192
    v_mfma_f32_16x16x32_bf16 v[168:171], v[208:211], v[72:75], v[168:171]
    s_waitcnt lgkmcnt(5)
    v_mfma_f32_16x16x32_bf16 v[172:175], v[208:211], v[76:79], v[172:175]
    ds_read_b128 v[208:211], v4 offset:9216
    v_mfma_f32_16x16x32_bf16 v[180:183], v[212:215], v[76:79], v[180:183]
    s_waitcnt lgkmcnt(5)
    v_mfma_f32_16x16x32_bf16 v[176:179], v[212:215], v[72:75], v[176:179]
    ds_read_b128 v[212:215], v4 offset:10240
    v_mfma_f32_16x16x32_bf16 v[184:187], v[216:219], v[72:75], v[184:187]
    s_waitcnt lgkmcnt(5)
    v_mfma_f32_16x16x32_bf16 v[188:191], v[216:219], v[76:79], v[188:191]
    ds_read_b128 v[216:219], v4 offset:11264
    s_waitcnt vmcnt(16)
    v_mfma_f32_16x16x32_bf16 v[136:139], v[192:195], v[120:123], v[136:139]
    s_waitcnt lgkmcnt(5)
    v_mfma_f32_16x16x32_bf16 v[140:143], v[192:195], v[124:127], v[140:143]
    s_add_u32 s52, s65, 0x1ed0000
    v_mfma_f32_16x16x32_bf16 v[148:151], v[196:199], v[124:127], v[148:151]
    s_waitcnt lgkmcnt(4)
    buffer_load_dwordx4 v[72:75], v5, s[12:15], s52 offen sc1
    v_mfma_f32_16x16x32_bf16 v[144:147], v[196:199], v[120:123], v[144:147]
    v_mfma_f32_16x16x32_bf16 v[152:155], v[200:203], v[120:123], v[152:155]
    s_waitcnt lgkmcnt(3)
    v_mfma_f32_16x16x32_bf16 v[156:159], v[200:203], v[124:127], v[156:159]
    s_add_u32 s54, s34, 0x2250000
    v_pk_mul_f32 v[136:137], v[136:137], v[138:139]
    v_pk_mul_f32 v[140:141], v[140:141], v[142:143]
    v_cvt_pk_bf16_f32 v136, v136, v137
    v_cvt_pk_bf16_f32 v140, v140, v141
    v_mfma_f32_16x16x32_bf16 v[164:167], v[204:207], v[124:127], v[164:167]
    s_waitcnt lgkmcnt(2)
    buffer_load_dwordx4 v[76:79], v5, s[12:15], s52 offen offset:2048 sc1
    v_mfma_f32_16x16x32_bf16 v[160:163], v[204:207], v[120:123], v[160:163]
    v_pk_mul_f32 v[144:145], v[144:145], v[146:147]
    v_pk_mul_f32 v[148:149], v[148:149], v[150:151]
    v_cvt_pk_bf16_f32 v137, v144, v145
    v_cvt_pk_bf16_f32 v141, v148, v149
    v_mfma_f32_16x16x32_bf16 v[168:171], v[208:211], v[120:123], v[168:171]
    s_waitcnt lgkmcnt(1)
    v_mfma_f32_16x16x32_bf16 v[172:175], v[208:211], v[124:127], v[172:175]
    v_pk_mul_f32 v[152:153], v[152:153], v[154:155]
    v_pk_mul_f32 v[156:157], v[156:157], v[158:159]
    v_cvt_pk_bf16_f32 v138, v152, v153
    v_cvt_pk_bf16_f32 v142, v156, v157
    v_mfma_f32_16x16x32_bf16 v[180:183], v[212:215], v[124:127], v[180:183]
    s_waitcnt lgkmcnt(0)
    v_mfma_f32_16x16x32_bf16 v[176:179], v[212:215], v[120:123], v[176:179]
    v_pk_mul_f32 v[160:161], v[160:161], v[162:163]
    v_pk_mul_f32 v[164:165], v[164:165], v[166:167]
    v_cvt_pk_bf16_f32 v139, v160, v161
    v_cvt_pk_bf16_f32 v143, v164, v165
    buffer_store_dwordx4 v[136:139], v7, s[12:15], s54 offen offset:0 sc1
    buffer_store_dwordx4 v[140:143], v7, s[12:15], s54 offen offset:1024 sc1
    v_mfma_f32_16x16x32_bf16 v[184:187], v[216:219], v[120:123], v[184:187]
    v_mfma_f32_16x16x32_bf16 v[188:191], v[216:219], v[124:127], v[188:191]
    v_pk_mul_f32 v[168:169], v[168:169], v[170:171]
    v_pk_mul_f32 v[172:173], v[172:173], v[174:175]
    v_cvt_pk_bf16_f32 v168, v168, v169
    v_cvt_pk_bf16_f32 v172, v172, v173
    v_pk_mul_f32 v[176:177], v[176:177], v[178:179]
    v_pk_mul_f32 v[180:181], v[180:181], v[182:183]
    v_cvt_pk_bf16_f32 v169, v176, v177
    v_cvt_pk_bf16_f32 v173, v180, v181
    s_nop 3
    v_pk_mul_f32 v[184:185], v[184:185], v[186:187]
    v_pk_mul_f32 v[188:189], v[188:189], v[190:191]
    v_cvt_pk_bf16_f32 v170, v184, v185
    v_cvt_pk_bf16_f32 v174, v188, v189
    v_mov_b32 v24, v170
    v_mov_b32 v25, v168
    v_mov_b32 v28, v174
    s_add_u32 s52, s66, 0x1ed0000
    buffer_load_dwordx4 v[120:123], v5, s[12:15], s52 offen sc1
    v_mov_b32 v29, v172
    s_nop 0
    v_permlane16_swap_b32 v24, v171
    v_permlane16_swap_b32 v25, v26
    v_permlane16_swap_b32 v28, v175
    v_permlane16_swap_b32 v29, v30
    s_nop 0
    v_mov_b32_dpp v26, v169 quad_perm:[0,1,2,3] row_mask:0x8 bank_mask:0xf
    v_mov_b32_dpp v30, v173 quad_perm:[0,1,2,3] row_mask:0x8 bank_mask:0xf
    s_nop 1
    v_permlane32_swap_b32 v26, v171
    v_permlane32_swap_b32 v30, v175
    buffer_load_dwordx4 v[124:127], v5, s[12:15], s52 offen offset:2048 sc1
    s_mov_b32 exec_hi, 0xffff
    buffer_store_dwordx4 v[168:171], v7, s[12:15], s54 offen offset:2048 sc1
    s_mov_b32 exec_hi, -1
    s_mov_b32 exec_hi, 0xffff
    buffer_store_dwordx4 v[172:175], v7, s[12:15], s54 offen offset:3072 sc1
    s_mov_b32 exec_hi, -1
    s_waitcnt vmcnt(22)
    v_mfma_f32_16x16x32_bf16 v[196:199], a[0:3], v[128:131], 0
    v_mfma_f32_16x16x32_bf16 v[200:203], a[4:7], v[128:131], 0
    v_mfma_f32_16x16x32_bf16 v[204:207], a[8:11], v[128:131], 0
    v_mfma_f32_16x16x32_bf16 v[208:211], a[12:15], v[128:131], 0
    v_mfma_f32_16x16x32_bf16 v[212:215], a[16:19], v[128:131], 0
    v_mfma_f32_16x16x32_bf16 v[196:199], a[20:23], v[132:135], v[196:199]
    v_mfma_f32_16x16x32_bf16 v[200:203], a[24:27], v[132:135], v[200:203]
    v_mfma_f32_16x16x32_bf16 v[204:207], a[28:31], v[132:135], v[204:207]
    v_mfma_f32_16x16x32_bf16 v[208:211], a[32:35], v[132:135], v[208:211]
    v_mfma_f32_16x16x32_bf16 v[212:215], a[36:39], v[132:135], v[212:215]
    s_waitcnt vmcnt(20)
    v_mfma_f32_16x16x32_bf16 v[196:199], a[40:43], v[80:83], v[196:199]
    s_add_u32 s52, s67, 0x1ed0000
    v_lshlrev_b32 v176, 16, v220
    v_mfma_f32_16x16x32_bf16 v[200:203], a[44:47], v[80:83], v[200:203]
    buffer_load_dwordx4 v[128:131], v5, s[12:15], s52 offen sc1
    v_mfma_f32_16x16x32_bf16 v[204:207], a[48:51], v[80:83], v[204:207]
    v_and_b32 v177, 0xffff0000, v220
    v_lshlrev_b32 v178, 16, v221
    v_mfma_f32_16x16x32_bf16 v[208:211], a[52:55], v[80:83], v[208:211]
    buffer_load_dwordx4 v[132:135], v5, s[12:15], s52 offen offset:2048 sc1
    v_mfma_f32_16x16x32_bf16 v[212:215], a[56:59], v[80:83], v[212:215]
    v_and_b32 v179, 0xffff0000, v221
    v_lshlrev_b32 v180, 16, v222
    v_mfma_f32_16x16x32_bf16 v[196:199], a[60:63], v[84:87], v[196:199]
    v_and_b32 v181, 0xffff0000, v222
    v_lshlrev_b32 v182, 16, v223
    v_mfma_f32_16x16x32_bf16 v[200:203], a[64:67], v[84:87], v[200:203]
    v_and_b32 v183, 0xffff0000, v223
    v_lshlrev_b32 v192, 16, v224
    v_mfma_f32_16x16x32_bf16 v[204:207], a[68:71], v[84:87], v[204:207]
    v_and_b32 v193, 0xffff0000, v224
    v_lshlrev_b32 v194, 16, v225
    v_mfma_f32_16x16x32_bf16 v[208:211], a[72:75], v[84:87], v[208:211]
    v_and_b32 v195, 0xffff0000, v225
    v_mfma_f32_16x16x32_bf16 v[212:215], a[76:79], v[84:87], v[212:215]
    s_waitcnt vmcnt(20)
    v_mfma_f32_16x16x32_bf16 v[196:199], a[80:83], v[88:91], v[196:199]
    s_add_u32 s52, s68, 0x1ed0000
    v_mfma_f32_16x16x32_bf16 v[200:203], a[84:87], v[88:91], v[200:203]
    buffer_load_dwordx4 v[80:83], v5, s[12:15], s52 offen sc1
    v_mfma_f32_16x16x32_bf16 v[204:207], a[88:91], v[88:91], v[204:207]
    v_mfma_f32_16x16x32_bf16 v[208:211], a[92:95], v[88:91], v[208:211]
    buffer_load_dwordx4 v[84:87], v5, s[12:15], s52 offen offset:2048 sc1
    v_mfma_f32_16x16x32_bf16 v[212:215], a[96:99], v[88:91], v[212:215]
    v_mfma_f32_16x16x32_bf16 v[196:199], a[100:103], v[92:95], v[196:199]
    v_mfma_f32_16x16x32_bf16 v[200:203], a[104:107], v[92:95], v[200:203]
    v_mfma_f32_16x16x32_bf16 v[204:207], a[108:111], v[92:95], v[204:207]
    v_mfma_f32_16x16x32_bf16 v[208:211], a[112:115], v[92:95], v[208:211]
    v_mfma_f32_16x16x32_bf16 v[212:215], a[116:119], v[92:95], v[212:215]
    s_waitcnt vmcnt(20)
    v_mfma_f32_16x16x32_bf16 v[196:199], a[120:123], v[96:99], v[196:199]
    s_add_u32 s52, s69, 0x1ed0000
    v_mfma_f32_16x16x32_bf16 v[200:203], a[124:127], v[96:99], v[200:203]
    buffer_load_dwordx4 v[88:91], v5, s[12:15], s52 offen sc1
    v_mfma_f32_16x16x32_bf16 v[204:207], a[128:131], v[96:99], v[204:207]
    v_mfma_f32_16x16x32_bf16 v[208:211], a[132:135], v[96:99], v[208:211]
    buffer_load_dwordx4 v[92:95], v5, s[12:15], s52 offen offset:2048 sc1
    v_mfma_f32_16x16x32_bf16 v[212:215], a[136:139], v[96:99], v[212:215]
    v_mfma_f32_16x16x32_bf16 v[196:199], a[140:143], v[100:103], v[196:199]
    v_mfma_f32_16x16x32_bf16 v[200:203], a[144:147], v[100:103], v[200:203]
    v_mfma_f32_16x16x32_bf16 v[204:207], a[148:151], v[100:103], v[204:207]
    v_mfma_f32_16x16x32_bf16 v[208:211], a[152:155], v[100:103], v[208:211]
    v_mfma_f32_16x16x32_bf16 v[212:215], a[156:159], v[100:103], v[212:215]
    s_waitcnt vmcnt(20)
    v_mfma_f32_16x16x32_bf16 v[196:199], a[160:163], v[104:107], v[196:199]
    s_add_u32 s52, s70, 0x1ed0000
    v_mfma_f32_16x16x32_bf16 v[200:203], a[164:167], v[104:107], v[200:203]
    buffer_load_dwordx4 v[96:99], v5, s[12:15], s52 offen sc1
    v_mfma_f32_16x16x32_bf16 v[204:207], a[168:171], v[104:107], v[204:207]
    v_mfma_f32_16x16x32_bf16 v[208:211], a[172:175], v[104:107], v[208:211]
    buffer_load_dwordx4 v[100:103], v5, s[12:15], s52 offen offset:2048 sc1
    v_mfma_f32_16x16x32_bf16 v[212:215], a[176:179], v[104:107], v[212:215]
    v_mfma_f32_16x16x32_bf16 v[196:199], a[180:183], v[108:111], v[196:199]
    v_mfma_f32_16x16x32_bf16 v[200:203], a[184:187], v[108:111], v[200:203]
    v_mfma_f32_16x16x32_bf16 v[204:207], a[188:191], v[108:111], v[204:207]
    v_mfma_f32_16x16x32_bf16 v[208:211], a[192:195], v[108:111], v[208:211]
    v_mfma_f32_16x16x32_bf16 v[212:215], a[196:199], v[108:111], v[212:215]
    s_waitcnt vmcnt(20)
    v_mfma_f32_16x16x32_bf16 v[196:199], a[200:203], v[112:115], v[196:199]
    v_mfma_f32_16x16x32_bf16 v[200:203], a[204:207], v[112:115], v[200:203]
    v_mfma_f32_16x16x32_bf16 v[204:207], a[208:211], v[112:115], v[204:207]
    v_mfma_f32_16x16x32_bf16 v[208:211], a[212:215], v[112:115], v[208:211]
    v_mfma_f32_16x16x32_bf16 v[212:215], a[216:219], v[112:115], v[212:215]
    v_mfma_f32_16x16x32_bf16 v[196:199], a[220:223], v[116:119], v[196:199]
    v_mfma_f32_16x16x32_bf16 v[200:203], a[224:227], v[116:119], v[200:203]
    v_mfma_f32_16x16x32_bf16 v[204:207], a[228:231], v[116:119], v[204:207]
    v_mfma_f32_16x16x32_bf16 v[208:211], a[232:235], v[116:119], v[208:211]
    v_mfma_f32_16x16x32_bf16 v[212:215], a[236:239], v[116:119], v[212:215]
    s_waitcnt vmcnt(8)
    s_add_u32 s55, s46, 0x1770000
    s_mov_b64 exec, 1
    buffer_store_dword v19, v20, s[12:15], s55 offen sc1
    s_mov_b64 exec, -1
    v_mfma_f32_16x16x32_bf16 v[196:199], a[240:243], v[56:59], v[196:199]
    v_mfma_f32_16x16x32_bf16 v[200:203], a[244:247], v[56:59], v[200:203]
    v_mfma_f32_16x16x32_bf16 v[204:207], a[248:251], v[56:59], v[204:207]
    v_mfma_f32_16x16x32_bf16 v[208:211], a[252:255], v[56:59], v[208:211]
    v_mfma_f32_16x16x32_bf16 v[212:215], v[32:35], v[56:59], v[212:215]
    v_mfma_f32_16x16x32_bf16 v[196:199], v[36:39], v[60:63], v[196:199]
    v_mfma_f32_16x16x32_bf16 v[200:203], v[40:43], v[60:63], v[200:203]
    v_mfma_f32_16x16x32_bf16 v[204:207], v[44:47], v[60:63], v[204:207]
    v_mfma_f32_16x16x32_bf16 v[208:211], v[48:51], v[60:63], v[208:211]
    v_mfma_f32_16x16x32_bf16 v[212:215], v[52:55], v[60:63], v[212:215]
    s_nop 1
    v_mfma_f32_16x16x32_bf16 v[176:179], a[0:3], v[64:67], v[176:179]
    v_mfma_f32_16x16x32_bf16 v[180:183], a[4:7], v[64:67], v[180:183]
    v_mfma_f32_16x16x32_bf16 v[184:187], a[8:11], v[64:67], 0
    v_mfma_f32_16x16x32_bf16 v[188:191], a[12:15], v[64:67], 0
    v_mfma_f32_16x16x32_bf16 v[192:195], a[16:19], v[64:67], v[192:195]
    v_mfma_f32_16x16x32_bf16 v[176:179], a[20:23], v[68:71], v[176:179]
    v_mfma_f32_16x16x32_bf16 v[180:183], a[24:27], v[68:71], v[180:183]
    v_mfma_f32_16x16x32_bf16 v[184:187], a[28:31], v[68:71], v[184:187]
    v_mfma_f32_16x16x32_bf16 v[188:191], a[32:35], v[68:71], v[188:191]
    v_mfma_f32_16x16x32_bf16 v[192:195], a[36:39], v[68:71], v[192:195]
    v_mfma_f32_16x16x32_bf16 v[176:179], a[40:43], v[72:75], v[176:179]
    ds_write_b128 v15, v[196:199] offset:0
    ds_write_b128 v15, v[200:203] offset:1024
    v_mfma_f32_16x16x32_bf16 v[180:183], a[44:47], v[72:75], v[180:183]
    ds_write_b128 v15, v[204:207] offset:2048
    ds_write_b128 v15, v[208:211] offset:3072
    v_mfma_f32_16x16x32_bf16 v[184:187], a[48:51], v[72:75], v[184:187]
    ds_write_b128 v15, v[212:215] offset:4096
    v_mfma_f32_16x16x32_bf16 v[188:191], a[52:55], v[72:75], v[188:191]
    v_mfma_f32_16x16x32_bf16 v[192:195], a[56:59], v[72:75], v[192:195]
    v_mfma_f32_16x16x32_bf16 v[176:179], a[60:63], v[76:79], v[176:179]
    v_mfma_f32_16x16x32_bf16 v[180:183], a[64:67], v[76:79], v[180:183]
    v_mfma_f32_16x16x32_bf16 v[184:187], a[68:71], v[76:79], v[184:187]
    v_mfma_f32_16x16x32_bf16 v[188:191], a[72:75], v[76:79], v[188:191]
    v_mfma_f32_16x16x32_bf16 v[192:195], a[76:79], v[76:79], v[192:195]
    v_mfma_f32_16x16x32_bf16 v[176:179], a[80:83], v[120:123], v[176:179]
    s_waitcnt lgkmcnt(0)
    s_barrier
    v_mfma_f32_16x16x32_bf16 v[180:183], a[84:87], v[120:123], v[180:183]
    ds_read_b128 v[196:199], v16 offset:0
    ds_read_b128 v[200:203], v16 offset:1024
    v_mfma_f32_16x16x32_bf16 v[184:187], a[88:91], v[120:123], v[184:187]
    ds_read_b128 v[204:207], v16 offset:4096
    ds_read_b128 v[208:211], v1 offset:2048
    v_mfma_f32_16x16x32_bf16 v[188:191], a[92:95], v[120:123], v[188:191]
    ds_read_b128 v[212:215], v1 offset:3072
    v_mfma_f32_16x16x32_bf16 v[192:195], a[96:99], v[120:123], v[192:195]
    v_mfma_f32_16x16x32_bf16 v[176:179], a[100:103], v[124:127], v[176:179]
    v_mfma_f32_16x16x32_bf16 v[180:183], a[104:107], v[124:127], v[180:183]
    v_mfma_f32_16x16x32_bf16 v[184:187], a[108:111], v[124:127], v[184:187]
    v_mfma_f32_16x16x32_bf16 v[188:191], a[112:115], v[124:127], v[188:191]
    v_mfma_f32_16x16x32_bf16 v[192:195], a[116:119], v[124:127], v[192:195]
    s_add_u32 s55, s44, 0x1770000
    buffer_load_dword v18, v13, s[12:15], s55 offen sc1
    s_waitcnt vmcnt(8)
    v_mfma_f32_16x16x32_bf16 v[176:179], a[120:123], v[128:131], v[176:179]
    s_waitcnt lgkmcnt(0)
    v_add_f32 v196, v196, v208
    v_mfma_f32_16x16x32_bf16 v[180:183], a[124:127], v[128:131], v[180:183]
    v_add_f32 v197, v197, v209
    v_add_f32 v198, v198, v210
    v_mfma_f32_16x16x32_bf16 v[184:187], a[128:131], v[128:131], v[184:187]
    v_add_f32 v199, v199, v211
    ds_read_b128 v[208:211], v1 offset:4096
    v_mfma_f32_16x16x32_bf16 v[188:191], a[132:135], v[128:131], v[188:191]
    v_add_f32 v200, v200, v212
    v_add_f32 v201, v201, v213
    v_mfma_f32_16x16x32_bf16 v[192:195], a[136:139], v[128:131], v[192:195]
    v_add_f32 v202, v202, v214
    v_add_f32 v203, v203, v215
    v_mfma_f32_16x16x32_bf16 v[176:179], a[140:143], v[132:135], v[176:179]
    v_mfma_f32_16x16x32_bf16 v[180:183], a[144:147], v[132:135], v[180:183]
    v_mfma_f32_16x16x32_bf16 v[184:187], a[148:151], v[132:135], v[184:187]
    v_mfma_f32_16x16x32_bf16 v[188:191], a[152:155], v[132:135], v[188:191]
    v_mfma_f32_16x16x32_bf16 v[192:195], a[156:159], v[132:135], v[192:195]
    s_waitcnt vmcnt(6)
    v_mfma_f32_16x16x32_bf16 v[176:179], a[160:163], v[80:83], v[176:179]
    s_waitcnt lgkmcnt(0)
    s_barrier
    v_mfma_f32_16x16x32_bf16 v[180:183], a[164:167], v[80:83], v[180:183]
    v_add_f32 v204, v204, v208
    v_add_f32 v205, v205, v209
    v_mfma_f32_16x16x32_bf16 v[184:187], a[168:171], v[80:83], v[184:187]
    v_add_f32 v206, v206, v210
    v_add_f32 v207, v207, v211
    v_mfma_f32_16x16x32_bf16 v[188:191], a[172:175], v[80:83], v[188:191]
    v_mfma_f32_16x16x32_bf16 v[192:195], a[176:179], v[80:83], v[192:195]
    v_mfma_f32_16x16x32_bf16 v[176:179], a[180:183], v[84:87], v[176:179]
    v_mfma_f32_16x16x32_bf16 v[180:183], a[184:187], v[84:87], v[180:183]
    v_mfma_f32_16x16x32_bf16 v[184:187], a[188:191], v[84:87], v[184:187]
    v_mfma_f32_16x16x32_bf16 v[188:191], a[192:195], v[84:87], v[188:191]
    v_mfma_f32_16x16x32_bf16 v[192:195], a[196:199], v[84:87], v[192:195]
    s_waitcnt vmcnt(4)
    v_mfma_f32_16x16x32_bf16 v[176:179], a[200:203], v[88:91], v[176:179]
    v_mfma_f32_16x16x32_bf16 v[180:183], a[204:207], v[88:91], v[180:183]
    v_mfma_f32_16x16x32_bf16 v[184:187], a[208:211], v[88:91], v[184:187]
    v_mfma_f32_16x16x32_bf16 v[188:191], a[212:215], v[88:91], v[188:191]
    v_mfma_f32_16x16x32_bf16 v[192:195], a[216:219], v[88:91], v[192:195]
    v_mfma_f32_16x16x32_bf16 v[176:179], a[220:223], v[92:95], v[176:179]
    v_mfma_f32_16x16x32_bf16 v[180:183], a[224:227], v[92:95], v[180:183]
    v_mfma_f32_16x16x32_bf16 v[184:187], a[228:231], v[92:95], v[184:187]
    v_mfma_f32_16x16x32_bf16 v[188:191], a[232:235], v[92:95], v[188:191]
    v_mfma_f32_16x16x32_bf16 v[192:195], a[236:239], v[92:95], v[192:195]
    s_waitcnt vmcnt(2)
    v_mfma_f32_16x16x32_bf16 v[184:187], a[248:251], v[96:99], v[184:187]
    v_mfma_f32_16x16x32_bf16 v[188:191], a[252:255], v[96:99], v[188:191]
    v_mfma_f32_16x16x32_bf16 v[192:195], v[32:35], v[96:99], v[192:195]
    v_mfma_f32_16x16x32_bf16 v[184:187], v[44:47], v[100:103], v[184:187]
    v_mfma_f32_16x16x32_bf16 v[188:191], v[48:51], v[100:103], v[188:191]
    v_mfma_f32_16x16x32_bf16 v[192:195], v[52:55], v[100:103], v[192:195]
    v_mfma_f32_16x16x32_bf16 v[176:179], a[240:243], v[96:99], v[176:179]
    v_mfma_f32_16x16x32_bf16 v[180:183], a[244:247], v[96:99], v[180:183]
    v_mfma_f32_16x16x32_bf16 v[176:179], v[36:39], v[100:103], v[176:179]
    v_mfma_f32_16x16x32_bf16 v[180:183], v[40:43], v[100:103], v[180:183]
    s_nop 2
    ds_write_b128 v15, v[184:187] offset:2048
    ds_write_b128 v15, v[188:191] offset:3072
    ds_write_b128 v15, v[192:195] offset:4096
    s_nop 3
    v_pk_add_f32 v[176:177], v[176:177], v[196:197]
    v_pk_add_f32 v[178:179], v[178:179], v[198:199]
    v_pk_add_f32 v[180:181], v[180:181], v[200:201]
    v_pk_add_f32 v[182:183], v[182:183], v[202:203]
    s_waitcnt lgkmcnt(0)
    s_barrier
    ds_read_b128 v[208:211], v17 offset:2048
    ds_read_b128 v[212:215], v17 offset:3072
    ds_read_b128 v[184:187], v17 offset:4096
    v_pk_add_f32 v[192:193], v[192:193], v[204:205]
    v_pk_add_f32 v[194:195], v[194:195], v[206:207]
    s_waitcnt vmcnt(0)
L_chk_56:
    v_cmp_ne_u32 vcc, v19, v18
    s_cbranch_vccz L_ok_57
    s_cmp_eq_u32 s50, 0
    s_cbranch_scc1 L_ok_57
    s_sub_u32 s50, s50, 1
    s_sleep 1
    s_mov_b64 exec, vcc
    s_add_u32 s55, s44, 0x1770000
    buffer_load_dword v18, v13, s[12:15], s55 offen sc1
    s_mov_b64 exec, -1
    s_waitcnt vmcnt(0)
    s_branch L_chk_56
L_ok_57:
    s_add_u32 s52, s64, 0x2250000
    buffer_load_dwordx4 v[104:107], v6, s[12:15], s52 offen sc1
    buffer_load_dwordx4 v[108:111], v6, s[12:15], s52 offen offset:2048 sc1
    s_add_u32 s52, s65, 0x2250000
    buffer_load_dwordx4 v[112:115], v6, s[12:15], s52 offen sc1
    buffer_load_dwordx4 v[116:119], v6, s[12:15], s52 offen offset:2048 sc1
    s_add_u32 s52, s66, 0x2250000
    buffer_load_dwordx4 v[56:59], v6, s[12:15], s52 offen sc1
    buffer_load_dwordx4 v[60:63], v6, s[12:15], s52 offen offset:2048 sc1
    s_add_u32 s52, s67, 0x2250000
    buffer_load_dwordx4 v[64:67], v6, s[12:15], s52 offen sc1
    buffer_load_dwordx4 v[68:71], v6, s[12:15], s52 offen offset:2048 sc1
    s_waitcnt lgkmcnt(2)
    v_pk_add_f32 v[176:177], v[176:177], v[208:209]
    v_pk_add_f32 v[178:179], v[178:179], v[210:211]
    s_waitcnt lgkmcnt(1)
    v_pk_add_f32 v[180:181], v[180:181], v[212:213]
    v_pk_add_f32 v[182:183], v[182:183], v[214:215]
    s_waitcnt lgkmcnt(0)
    v_pk_add_f32 v[192:193], v[192:193], v[184:185]
    v_pk_add_f32 v[194:195], v[194:195], v[186:187]
    v_cvt_pk_bf16_f32 v196, v176, v177
    v_cvt_pk_bf16_f32 v197, v178, v179
    v_cvt_pk_bf16_f32 v198, v180, v181
    v_cvt_pk_bf16_f32 v199, v182, v183
    v_cvt_pk_bf16_f32 v200, v192, v193
    v_cvt_pk_bf16_f32 v201, v194, v195
    s_add_u32 s55, s38, 0
    buffer_store_dwordx4 v[196:199], v10, s[20:23], s55 offen
    s_add_u32 s55, s38, 0
    s_mov_b64 exec, s[56:57]
    buffer_store_dwordx2 v[200:201], v11, s[20:23], s55 offen
    s_mov_b64 exec, -1
    s_add_u32 s52, s68, 0x2250000
    buffer_load_dwordx4 v[72:75], v6, s[12:15], s52 offen sc1
    buffer_load_dwordx4 v[76:79], v6, s[12:15], s52 offen offset:2048 sc1
    s_add_u32 s52, s69, 0x2250000
    buffer_load_dwordx4 v[120:123], v6, s[12:15], s52 offen sc1
    buffer_load_dwordx4 v[124:127], v6, s[12:15], s52 offen offset:2048 sc1
    s_add_u32 s52, s70, 0x2250000
    buffer_load_dwordx4 v[128:131], v6, s[12:15], s52 offen sc1
    buffer_load_dwordx4 v[132:135], v6, s[12:15], s52 offen offset:2048 sc1
    s_add_u32 s52, s64, 0x2250000
    buffer_load_dwordx4 v[80:83], v5, s[12:15], s52 offen sc1
    buffer_load_dwordx4 v[84:87], v5, s[12:15], s52 offen offset:2048 sc1
    s_add_u32 s52, s65, 0x2250000
    buffer_load_dwordx4 v[88:91], v5, s[12:15], s52 offen sc1
    buffer_load_dwordx4 v[92:95], v5, s[12:15], s52 offen offset:2048 sc1
    s_add_u32 s52, s66, 0x2250000
    buffer_load_dwordx4 v[96:99], v5, s[12:15], s52 offen sc1
    buffer_load_dwordx4 v[100:103], v5, s[12:15], s52 offen offset:2048 sc1
    s_waitcnt vmcnt(20)
    v_mfma_f32_16x16x32_bf16 v[156:159], a[0:3], v[104:107], 0
    v_mfma_f32_16x16x32_bf16 v[160:163], a[4:7], v[104:107], 0
    v_mfma_f32_16x16x32_bf16 v[164:167], a[8:11], v[104:107], 0
    v_mfma_f32_16x16x32_bf16 v[168:171], a[12:15], v[104:107], 0
    v_mfma_f32_16x16x32_bf16 v[172:175], a[16:19], v[104:107], 0
    v_mfma_f32_16x16x32_bf16 v[156:159], a[20:23], v[108:111], v[156:159]
    v_mfma_f32_16x16x32_bf16 v[160:163], a[24:27], v[108:111], v[160:163]
    v_mfma_f32_16x16x32_bf16 v[164:167], a[28:31], v[108:111], v[164:167]
    v_mfma_f32_16x16x32_bf16 v[168:171], a[32:35], v[108:111], v[168:171]
    v_mfma_f32_16x16x32_bf16 v[172:175], a[36:39], v[108:111], v[172:175]
    s_waitcnt vmcnt(18)
    v_mfma_f32_16x16x32_bf16 v[156:159], a[40:43], v[112:115], v[156:159]
    s_add_u32 s52, s67, 0x2250000
    v_lshlrev_b32 v136, 16, v226
    v_mfma_f32_16x16x32_bf16 v[160:163], a[44:47], v[112:115], v[160:163]
    buffer_load_dwordx4 v[104:107], v5, s[12:15], s52 offen sc1
    v_mfma_f32_16x16x32_bf16 v[164:167], a[48:51], v[112:115], v[164:167]
    v_and_b32 v137, 0xffff0000, v226
    v_lshlrev_b32 v138, 16, v227
    v_mfma_f32_16x16x32_bf16 v[168:171], a[52:55], v[112:115], v[168:171]
    buffer_load_dwordx4 v[108:111], v5, s[12:15], s52 offen offset:2048 sc1
    v_mfma_f32_16x16x32_bf16 v[172:175], a[56:59], v[112:115], v[172:175]
    v_and_b32 v139, 0xffff0000, v227
    v_lshlrev_b32 v140, 16, v228
    v_mfma_f32_16x16x32_bf16 v[156:159], a[60:63], v[116:119], v[156:159]
    v_and_b32 v141, 0xffff0000, v228
    v_lshlrev_b32 v142, 16, v229
    v_mfma_f32_16x16x32_bf16 v[160:163], a[64:67], v[116:119], v[160:163]
    v_and_b32 v143, 0xffff0000, v229
    v_lshlrev_b32 v152, 16, v230
    v_mfma_f32_16x16x32_bf16 v[164:167], a[68:71], v[116:119], v[164:167]
    v_and_b32 v153, 0xffff0000, v230
    v_lshlrev_b32 v154, 16, v231
    v_mfma_f32_16x16x32_bf16 v[168:171], a[72:75], v[116:119], v[168:171]
    v_and_b32 v155, 0xffff0000, v231
    v_mfma_f32_16x16x32_bf16 v[172:175], a[76:79], v[116:119], v[172:175]
    s_waitcnt vmcnt(18)
    v_mfma_f32_16x16x32_bf16 v[156:159], a[80:83], v[56:59], v[156:159]
    s_add_u32 s52, s68, 0x2250000
    v_mfma_f32_16x16x32_bf16 v[160:163], a[84:87], v[56:59], v[160:163]
    buffer_load_dwordx4 v[112:115], v5, s[12:15], s52 offen sc1
    v_mfma_f32_16x16x32_bf16 v[164:167], a[88:91], v[56:59], v[164:167]
    v_mfma_f32_16x16x32_bf16 v[168:171], a[92:95], v[56:59], v[168:171]
    buffer_load_dwordx4 v[116:119], v5, s[12:15], s52 offen offset:2048 sc1
    v_mfma_f32_16x16x32_bf16 v[172:175], a[96:99], v[56:59], v[172:175]
    v_mfma_f32_16x16x32_bf16 v[156:159], a[100:103], v[60:63], v[156:159]
    v_mfma_f32_16x16x32_bf16 v[160:163], a[104:107], v[60:63], v[160:163]
    v_mfma_f32_16x16x32_bf16 v[164:167], a[108:111], v[60:63], v[164:167]
    v_mfma_f32_16x16x32_bf16 v[168:171], a[112:115], v[60:63], v[168:171]
    v_mfma_f32_16x16x32_bf16 v[172:175], a[116:119], v[60:63], v[172:175]
    s_waitcnt vmcnt(18)
    v_mfma_f32_16x16x32_bf16 v[156:159], a[120:123], v[64:67], v[156:159]
    s_add_u32 s52, s69, 0x2250000
    v_mfma_f32_16x16x32_bf16 v[160:163], a[124:127], v[64:67], v[160:163]
    buffer_load_dwordx4 v[56:59], v5, s[12:15], s52 offen sc1
    v_mfma_f32_16x16x32_bf16 v[164:167], a[128:131], v[64:67], v[164:167]
    v_mfma_f32_16x16x32_bf16 v[168:171], a[132:135], v[64:67], v[168:171]
    buffer_load_dwordx4 v[60:63], v5, s[12:15], s52 offen offset:2048 sc1
    v_mfma_f32_16x16x32_bf16 v[172:175], a[136:139], v[64:67], v[172:175]
    v_mfma_f32_16x16x32_bf16 v[156:159], a[140:143], v[68:71], v[156:159]
    v_mfma_f32_16x16x32_bf16 v[160:163], a[144:147], v[68:71], v[160:163]
    v_mfma_f32_16x16x32_bf16 v[164:167], a[148:151], v[68:71], v[164:167]
    v_mfma_f32_16x16x32_bf16 v[168:171], a[152:155], v[68:71], v[168:171]
    v_mfma_f32_16x16x32_bf16 v[172:175], a[156:159], v[68:71], v[172:175]
    s_waitcnt vmcnt(16)
    v_mfma_f32_16x16x32_bf16 v[156:159], a[160:163], v[72:75], v[156:159]
    s_add_u32 s52, s70, 0x2250000
    v_mfma_f32_16x16x32_bf16 v[160:163], a[164:167], v[72:75], v[160:163]
    buffer_load_dwordx4 v[64:67], v5, s[12:15], s52 offen sc1
    v_mfma_f32_16x16x32_bf16 v[164:167], a[168:171], v[72:75], v[164:167]
    v_mfma_f32_16x16x32_bf16 v[168:171], a[172:175], v[72:75], v[168:171]
    buffer_load_dwordx4 v[68:71], v5, s[12:15], s52 offen offset:2048 sc1
    v_mfma_f32_16x16x32_bf16 v[172:175], a[176:179], v[72:75], v[172:175]
    v_mfma_f32_16x16x32_bf16 v[156:159], a[180:183], v[76:79], v[156:159]
    v_mfma_f32_16x16x32_bf16 v[160:163], a[184:187], v[76:79], v[160:163]
    v_mfma_f32_16x16x32_bf16 v[164:167], a[188:191], v[76:79], v[164:167]
    v_mfma_f32_16x16x32_bf16 v[168:171], a[192:195], v[76:79], v[168:171]
    v_mfma_f32_16x16x32_bf16 v[172:175], a[196:199], v[76:79], v[172:175]
    s_waitcnt vmcnt(16)
    v_mfma_f32_16x16x32_bf16 v[156:159], a[200:203], v[120:123], v[156:159]
    v_mfma_f32_16x16x32_bf16 v[160:163], a[204:207], v[120:123], v[160:163]
    v_mfma_f32_16x16x32_bf16 v[164:167], a[208:211], v[120:123], v[164:167]
    v_mfma_f32_16x16x32_bf16 v[168:171], a[212:215], v[120:123], v[168:171]
    v_mfma_f32_16x16x32_bf16 v[172:175], a[216:219], v[120:123], v[172:175]
    v_mfma_f32_16x16x32_bf16 v[156:159], a[220:223], v[124:127], v[156:159]
    v_mfma_f32_16x16x32_bf16 v[160:163], a[224:227], v[124:127], v[160:163]
    v_mfma_f32_16x16x32_bf16 v[164:167], a[228:231], v[124:127], v[164:167]
    v_mfma_f32_16x16x32_bf16 v[168:171], a[232:235], v[124:127], v[168:171]
    v_mfma_f32_16x16x32_bf16 v[172:175], a[236:239], v[124:127], v[172:175]
    s_waitcnt vmcnt(14)
    v_mfma_f32_16x16x32_bf16 v[156:159], a[240:243], v[128:131], v[156:159]
    v_mfma_f32_16x16x32_bf16 v[160:163], a[244:247], v[128:131], v[160:163]
    v_mfma_f32_16x16x32_bf16 v[164:167], a[248:251], v[128:131], v[164:167]
    v_mfma_f32_16x16x32_bf16 v[168:171], a[252:255], v[128:131], v[168:171]
    v_mfma_f32_16x16x32_bf16 v[172:175], v[32:35], v[128:131], v[172:175]
    v_mfma_f32_16x16x32_bf16 v[156:159], v[36:39], v[132:135], v[156:159]
    v_mfma_f32_16x16x32_bf16 v[160:163], v[40:43], v[132:135], v[160:163]
    v_mfma_f32_16x16x32_bf16 v[164:167], v[44:47], v[132:135], v[164:167]
    v_mfma_f32_16x16x32_bf16 v[168:171], v[48:51], v[132:135], v[168:171]
    v_mfma_f32_16x16x32_bf16 v[172:175], v[52:55], v[132:135], v[172:175]
    s_waitcnt vmcnt(12)
    s_nop 1
    v_mfma_f32_16x16x32_bf16 v[136:139], a[0:3], v[80:83], v[136:139]
    v_mfma_f32_16x16x32_bf16 v[140:143], a[4:7], v[80:83], v[140:143]
    v_mfma_f32_16x16x32_bf16 v[144:147], a[8:11], v[80:83], 0
    v_mfma_f32_16x16x32_bf16 v[148:151], a[12:15], v[80:83], 0
    v_mfma_f32_16x16x32_bf16 v[152:155], a[16:19], v[80:83], v[152:155]
    v_mfma_f32_16x16x32_bf16 v[136:139], a[20:23], v[84:87], v[136:139]
    v_mfma_f32_16x16x32_bf16 v[140:143], a[24:27], v[84:87], v[140:143]
    v_mfma_f32_16x16x32_bf16 v[144:147], a[28:31], v[84:87], v[144:147]
    v_mfma_f32_16x16x32_bf16 v[148:151], a[32:35], v[84:87], v[148:151]
    v_mfma_f32_16x16x32_bf16 v[152:155], a[36:39], v[84:87], v[152:155]
    s_waitcnt vmcnt(10)
    v_mfma_f32_16x16x32_bf16 v[136:139], a[40:43], v[88:91], v[136:139]
    s_barrier
    ds_write_b128 v15, v[156:159] offset:0
    v_mfma_f32_16x16x32_bf16 v[140:143], a[44:47], v[88:91], v[140:143]
    ds_write_b128 v15, v[160:163] offset:1024
    ds_write_b128 v15, v[164:167] offset:2048
    v_mfma_f32_16x16x32_bf16 v[144:147], a[48:51], v[88:91], v[144:147]
    ds_write_b128 v15, v[168:171] offset:3072
    ds_write_b128 v15, v[172:175] offset:4096
    v_mfma_f32_16x16x32_bf16 v[148:151], a[52:55], v[88:91], v[148:151]
    v_mfma_f32_16x16x32_bf16 v[152:155], a[56:59], v[88:91], v[152:155]
    v_mfma_f32_16x16x32_bf16 v[136:139], a[60:63], v[92:95], v[136:139]
    v_mfma_f32_16x16x32_bf16 v[140:143], a[64:67], v[92:95], v[140:143]
    v_mfma_f32_16x16x32_bf16 v[144:147], a[68:71], v[92:95], v[144:147]
    v_mfma_f32_16x16x32_bf16 v[148:151], a[72:75], v[92:95], v[148:151]
    v_mfma_f32_16x16x32_bf16 v[152:155], a[76:79], v[92:95], v[152:155]
    s_waitcnt vmcnt(8)
    v_mfma_f32_16x16x32_bf16 v[136:139], a[80:83], v[96:99], v[136:139]
    s_waitcnt lgkmcnt(0)
    s_barrier
    v_mfma_f32_16x16x32_bf16 v[140:143], a[84:87], v[96:99], v[140:143]
    ds_read_b128 v[156:159], v16 offset:0
    ds_read_b128 v[160:163], v16 offset:1024
    v_mfma_f32_16x16x32_bf16 v[144:147], a[88:91], v[96:99], v[144:147]
    ds_read_b128 v[164:167], v16 offset:4096
    ds_read_b128 v[168:171], v1 offset:2048
    v_mfma_f32_16x16x32_bf16 v[148:151], a[92:95], v[96:99], v[148:151]
    ds_read_b128 v[172:175], v1 offset:3072
    v_mfma_f32_16x16x32_bf16 v[152:155], a[96:99], v[96:99], v[152:155]
    v_mfma_f32_16x16x32_bf16 v[136:139], a[100:103], v[100:103], v[136:139]
    v_mfma_f32_16x16x32_bf16 v[140:143], a[104:107], v[100:103], v[140:143]
    v_mfma_f32_16x16x32_bf16 v[144:147], a[108:111], v[100:103], v[144:147]
    v_mfma_f32_16x16x32_bf16 v[148:151], a[112:115], v[100:103], v[148:151]
    v_mfma_f32_16x16x32_bf16 v[152:155], a[116:119], v[100:103], v[152:155]
    s_waitcnt vmcnt(6)
    v_mfma_f32_16x16x32_bf16 v[136:139], a[120:123], v[104:107], v[136:139]
    s_waitcnt lgkmcnt(0)
    v_add_f32 v156, v156, v168
    v_mfma_f32_16x16x32_bf16 v[140:143], a[124:127], v[104:107], v[140:143]
    v_add_f32 v157, v157, v169
    v_add_f32 v158, v158, v170
    v_mfma_f32_16x16x32_bf16 v[144:147], a[128:131], v[104:107], v[144:147]
    v_add_f32 v159, v159, v171
    ds_read_b128 v[168:171], v1 offset:4096
    v_mfma_f32_16x16x32_bf16 v[148:151], a[132:135], v[104:107], v[148:151]
    v_add_f32 v160, v160, v172
    v_add_f32 v161, v161, v173
    v_mfma_f32_16x16x32_bf16 v[152:155], a[136:139], v[104:107], v[152:155]
    v_add_f32 v162, v162, v174
    v_add_f32 v163, v163, v175
    v_mfma_f32_16x16x32_bf16 v[136:139], a[140:143], v[108:111], v[136:139]
    v_mfma_f32_16x16x32_bf16 v[140:143], a[144:147], v[108:111], v[140:143]
    v_mfma_f32_16x16x32_bf16 v[144:147], a[148:151], v[108:111], v[144:147]
    v_mfma_f32_16x16x32_bf16 v[148:151], a[152:155], v[108:111], v[148:151]
    v_mfma_f32_16x16x32_bf16 v[152:155], a[156:159], v[108:111], v[152:155]
    s_waitcnt vmcnt(4)
    v_mfma_f32_16x16x32_bf16 v[136:139], a[160:163], v[112:115], v[136:139]
    s_waitcnt lgkmcnt(0)
    s_barrier
    v_mfma_f32_16x16x32_bf16 v[140:143], a[164:167], v[112:115], v[140:143]
    v_add_f32 v164, v164, v168
    v_add_f32 v165, v165, v169
    v_mfma_f32_16x16x32_bf16 v[144:147], a[168:171], v[112:115], v[144:147]
    v_add_f32 v166, v166, v170
    v_add_f32 v167, v167, v171
    v_mfma_f32_16x16x32_bf16 v[148:151], a[172:175], v[112:115], v[148:151]
    v_mfma_f32_16x16x32_bf16 v[152:155], a[176:179], v[112:115], v[152:155]
    v_mfma_f32_16x16x32_bf16 v[136:139], a[180:183], v[116:119], v[136:139]
    v_mfma_f32_16x16x32_bf16 v[140:143], a[184:187], v[116:119], v[140:143]
    v_mfma_f32_16x16x32_bf16 v[144:147], a[188:191], v[116:119], v[144:147]
    v_mfma_f32_16x16x32_bf16 v[148:151], a[192:195], v[116:119], v[148:151]
    v_mfma_f32_16x16x32_bf16 v[152:155], a[196:199], v[116:119], v[152:155]
    s_waitcnt vmcnt(2)
    v_mfma_f32_16x16x32_bf16 v[136:139], a[200:203], v[56:59], v[136:139]
    v_mfma_f32_16x16x32_bf16 v[140:143], a[204:207], v[56:59], v[140:143]
    v_mfma_f32_16x16x32_bf16 v[144:147], a[208:211], v[56:59], v[144:147]
    v_mfma_f32_16x16x32_bf16 v[148:151], a[212:215], v[56:59], v[148:151]
    v_mfma_f32_16x16x32_bf16 v[152:155], a[216:219], v[56:59], v[152:155]
    v_mfma_f32_16x16x32_bf16 v[136:139], a[220:223], v[60:63], v[136:139]
    v_mfma_f32_16x16x32_bf16 v[140:143], a[224:227], v[60:63], v[140:143]
    v_mfma_f32_16x16x32_bf16 v[144:147], a[228:231], v[60:63], v[144:147]
    v_mfma_f32_16x16x32_bf16 v[148:151], a[232:235], v[60:63], v[148:151]
    v_mfma_f32_16x16x32_bf16 v[152:155], a[236:239], v[60:63], v[152:155]
    s_waitcnt vmcnt(0)
    v_mfma_f32_16x16x32_bf16 v[144:147], a[248:251], v[64:67], v[144:147]
    v_mfma_f32_16x16x32_bf16 v[148:151], a[252:255], v[64:67], v[148:151]
    v_mfma_f32_16x16x32_bf16 v[152:155], v[32:35], v[64:67], v[152:155]
    v_mfma_f32_16x16x32_bf16 v[144:147], v[44:47], v[68:71], v[144:147]
    v_mfma_f32_16x16x32_bf16 v[148:151], v[48:51], v[68:71], v[148:151]
    v_mfma_f32_16x16x32_bf16 v[152:155], v[52:55], v[68:71], v[152:155]
    v_mfma_f32_16x16x32_bf16 v[136:139], a[240:243], v[64:67], v[136:139]
    v_mfma_f32_16x16x32_bf16 v[140:143], a[244:247], v[64:67], v[140:143]
    v_mfma_f32_16x16x32_bf16 v[136:139], v[36:39], v[68:71], v[136:139]
    v_mfma_f32_16x16x32_bf16 v[140:143], v[40:43], v[68:71], v[140:143]
    s_nop 2
    ds_write_b128 v15, v[144:147] offset:2048
    ds_write_b128 v15, v[148:151] offset:3072
    ds_write_b128 v15, v[152:155] offset:4096
    s_nop 3
    v_pk_add_f32 v[136:137], v[136:137], v[156:157]
    v_pk_add_f32 v[138:139], v[138:139], v[158:159]
    v_pk_add_f32 v[140:141], v[140:141], v[160:161]
    v_pk_add_f32 v[142:143], v[142:143], v[162:163]
    s_waitcnt lgkmcnt(0)
    s_barrier
    ds_read_b128 v[168:171], v17 offset:2048
    ds_read_b128 v[172:175], v17 offset:3072
    ds_read_b128 v[144:147], v17 offset:4096
    v_pk_add_f32 v[152:153], v[152:153], v[164:165]
    v_pk_add_f32 v[154:155], v[154:155], v[166:167]
    s_waitcnt lgkmcnt(2)
    v_pk_add_f32 v[136:137], v[136:137], v[168:169]
    v_pk_add_f32 v[138:139], v[138:139], v[170:171]
    s_waitcnt lgkmcnt(1)
    v_pk_add_f32 v[140:141], v[140:141], v[172:173]
    v_pk_add_f32 v[142:143], v[142:143], v[174:175]
    s_waitcnt lgkmcnt(0)
    v_pk_add_f32 v[152:153], v[152:153], v[144:145]
    v_pk_add_f32 v[154:155], v[154:155], v[146:147]
    v_cvt_pk_bf16_f32 v156, v136, v137
    v_cvt_pk_bf16_f32 v157, v138, v139
    v_cvt_pk_bf16_f32 v158, v140, v141
    v_cvt_pk_bf16_f32 v159, v142, v143
    v_cvt_pk_bf16_f32 v160, v152, v153
    v_cvt_pk_bf16_f32 v161, v154, v155
    s_add_u32 s55, s38, 1310720
    buffer_store_dwordx4 v[156:159], v10, s[20:23], s55 offen
    s_add_u32 s55, s38, 1310720
    s_mov_b64 exec, s[56:57]
    buffer_store_dwordx2 v[160:161], v11, s[20:23], s55 offen
    s_mov_b64 exec, -1
L_end_1:
    s_endpgm
.section .rodata,"a"
.p2align 6
.amdhsa_kernel interleave_layers__ssm_conv_h3__glu_gated_bilinear__prompt_kernel
  .amdhsa_next_free_vgpr 512
  .amdhsa_next_free_sgpr 102
  .amdhsa_accum_offset 256
  .amdhsa_group_segment_fixed_size 0
  .amdhsa_kernarg_size 104
  .amdhsa_user_sgpr_count 2
  .amdhsa_user_sgpr_kernarg_segment_ptr 1
  .amdhsa_system_sgpr_workgroup_id_x 1
  .amdhsa_float_denorm_mode_32 3
.end_amdhsa_kernel
```
